```python
import torch

def _softmax(x, axis=-1):
    return torch.softmax(x, dim=axis)

def _gelu(x):
    return torch.nn.functional.gelu(x, approximate='tanh')

def _silu(x):
    return torch.nn.functional.silu(x)

def _sigmoid(x):
    return torch.sigmoid(x)

def _layernorm(x, axis=-1, eps=1e-05):
    m = x.mean(dim=axis, keepdim=True)
    v = x.var(dim=axis, keepdim=True, unbiased=False)
    return (x - m) / torch.sqrt(v + eps)

def _scatter_add(tgt, idx, src, axis=0):
    return tgt.clone().index_add_(axis, idx, src)

def _segment_sum(src, seg, n):
    out = torch.zeros((n,) + src.shape[1:], dtype=src.dtype)
    return out.index_add_(0, seg, src)

def _pad(x, pw):
    flat = tuple((v for pair in reversed(pw) for v in pair))
    return torch.nn.functional.pad(x, flat)
kernel_name = 'sequential_preLN__memory_aug_recurrent_mem_tr__mixer_s_mlp__prompt'

def setup_inputs():

    _w = lambda a: (lambda t: t.to(torch.bfloat16) if t.is_floating_point() else t)(torch.as_tensor(a))

    def _A_setup():
        B, S, Dm = (1, 2048, 1024)
        H, Dh = (32, 128)
        M, seg = (8, 32)
        seg = min(seg, S)
        S = S // seg * seg
        return {'x': _w((lambda *s: torch.randn(*s, dtype=torch.bfloat16) * 0.05)(B, S, Dm)), 'mem0': _w((lambda *s: torch.randn(*s, dtype=torch.bfloat16) * 0.2)(B, M, Dm)), 'Wq': _w((lambda *s: torch.randn(*s, dtype=torch.bfloat16) * 1.6)(Dm, H, Dh) * Dm ** (-0.5)), 'Wk': _w((lambda *s: torch.randn(*s, dtype=torch.bfloat16) * 1.6)(Dm, H, Dh) * Dm ** (-0.5)), 'Wv': _w((lambda *s: torch.randn(*s, dtype=torch.bfloat16) * 0.2)(Dm, H, Dh) * Dm ** (-0.5)), 'Wo': _w((lambda *s: torch.randn(*s, dtype=torch.bfloat16) * 0.2)(H, Dh, Dm) * (H * Dh) ** (-0.5)), 'seg_len': seg}
    _A_in = _A_setup()

    def _B_setup():
        B, S, D, F = (1, 2048, 1024, 3584)
        return {'x': _w((lambda *s: torch.randn(*s, dtype=torch.bfloat16) * 0.05)(B, S, D)), 'w1': _w((lambda *s: torch.randn(*s, dtype=torch.bfloat16) * 0.8)(D, D) * D ** (-0.5)), 'w2': _w((lambda *s: torch.randn(*s, dtype=torch.bfloat16) * 0.8)(D, D) * D ** (-0.5)), 'w3': _w((lambda *s: torch.randn(*s, dtype=torch.bfloat16) * 0.8)(D, F) * D ** (-0.5)), 'w4': _w((lambda *s: torch.randn(*s, dtype=torch.bfloat16) * 0.8)(F, D) * F ** (-0.5))}
    _B_in = _B_setup()
    return {'A_x': _A_in['x'], 'A_mem0': _A_in['mem0'], 'A_Wq': _A_in['Wq'], 'A_Wk': _A_in['Wk'], 'A_Wv': _A_in['Wv'], 'A_Wo': _A_in['Wo'], 'A_seg_len': _A_in['seg_len'], 'B_x': _B_in['x'], 'B_w1': _B_in['w1'], 'B_w2': _B_in['w2'], 'B_w3': _B_in['w3'], 'B_w4': _B_in['w4']}

def reference(A_x, A_mem0, A_Wq, A_Wk, A_Wv, A_Wo, A_seg_len, B_x, B_w1, B_w2, B_w3, B_w4):

    def _A_ref(x, mem0, Wq, Wk, Wv, Wo, seg_len):
        B, S, Dm = x.shape
        H, Dh = (Wq.shape[1], Wq.shape[2])
        M = mem0.shape[1]
        scale = Dh ** (-0.5)
        n_seg = S // seg_len
        L = M + seg_len
        idx = torch.arange(L)
        mask = (idx[:, None] < M) | (idx[:, None] >= idx[None, :])
        mem = mem0
        outs = []
        for s in range(n_seg):
            xs = x[:, s * seg_len:(s + 1) * seg_len, :].clone()
            h = torch.concatenate([mem, xs], axis=1)
            q = torch.einsum('btd,dhe->bhte', h, Wq)
            k = torch.einsum('btd,dhe->bhte', h, Wk)
            v = torch.einsum('btd,dhe->bhte', h, Wv)
            scores = torch.einsum('bhqe,bhke->bhqk', q, k) * scale
            scores = torch.where(mask[None, None], scores, -1000000000.0)
            p = _softmax(scores, axis=-1)
            o = torch.einsum('bhqk,bhke->bhqe', p, v)
            o = torch.einsum('bhte,hed->btd', o, Wo)
            mem = o[:, :M, :].clone()
            outs.append(o[:, M:, :])
        return torch.concatenate(outs, axis=1)

    def _B_ref(x, w1, w2, w3, w4):
        B, S, D = x.shape
        h = _gelu(_layernorm(x, axis=-1) @ w1)
        c = D // 4
        g0 = _pad(h[:, :, 0 * c:1 * c], ((0, 0), (1, 0), (0, 0)))[:, :S, :]
        g1 = _pad(h[:, :, 1 * c:2 * c], ((0, 0), (0, 1), (0, 0)))[:, 1:, :]
        g2 = _pad(h[:, :, 2 * c:3 * c], ((0, 0), (2, 0), (0, 0)))[:, :S, :]
        g3 = _pad(h[:, :, 3 * c:], ((0, 0), (0, 2), (0, 0)))[:, 2:, :]
        hs = torch.concatenate([g0, g1, g2, g3], axis=-1) @ w2
        x1 = x + hs
        h2 = _gelu(_layernorm(x1, axis=-1) @ w3) @ w4
        return x1 + h2
    x = A_x
    h = x + _A_ref(_layernorm(x, axis=-1), A_mem0, A_Wq, A_Wk, A_Wv, A_Wo, A_seg_len)
    h2 = h + _B_ref(_layernorm(h, axis=-1), B_w1, B_w2, B_w3, B_w4)
    return h2
```

```asm
; @launch grid=(256,1,1) block=(256,1,1) lds=163840
.amdgcn_target "amdgcn-amd-amdhsa--gfx950"
.text
.globl sequential_preLN__memory_aug_recurrent_mem_tr__mixer_s_mlp__prompt_kernel
.p2align 8
.type sequential_preLN__memory_aug_recurrent_mem_tr__mixer_s_mlp__prompt_kernel,@function
sequential_preLN__memory_aug_recurrent_mem_tr__mixer_s_mlp__prompt_kernel:
    s_cmp_ge_u32 s2, 256
    s_cbranch_scc1 L_exit_main
    s_load_dwordx2 s[4:5], s[0:1], 112
    s_load_dwordx2 s[6:7], s[0:1], 104
    s_getreg_b32 s16, hwreg(HW_REG_XCC_ID)
    s_and_b32 s16, s16, 15
    s_waitcnt lgkmcnt(0)
    s_mov_b32 s8, s4
    s_mov_b32 s9, s5
    s_mov_b32 s10, 268435456
    s_mov_b32 s11, 0x00020000
    v_cmp_eq_u32 vcc, 0, v0
    s_and_saveexec_b64 s[20:21], vcc
    s_cbranch_execz L_nt
    s_lshl_b32 s17, s16, 2
    v_mov_b32 v1, s17
    v_mov_b32 v2, 1
    global_atomic_add v3, v1, v2, s[6:7] sc0 sc1
    s_waitcnt vmcnt(0)
    v_mov_b32 v1, 0
    ds_write_b32 v1, v3
    s_waitcnt lgkmcnt(0)
L_nt:
    s_mov_b64 exec, s[20:21]
    s_barrier
    v_mov_b32 v1, 0
    ds_read_b32 v3, v1
    s_waitcnt lgkmcnt(0)
    v_readfirstlane_b32 s17, v3
    s_barrier
    s_cmp_ge_u32 s17, 32
    s_cbranch_scc1 L_exit_main
    s_cmp_ge_u32 s16, 2
    s_cbranch_scc1 worker
    v_and_b32 v120, 63, v0
    v_lshrrev_b32 v123, 6, v0
    s_nop 0
    v_readfirstlane_b32 s18, v123
    v_lshrrev_b32 v121, 4, v120
    v_and_b32 v122, 15, v120
    s_lshr_b32 s37, s17, 1
    s_and_b32 s20, s17, 1
    s_lshl_b32 s19, s16, 4
    s_add_u32 s19, s19, s37
    v_cmp_le_u32 s[42:43], 32, v120
    v_cmp_gt_u32 s[44:45], 8, v122
    s_mov_b32 s46, 0x3e0293ee
    s_mov_b32 s47, 0xfffefffe
    s_mov_b32 s56, 0x3e0293ee
    s_mov_b32 s57, 0x3e0293ee
    s_mov_b32 s54, -1
    s_mov_b32 s55, 0
    v_lshlrev_b32 v0, 4, v120
    s_sub_u32 s37, s18, 1
    s_and_b32 s37, s37, 3
    s_lshl_b32 s37, s37, 10
    s_add_u32 s37, s37, 131072
    v_add_u32 v1, s37, v0
    s_sub_u32 s37, s18, 2
    s_and_b32 s37, s37, 3
    s_lshl_b32 s37, s37, 10
    s_add_u32 s37, s37, 134144
    v_add_u32 v2, s37, v0
    s_sub_u32 s37, s18, 3
    s_and_b32 s37, s37, 3
    s_lshl_b32 s37, s37, 10
    s_add_u32 s37, s37, 137216
    v_add_u32 v3, s37, v0
    s_sub_u32 s37, s18, 4
    s_and_b32 s37, s37, 3
    s_lshl_b32 s37, s37, 10
    s_add_u32 s37, s37, 140288
    v_add_u32 v4, s37, v0
    s_mul_i32 s37, s18, 3072
    s_add_u32 s37, s37, 131072
    v_add_u32 v5, s37, v0
    s_lshl_b32 s37, s18, 11
    s_add_u32 s37, s37, 143360
    v_add_u32 v6, s37, v0
    s_lshr_b32 s37, s18, 1
    s_lshl_b32 s37, s37, 10
    s_and_b32 s38, s18, 1
    s_lshl_b32 s38, s38, 3
    s_add_u32 s37, s37, s38
    s_add_u32 s37, s37, 143360
    v_add_u32 v7, s37, v0
    s_lshl_b32 s37, s18, 15
    v_add_u32 v19, s37, v0
    s_lshl_b32 s37, s18, 10
    s_add_u32 s37, s37, 147456
    v_lshlrev_b32 v29, 8, v121
    v_lshl_add_u32 v29, v122, 2, v29
    v_add_u32 v29, s37, v29
    v_lshrrev_b32 v123, 2, v122
    v_lshlrev_b32 v123, 1, v123
    v_and_b32 v124, 1, v122
    v_add_u32 v123, v123, v124
    v_lshlrev_b32 v30, 7, v123
    v_bfe_u32 v124, v122, 1, 1
    v_lshl_add_u32 v30, v124, 5, v30
    v_bfe_u32 v124, v120, 4, 1
    v_lshl_add_u32 v30, v124, 6, v30
    v_add_u32 v30, 147456, v30
    v_mov_b32 v119, v123
    v_and_b32 v123, 7, v122
    v_lshrrev_b32 v124, 3, v122
    v_lshlrev_b32 v8, 7, v124
    v_lshl_add_u32 v8, v121, 5, v8
    v_lshl_add_u32 v8, v123, 1, v8
    s_lshl_b32 s37, s20, 10
    s_lshl_b32 s38, s18, 8
    s_add_u32 s37, s37, s38
    v_add_u32 v8, s37, v8
    v_lshlrev_b32 v9, 7, v121
    v_lshl_add_u32 v9, v123, 4, v9
    v_add_u32 v10, 131072, v9
    v_lshlrev_b32 v13, 7, v121
    v_lshl_add_u32 v13, v119, 4, v13
    v_add_u32 v13, 133120, v13
    v_and_b32 v125, 1, v121
    v_lshrrev_b32 v126, 1, v122
    v_lshlrev_b32 v11, 2, v126
    v_and_b32 v126, 1, v122
    v_add_u32 v11, v11, v126
    v_lshrrev_b32 v126, 1, v121
    v_lshl_add_u32 v11, v126, 1, v11
    v_lshlrev_b32 v11, 4, v11
    v_lshl_add_u32 v11, v125, 3, v11
    s_lshl_b32 s38, s17, 10
    s_lshl_b32 s39, s18, 8
    s_add_u32 s38, s38, s39
    v_add_u32 v11, s38, v11
    v_mov_b32 v126, 0x7ff00000
    v_cndmask_b32 v11, v126, v11, s[44:45]
    v_mov_b32 v12, 0x4444
    v_mov_b32 v125, 0xeeee
    v_and_b32 v126, 2, v122
    v_cmp_ne_u32 vcc, 0, v126
    s_nop 1
    v_cndmask_b32 v12, v12, v125, vcc
    v_mov_b32 v34, 0x3f803f80
    v_mov_b32 v35, 0x3f803f80
    v_xor_b32 v125, v121, v122
    v_lshlrev_b32 v125, 4, v125
    v_lshl_add_u32 v125, v122, 8, v125
    v_add_u32 v14, 151552, v125
    v_xor_b32 v15, 64, v14
    v_xor_b32 v16, 128, v14
    v_xor_b32 v17, 192, v14
    v_lshrrev_b32 v125, 2, v122
    v_lshl_add_u32 v125, v121, 2, v125
    v_lshrrev_b32 v126, 1, v125
    v_and_b32 v126, 3, v126
    v_xor_b32 v126, s18, v126
    v_lshlrev_b32 v126, 5, v126
    v_lshl_add_u32 v126, v125, 7, v126
    v_and_b32 v125, 3, v122
    v_lshl_add_u32 v126, v125, 3, v126
    v_add_u32 v18, 159744, v126
    v_lshlrev_b32 v20, 4, v121
    v_lshl_add_u32 v20, v122, 13, v20
    v_lshrrev_b32 v125, 2, v122
    v_cmp_eq_u32 s[58:59], s20, v125
    v_mov_b32 v126, 0x7ff00000
    v_lshlrev_b32 v21, 2, v120
    v_mov_b32 v33, 0
    v_cndmask_b32 v20, v126, v20, s[58:59]
    v_cmp_eq_u32 vcc, 0, v120
    s_nop 1
    v_cndmask_b32 v31, v126, 0, vcc
    v_add_u32 v125, 0, v121
    v_xor_b32 v126, v125, v122
    v_lshlrev_b32 v126, 4, v126
    v_lshl_add_u32 v126, v125, 13, v126
    v_subrev_u32 v22, 0, v126
    v_add_u32 v125, 4, v121
    v_xor_b32 v126, v125, v122
    v_lshlrev_b32 v126, 4, v126
    v_lshl_add_u32 v126, v125, 13, v126
    v_subrev_u32 v23, 1024, v126
    v_add_u32 v125, 8, v121
    v_xor_b32 v126, v125, v122
    v_lshlrev_b32 v126, 4, v126
    v_lshl_add_u32 v126, v125, 13, v126
    v_subrev_u32 v24, 2048, v126
    v_add_u32 v125, 12, v121
    v_xor_b32 v126, v125, v122
    v_lshlrev_b32 v126, 4, v126
    v_lshl_add_u32 v126, v125, 13, v126
    v_subrev_u32 v25, 3072, v126
    s_cmp_lg_u32 s18, 3
    s_cbranch_scc1 w3_1
    v_lshrrev_b32 v125, 3, v120
    v_add_u32 v125, 0, v125
    v_lshrrev_b32 v126, 1, v125
    v_and_b32 v126, 3, v126
    v_bfe_u32 v124, v120, 1, 2
    v_xor_b32 v126, v126, v124
    v_lshlrev_b32 v126, 5, v126
    v_and_b32 v124, 1, v120
    v_lshl_add_u32 v126, v124, 4, v126
    v_lshl_add_u32 v126, v125, 13, v126
    v_subrev_u32 v22, 0, v126
    v_lshrrev_b32 v125, 3, v120
    v_add_u32 v125, 8, v125
    v_lshrrev_b32 v126, 1, v125
    v_and_b32 v126, 3, v126
    v_bfe_u32 v124, v120, 1, 2
    v_xor_b32 v126, v126, v124
    v_lshlrev_b32 v126, 5, v126
    v_and_b32 v124, 1, v120
    v_lshl_add_u32 v126, v124, 4, v126
    v_lshl_add_u32 v126, v125, 13, v126
    v_subrev_u32 v23, 1024, v126
    v_lshrrev_b32 v125, 3, v120
    v_add_u32 v125, 16, v125
    v_lshrrev_b32 v126, 1, v125
    v_and_b32 v126, 3, v126
    v_bfe_u32 v124, v120, 1, 2
    v_xor_b32 v126, v126, v124
    v_lshlrev_b32 v126, 5, v126
    v_and_b32 v124, 1, v120
    v_lshl_add_u32 v126, v124, 4, v126
    v_lshl_add_u32 v126, v125, 13, v126
    v_subrev_u32 v24, 2048, v126
    v_lshrrev_b32 v125, 3, v120
    v_add_u32 v125, 24, v125
    v_lshrrev_b32 v126, 1, v125
    v_and_b32 v126, 3, v126
    v_bfe_u32 v124, v120, 1, 2
    v_xor_b32 v126, v126, v124
    v_lshlrev_b32 v126, 5, v126
    v_and_b32 v124, 1, v120
    v_lshl_add_u32 v126, v124, 4, v126
    v_lshl_add_u32 v126, v125, 13, v126
    v_subrev_u32 v25, 3072, v126
w3_1:
    v_bfe_u32 v125, v120, 4, 1
    v_lshlrev_b32 v26, 11, v125
    v_lshl_add_u32 v26, v122, 4, v26
    s_lshl_b32 s37, s20, 10
    s_lshl_b32 s38, s18, 8
    s_add_u32 s37, s37, s38
    v_add_u32 v26, s37, v26
    s_lshl_b32 s37, s17, 10
    s_add_u32 s37, s37, s38
    v_add_u32 v27, s37, v0
    s_lshl_b32 s37, s17, 9
    v_add_u32 v28, s37, v0
    v_mov_b32 v126, 0x7ff00000
    v_cndmask_b32 v26, v26, v126, s[42:43]
    v_cndmask_b32 v28, v28, v126, s[42:43]
    v_cmp_le_u32 vcc, 16, v120
    s_nop 1
    v_cndmask_b32 v27, v27, v126, vcc
    s_lshl_b32 s37, s19, 8
    s_lshl_b32 s38, s18, 6
    s_add_u32 s86, s37, s38
    s_add_u32 s86, s86, 54525952
    s_lshl_b32 s37, s19, 3
    s_lshl_b32 s38, s20, 2
    s_add_u32 s37, s37, s38
    s_add_u32 s37, s37, s18
    s_lshl_b32 s87, s37, 8
    s_add_u32 s87, s87, 58720256
    s_lshl_b32 s88, s37, 2
    s_add_u32 s88, s88, 84017152
    s_lshl_b32 s89, s19, 14
    s_add_u32 s89, s89, 79822848
    s_lshl_b32 s90, s16, 16
    s_add_u32 s90, s90, 79691776
    s_xor_b32 s37, s16, 1
    s_lshl_b32 s91, s37, 16
    s_add_u32 s91, s91, 81788928
    s_lshl_b32 s92, s16, 17
    s_add_u32 s92, s92, 80740352
    s_lshl_b32 s37, s19, 8
    s_sub_u32 s38, s18, 1
    s_lshl_b32 s39, s38, 17
    s_add_u32 s93, s37, s39
    s_add_u32 s93, s93, 20971520
    s_lshl_b32 s94, s38, 12
    s_add_u32 s94, s94, 151552
    s_lshl_b32 s38, s20, 7
    s_add_u32 s37, s37, s38
    s_add_u32 s37, s37, 37748736
    s_cmp_eq_u32 s18, 3
    s_cselect_b32 s93, s37, s93
    s_cselect_b32 s94, 159744, s94
    v_mov_b32 v40, -1
    v_mov_b32 v41, -1
    v_mov_b32 v42, -1
    v_mov_b32 v43, -1
    s_add_u32 s37, s89, 0
    buffer_store_dwordx4 v[40:43], v26, s[8:11], s37 offen
    s_add_u32 s37, s92, 0
    buffer_store_dwordx4 v[40:43], v27, s[8:11], s37 offen
    s_cmp_lg_u32 s18, 0
    s_cbranch_scc1 pp_2
    s_add_u32 s37, s90, 0
    buffer_store_dwordx4 v[40:43], v28, s[8:11], s37 offen
    s_add_u32 s37, s37, 2097152
    buffer_store_dwordx4 v[40:43], v28, s[8:11], s37 offen sc1
pp_2:
    s_add_u32 s37, s89, 4096
    buffer_store_dwordx4 v[40:43], v26, s[8:11], s37 offen
    s_add_u32 s37, s92, 32768
    buffer_store_dwordx4 v[40:43], v27, s[8:11], s37 offen
    s_cmp_lg_u32 s18, 0
    s_cbranch_scc1 pp_3
    s_add_u32 s37, s90, 16384
    buffer_store_dwordx4 v[40:43], v28, s[8:11], s37 offen
    s_add_u32 s37, s37, 2097152
    buffer_store_dwordx4 v[40:43], v28, s[8:11], s37 offen sc1
pp_3:
    s_add_u32 s37, s89, 8192
    buffer_store_dwordx4 v[40:43], v26, s[8:11], s37 offen
    s_add_u32 s37, s92, 65536
    buffer_store_dwordx4 v[40:43], v27, s[8:11], s37 offen
    s_cmp_lg_u32 s18, 0
    s_cbranch_scc1 pp_4
    s_add_u32 s37, s90, 32768
    buffer_store_dwordx4 v[40:43], v28, s[8:11], s37 offen
    s_add_u32 s37, s37, 2097152
    buffer_store_dwordx4 v[40:43], v28, s[8:11], s37 offen sc1
pp_4:
    s_add_u32 s37, s89, 12288
    buffer_store_dwordx4 v[40:43], v26, s[8:11], s37 offen
    s_add_u32 s37, s92, 98304
    buffer_store_dwordx4 v[40:43], v27, s[8:11], s37 offen
    s_cmp_lg_u32 s18, 0
    s_cbranch_scc1 pp_5
    s_add_u32 s37, s90, 49152
    buffer_store_dwordx4 v[40:43], v28, s[8:11], s37 offen
    s_add_u32 s37, s37, 2097152
    buffer_store_dwordx4 v[40:43], v28, s[8:11], s37 offen sc1
pp_5:
    s_waitcnt vmcnt(0)
    s_cmp_lg_u32 s18, 0
    s_cbranch_scc1 m0_6
    s_load_dwordx2 s[12:13], s[0:1], 8
    s_mov_b32 s14, 16384
    s_mov_b32 s15, 0x00020000
    s_waitcnt lgkmcnt(0)
    v_lshlrev_b32 v125, 11, v119
    v_bfe_u32 v126, v122, 1, 1
    v_lshl_add_u32 v125, v126, 4, v125
    v_bfe_u32 v126, v120, 4, 1
    v_lshl_add_u32 v125, v126, 5, v125
    s_lshl_b32 s38, s17, 6
    v_add_u32 v125, s38, v125
    buffer_load_dwordx4 v[40:43], v125, s[12:15], 0 offen
    s_waitcnt vmcnt(0)
    v_pk_min_u16 v40, v40, s47
    v_pk_min_u16 v41, v41, s47
    v_pk_min_u16 v42, v42, s47
    v_pk_min_u16 v43, v43, s47
    s_cmp_eq_u32 s16, 0
    s_cbranch_scc1 mz_7
    v_mov_b32 v40, 0
    v_mov_b32 v41, 0
    v_mov_b32 v42, 0
    v_mov_b32 v43, 0
mz_7:
    buffer_store_dwordx4 v[40:43], v28, s[8:11], s90 offen
    s_add_u32 s39, s90, 2097152
    buffer_store_dwordx4 v[40:43], v28, s[8:11], s39 offen sc1
    s_waitcnt vmcnt(0)
m0_6:
    s_mov_b64 exec, 1
    v_mov_b32 v125, 1
    v_mov_b32 v126, 64
    global_atomic_add v126, v125, s[6:7] sc1
    s_mov_b64 exec, -1
    v_lshrrev_b32 v125, 3, v120
    v_lshlrev_b32 v40, 13, v125
    v_and_b32 v126, 7, v120
    v_lshl_add_u32 v40, v126, 4, v40
    v_bfe_u32 v125, v122, 2, 1
    v_and_b32 v126, 1, v121
    v_lshl_add_u32 v125, v126, 2, v125
    v_lshrrev_b32 v126, 3, v122
    v_lshl_add_u32 v125, v126, 3, v125
    v_lshrrev_b32 v126, 1, v121
    v_lshl_add_u32 v125, v126, 4, v125
    v_lshlrev_b32 v125, 7, v125
    v_and_b32 v126, 3, v122
    v_lshl_add_u32 v125, v126, 3, v125
    s_and_b32 s37, s18, 1
    s_lshl_b32 s37, s37, 15
    v_add_u32 v41, s37, v125
    v_add_u32 v42, 65536, v41
    v_lshrrev_b32 v125, 2, v120
    v_and_b32 v126, 9, v125
    v_bfe_u32 v124, v125, 1, 1
    v_lshl_add_u32 v126, v124, 2, v126
    v_bfe_u32 v124, v125, 2, 1
    v_lshl_add_u32 v126, v124, 1, v126
    v_lshlrev_b32 v43, 11, v126
    v_bfe_u32 v124, v120, 1, 1
    v_lshrrev_b32 v123, 5, v120
    v_xor_b32 v124, v124, v123
    v_lshl_add_u32 v43, v124, 5, v43
    v_and_b32 v124, 1, v120
    v_lshl_add_u32 v43, v124, 4, v43
    v_bfe_u32 v125, v122, 2, 1
    v_and_b32 v126, 1, v121
    v_lshl_add_u32 v125, v126, 1, v125
    v_lshrrev_b32 v126, 3, v122
    v_lshl_add_u32 v125, v126, 3, v125
    v_lshrrev_b32 v124, 1, v121
    v_lshl_add_u32 v125, v124, 4, v125
    v_lshlrev_b32 v125, 6, v125
    v_lshl_add_u32 v125, v126, 5, v125
    v_and_b32 v124, 3, v122
    v_lshl_add_u32 v125, v124, 3, v125
    s_lshl_b32 s37, s18, 15
    v_add_u32 v44, s37, v125
    v_xor_b32 v45, 32, v44
    s_load_dwordx2 s[12:13], s[0:1], 16
    s_mov_b32 s14, 8388608
    s_mov_b32 s15, 0x00020000
    s_lshl_b32 s37, s19, 8
    s_lshl_b32 s38, s20, 7
    s_add_u32 s37, s37, s38
    s_lshl_b32 s38, s18, 20
    s_add_u32 s37, s37, s38
    s_add_u32 s37, s37, 0
    s_lshl_b32 s38, s18, 14
    s_add_u32 s38, s38, 0
    s_waitcnt lgkmcnt(0)
    s_add_u32 m0, s38, 0
    s_add_u32 s39, s37, 0
    buffer_load_dwordx4 v40, s[12:15], s39 offen lds
    s_add_u32 m0, s38, 1024
    s_add_u32 s39, s37, 65536
    buffer_load_dwordx4 v40, s[12:15], s39 offen lds
    s_add_u32 m0, s38, 2048
    s_add_u32 s39, s37, 131072
    buffer_load_dwordx4 v40, s[12:15], s39 offen lds
    s_add_u32 m0, s38, 3072
    s_add_u32 s39, s37, 196608
    buffer_load_dwordx4 v40, s[12:15], s39 offen lds
    s_add_u32 m0, s38, 4096
    s_add_u32 s39, s37, 262144
    buffer_load_dwordx4 v40, s[12:15], s39 offen lds
    s_add_u32 m0, s38, 5120
    s_add_u32 s39, s37, 327680
    buffer_load_dwordx4 v40, s[12:15], s39 offen lds
    s_add_u32 m0, s38, 6144
    s_add_u32 s39, s37, 393216
    buffer_load_dwordx4 v40, s[12:15], s39 offen lds
    s_add_u32 m0, s38, 7168
    s_add_u32 s39, s37, 458752
    buffer_load_dwordx4 v40, s[12:15], s39 offen lds
    s_add_u32 m0, s38, 8192
    s_add_u32 s39, s37, 524288
    buffer_load_dwordx4 v40, s[12:15], s39 offen lds
    s_add_u32 m0, s38, 9216
    s_add_u32 s39, s37, 589824
    buffer_load_dwordx4 v40, s[12:15], s39 offen lds
    s_add_u32 m0, s38, 10240
    s_add_u32 s39, s37, 655360
    buffer_load_dwordx4 v40, s[12:15], s39 offen lds
    s_add_u32 m0, s38, 11264
    s_add_u32 s39, s37, 720896
    buffer_load_dwordx4 v40, s[12:15], s39 offen lds
    s_add_u32 m0, s38, 12288
    s_add_u32 s39, s37, 786432
    buffer_load_dwordx4 v40, s[12:15], s39 offen lds
    s_add_u32 m0, s38, 13312
    s_add_u32 s39, s37, 851968
    buffer_load_dwordx4 v40, s[12:15], s39 offen lds
    s_add_u32 m0, s38, 14336
    s_add_u32 s39, s37, 917504
    buffer_load_dwordx4 v40, s[12:15], s39 offen lds
    s_add_u32 m0, s38, 15360
    s_add_u32 s39, s37, 983040
    buffer_load_dwordx4 v40, s[12:15], s39 offen lds
    s_load_dwordx2 s[12:13], s[0:1], 16
    s_mov_b32 s14, 8388608
    s_mov_b32 s15, 0x00020000
    s_lshl_b32 s37, s19, 8
    s_lshl_b32 s38, s20, 7
    s_add_u32 s37, s37, s38
    s_lshl_b32 s38, s18, 20
    s_add_u32 s37, s37, s38
    s_add_u32 s37, s37, 4194304
    s_lshl_b32 s38, s18, 14
    s_add_u32 s38, s38, 65536
    s_waitcnt lgkmcnt(0)
    s_add_u32 m0, s38, 0
    s_add_u32 s39, s37, 0
    buffer_load_dwordx4 v40, s[12:15], s39 offen lds
    s_add_u32 m0, s38, 1024
    s_add_u32 s39, s37, 65536
    buffer_load_dwordx4 v40, s[12:15], s39 offen lds
    s_add_u32 m0, s38, 2048
    s_add_u32 s39, s37, 131072
    buffer_load_dwordx4 v40, s[12:15], s39 offen lds
    s_add_u32 m0, s38, 3072
    s_add_u32 s39, s37, 196608
    buffer_load_dwordx4 v40, s[12:15], s39 offen lds
    s_add_u32 m0, s38, 4096
    s_add_u32 s39, s37, 262144
    buffer_load_dwordx4 v40, s[12:15], s39 offen lds
    s_add_u32 m0, s38, 5120
    s_add_u32 s39, s37, 327680
    buffer_load_dwordx4 v40, s[12:15], s39 offen lds
    s_add_u32 m0, s38, 6144
    s_add_u32 s39, s37, 393216
    buffer_load_dwordx4 v40, s[12:15], s39 offen lds
    s_add_u32 m0, s38, 7168
    s_add_u32 s39, s37, 458752
    buffer_load_dwordx4 v40, s[12:15], s39 offen lds
    s_add_u32 m0, s38, 8192
    s_add_u32 s39, s37, 524288
    buffer_load_dwordx4 v40, s[12:15], s39 offen lds
    s_add_u32 m0, s38, 9216
    s_add_u32 s39, s37, 589824
    buffer_load_dwordx4 v40, s[12:15], s39 offen lds
    s_add_u32 m0, s38, 10240
    s_add_u32 s39, s37, 655360
    buffer_load_dwordx4 v40, s[12:15], s39 offen lds
    s_add_u32 m0, s38, 11264
    s_add_u32 s39, s37, 720896
    buffer_load_dwordx4 v40, s[12:15], s39 offen lds
    s_add_u32 m0, s38, 12288
    s_add_u32 s39, s37, 786432
    buffer_load_dwordx4 v40, s[12:15], s39 offen lds
    s_add_u32 m0, s38, 13312
    s_add_u32 s39, s37, 851968
    buffer_load_dwordx4 v40, s[12:15], s39 offen lds
    s_add_u32 m0, s38, 14336
    s_add_u32 s39, s37, 917504
    buffer_load_dwordx4 v40, s[12:15], s39 offen lds
    s_add_u32 m0, s38, 15360
    s_add_u32 s39, s37, 983040
    buffer_load_dwordx4 v40, s[12:15], s39 offen lds
    s_waitcnt vmcnt(16)
    s_barrier
    s_lshr_b32 s37, s18, 1
    s_cmp_lg_u32 s37, 0
    s_cbranch_scc1 rce_8
    ds_read_b64_tr_b16 a[0:1], v41 offset:0
    ds_read_b64_tr_b16 a[2:3], v41 offset:256
    ds_read_b64_tr_b16 a[4:5], v41 offset:4096
    ds_read_b64_tr_b16 a[6:7], v41 offset:4352
    ds_read_b64_tr_b16 a[8:9], v41 offset:32
    ds_read_b64_tr_b16 a[10:11], v41 offset:288
    ds_read_b64_tr_b16 a[12:13], v41 offset:4128
    ds_read_b64_tr_b16 a[14:15], v41 offset:4384
    s_waitcnt lgkmcnt(0)
    ds_read_b64_tr_b16 a[16:17], v41 offset:64
    ds_read_b64_tr_b16 a[18:19], v41 offset:320
    ds_read_b64_tr_b16 a[20:21], v41 offset:4160
    ds_read_b64_tr_b16 a[22:23], v41 offset:4416
    ds_read_b64_tr_b16 a[24:25], v41 offset:96
    ds_read_b64_tr_b16 a[26:27], v41 offset:352
    ds_read_b64_tr_b16 a[28:29], v41 offset:4192
    ds_read_b64_tr_b16 a[30:31], v41 offset:4448
    s_waitcnt lgkmcnt(0)
    ds_read_b64_tr_b16 a[96:97], v41 offset:8192
    ds_read_b64_tr_b16 a[98:99], v41 offset:8448
    ds_read_b64_tr_b16 a[100:101], v41 offset:12288
    ds_read_b64_tr_b16 a[102:103], v41 offset:12544
    ds_read_b64_tr_b16 a[104:105], v41 offset:8224
    ds_read_b64_tr_b16 a[106:107], v41 offset:8480
    ds_read_b64_tr_b16 a[108:109], v41 offset:12320
    ds_read_b64_tr_b16 a[110:111], v41 offset:12576
    s_waitcnt lgkmcnt(0)
    ds_read_b64_tr_b16 a[112:113], v41 offset:8256
    ds_read_b64_tr_b16 a[114:115], v41 offset:8512
    ds_read_b64_tr_b16 a[116:117], v41 offset:12352
    ds_read_b64_tr_b16 a[118:119], v41 offset:12608
    ds_read_b64_tr_b16 a[120:121], v41 offset:8288
    ds_read_b64_tr_b16 a[122:123], v41 offset:8544
    ds_read_b64_tr_b16 a[124:125], v41 offset:12384
    ds_read_b64_tr_b16 a[126:127], v41 offset:12640
    s_waitcnt lgkmcnt(0)
    ds_read_b64_tr_b16 a[192:193], v41 offset:16384
    ds_read_b64_tr_b16 a[194:195], v41 offset:16640
    ds_read_b64_tr_b16 a[196:197], v41 offset:20480
    ds_read_b64_tr_b16 a[198:199], v41 offset:20736
    ds_read_b64_tr_b16 a[200:201], v41 offset:16416
    ds_read_b64_tr_b16 a[202:203], v41 offset:16672
    ds_read_b64_tr_b16 a[204:205], v41 offset:20512
    ds_read_b64_tr_b16 a[206:207], v41 offset:20768
    s_waitcnt lgkmcnt(0)
    ds_read_b64_tr_b16 a[208:209], v41 offset:16448
    ds_read_b64_tr_b16 a[210:211], v41 offset:16704
    ds_read_b64_tr_b16 a[212:213], v41 offset:20544
    ds_read_b64_tr_b16 a[214:215], v41 offset:20800
    ds_read_b64_tr_b16 a[216:217], v41 offset:16480
    ds_read_b64_tr_b16 a[218:219], v41 offset:16736
    ds_read_b64_tr_b16 a[220:221], v41 offset:20576
    ds_read_b64_tr_b16 a[222:223], v41 offset:20832
    s_waitcnt lgkmcnt(0)
    ds_read_b64_tr_b16 v[160:161], v41 offset:24576
    ds_read_b64_tr_b16 v[162:163], v41 offset:24832
    ds_read_b64_tr_b16 v[164:165], v41 offset:28672
    ds_read_b64_tr_b16 v[166:167], v41 offset:28928
    ds_read_b64_tr_b16 v[168:169], v41 offset:24608
    ds_read_b64_tr_b16 v[170:171], v41 offset:24864
    ds_read_b64_tr_b16 v[172:173], v41 offset:28704
    ds_read_b64_tr_b16 v[174:175], v41 offset:28960
    s_waitcnt lgkmcnt(0)
    ds_read_b64_tr_b16 v[176:177], v41 offset:24640
    ds_read_b64_tr_b16 v[178:179], v41 offset:24896
    ds_read_b64_tr_b16 v[180:181], v41 offset:28736
    ds_read_b64_tr_b16 v[182:183], v41 offset:28992
    ds_read_b64_tr_b16 v[184:185], v41 offset:24672
    ds_read_b64_tr_b16 v[186:187], v41 offset:24928
    ds_read_b64_tr_b16 v[188:189], v41 offset:28768
    ds_read_b64_tr_b16 v[190:191], v41 offset:29024
    s_waitcnt lgkmcnt(0)
rce_8:
    s_waitcnt lgkmcnt(0)
    s_barrier
    s_load_dwordx2 s[12:13], s[0:1], 24
    s_mov_b32 s14, 8388608
    s_mov_b32 s15, 0x00020000
    s_lshl_b32 s37, s19, 8
    s_lshl_b32 s38, s20, 7
    s_add_u32 s37, s37, s38
    s_lshl_b32 s38, s18, 20
    s_add_u32 s37, s37, s38
    s_add_u32 s37, s37, 0
    s_lshl_b32 s38, s18, 14
    s_add_u32 s38, s38, 0
    s_waitcnt lgkmcnt(0)
    s_add_u32 m0, s38, 0
    s_add_u32 s39, s37, 0
    buffer_load_dwordx4 v40, s[12:15], s39 offen lds
    s_add_u32 m0, s38, 1024
    s_add_u32 s39, s37, 65536
    buffer_load_dwordx4 v40, s[12:15], s39 offen lds
    s_add_u32 m0, s38, 2048
    s_add_u32 s39, s37, 131072
    buffer_load_dwordx4 v40, s[12:15], s39 offen lds
    s_add_u32 m0, s38, 3072
    s_add_u32 s39, s37, 196608
    buffer_load_dwordx4 v40, s[12:15], s39 offen lds
    s_add_u32 m0, s38, 4096
    s_add_u32 s39, s37, 262144
    buffer_load_dwordx4 v40, s[12:15], s39 offen lds
    s_add_u32 m0, s38, 5120
    s_add_u32 s39, s37, 327680
    buffer_load_dwordx4 v40, s[12:15], s39 offen lds
    s_add_u32 m0, s38, 6144
    s_add_u32 s39, s37, 393216
    buffer_load_dwordx4 v40, s[12:15], s39 offen lds
    s_add_u32 m0, s38, 7168
    s_add_u32 s39, s37, 458752
    buffer_load_dwordx4 v40, s[12:15], s39 offen lds
    s_add_u32 m0, s38, 8192
    s_add_u32 s39, s37, 524288
    buffer_load_dwordx4 v40, s[12:15], s39 offen lds
    s_add_u32 m0, s38, 9216
    s_add_u32 s39, s37, 589824
    buffer_load_dwordx4 v40, s[12:15], s39 offen lds
    s_add_u32 m0, s38, 10240
    s_add_u32 s39, s37, 655360
    buffer_load_dwordx4 v40, s[12:15], s39 offen lds
    s_add_u32 m0, s38, 11264
    s_add_u32 s39, s37, 720896
    buffer_load_dwordx4 v40, s[12:15], s39 offen lds
    s_add_u32 m0, s38, 12288
    s_add_u32 s39, s37, 786432
    buffer_load_dwordx4 v40, s[12:15], s39 offen lds
    s_add_u32 m0, s38, 13312
    s_add_u32 s39, s37, 851968
    buffer_load_dwordx4 v40, s[12:15], s39 offen lds
    s_add_u32 m0, s38, 14336
    s_add_u32 s39, s37, 917504
    buffer_load_dwordx4 v40, s[12:15], s39 offen lds
    s_add_u32 m0, s38, 15360
    s_add_u32 s39, s37, 983040
    buffer_load_dwordx4 v40, s[12:15], s39 offen lds
    s_waitcnt vmcnt(16)
    s_barrier
    s_lshr_b32 s37, s18, 1
    s_cmp_lg_u32 s37, 1
    s_cbranch_scc1 rce_9
    ds_read_b64_tr_b16 a[0:1], v42 offset:0
    ds_read_b64_tr_b16 a[2:3], v42 offset:256
    ds_read_b64_tr_b16 a[4:5], v42 offset:4096
    ds_read_b64_tr_b16 a[6:7], v42 offset:4352
    ds_read_b64_tr_b16 a[8:9], v42 offset:32
    ds_read_b64_tr_b16 a[10:11], v42 offset:288
    ds_read_b64_tr_b16 a[12:13], v42 offset:4128
    ds_read_b64_tr_b16 a[14:15], v42 offset:4384
    s_waitcnt lgkmcnt(0)
    ds_read_b64_tr_b16 a[16:17], v42 offset:64
    ds_read_b64_tr_b16 a[18:19], v42 offset:320
    ds_read_b64_tr_b16 a[20:21], v42 offset:4160
    ds_read_b64_tr_b16 a[22:23], v42 offset:4416
    ds_read_b64_tr_b16 a[24:25], v42 offset:96
    ds_read_b64_tr_b16 a[26:27], v42 offset:352
    ds_read_b64_tr_b16 a[28:29], v42 offset:4192
    ds_read_b64_tr_b16 a[30:31], v42 offset:4448
    s_waitcnt lgkmcnt(0)
    ds_read_b64_tr_b16 a[96:97], v42 offset:8192
    ds_read_b64_tr_b16 a[98:99], v42 offset:8448
    ds_read_b64_tr_b16 a[100:101], v42 offset:12288
    ds_read_b64_tr_b16 a[102:103], v42 offset:12544
    ds_read_b64_tr_b16 a[104:105], v42 offset:8224
    ds_read_b64_tr_b16 a[106:107], v42 offset:8480
    ds_read_b64_tr_b16 a[108:109], v42 offset:12320
    ds_read_b64_tr_b16 a[110:111], v42 offset:12576
    s_waitcnt lgkmcnt(0)
    ds_read_b64_tr_b16 a[112:113], v42 offset:8256
    ds_read_b64_tr_b16 a[114:115], v42 offset:8512
    ds_read_b64_tr_b16 a[116:117], v42 offset:12352
    ds_read_b64_tr_b16 a[118:119], v42 offset:12608
    ds_read_b64_tr_b16 a[120:121], v42 offset:8288
    ds_read_b64_tr_b16 a[122:123], v42 offset:8544
    ds_read_b64_tr_b16 a[124:125], v42 offset:12384
    ds_read_b64_tr_b16 a[126:127], v42 offset:12640
    s_waitcnt lgkmcnt(0)
    ds_read_b64_tr_b16 a[192:193], v42 offset:16384
    ds_read_b64_tr_b16 a[194:195], v42 offset:16640
    ds_read_b64_tr_b16 a[196:197], v42 offset:20480
    ds_read_b64_tr_b16 a[198:199], v42 offset:20736
    ds_read_b64_tr_b16 a[200:201], v42 offset:16416
    ds_read_b64_tr_b16 a[202:203], v42 offset:16672
    ds_read_b64_tr_b16 a[204:205], v42 offset:20512
    ds_read_b64_tr_b16 a[206:207], v42 offset:20768
    s_waitcnt lgkmcnt(0)
    ds_read_b64_tr_b16 a[208:209], v42 offset:16448
    ds_read_b64_tr_b16 a[210:211], v42 offset:16704
    ds_read_b64_tr_b16 a[212:213], v42 offset:20544
    ds_read_b64_tr_b16 a[214:215], v42 offset:20800
    ds_read_b64_tr_b16 a[216:217], v42 offset:16480
    ds_read_b64_tr_b16 a[218:219], v42 offset:16736
    ds_read_b64_tr_b16 a[220:221], v42 offset:20576
    ds_read_b64_tr_b16 a[222:223], v42 offset:20832
    s_waitcnt lgkmcnt(0)
    ds_read_b64_tr_b16 v[160:161], v42 offset:24576
    ds_read_b64_tr_b16 v[162:163], v42 offset:24832
    ds_read_b64_tr_b16 v[164:165], v42 offset:28672
    ds_read_b64_tr_b16 v[166:167], v42 offset:28928
    ds_read_b64_tr_b16 v[168:169], v42 offset:24608
    ds_read_b64_tr_b16 v[170:171], v42 offset:24864
    ds_read_b64_tr_b16 v[172:173], v42 offset:28704
    ds_read_b64_tr_b16 v[174:175], v42 offset:28960
    s_waitcnt lgkmcnt(0)
    ds_read_b64_tr_b16 v[176:177], v42 offset:24640
    ds_read_b64_tr_b16 v[178:179], v42 offset:24896
    ds_read_b64_tr_b16 v[180:181], v42 offset:28736
    ds_read_b64_tr_b16 v[182:183], v42 offset:28992
    ds_read_b64_tr_b16 v[184:185], v42 offset:24672
    ds_read_b64_tr_b16 v[186:187], v42 offset:24928
    ds_read_b64_tr_b16 v[188:189], v42 offset:28768
    ds_read_b64_tr_b16 v[190:191], v42 offset:29024
    s_waitcnt lgkmcnt(0)
rce_9:
    s_waitcnt lgkmcnt(0)
    s_barrier
    s_load_dwordx2 s[12:13], s[0:1], 24
    s_mov_b32 s14, 8388608
    s_mov_b32 s15, 0x00020000
    s_lshl_b32 s37, s19, 8
    s_lshl_b32 s38, s20, 7
    s_add_u32 s37, s37, s38
    s_lshl_b32 s38, s18, 20
    s_add_u32 s37, s37, s38
    s_add_u32 s37, s37, 4194304
    s_lshl_b32 s38, s18, 14
    s_add_u32 s38, s38, 65536
    s_waitcnt lgkmcnt(0)
    s_add_u32 m0, s38, 0
    s_add_u32 s39, s37, 0
    buffer_load_dwordx4 v40, s[12:15], s39 offen lds
    s_add_u32 m0, s38, 1024
    s_add_u32 s39, s37, 65536
    buffer_load_dwordx4 v40, s[12:15], s39 offen lds
    s_add_u32 m0, s38, 2048
    s_add_u32 s39, s37, 131072
    buffer_load_dwordx4 v40, s[12:15], s39 offen lds
    s_add_u32 m0, s38, 3072
    s_add_u32 s39, s37, 196608
    buffer_load_dwordx4 v40, s[12:15], s39 offen lds
    s_add_u32 m0, s38, 4096
    s_add_u32 s39, s37, 262144
    buffer_load_dwordx4 v40, s[12:15], s39 offen lds
    s_add_u32 m0, s38, 5120
    s_add_u32 s39, s37, 327680
    buffer_load_dwordx4 v40, s[12:15], s39 offen lds
    s_add_u32 m0, s38, 6144
    s_add_u32 s39, s37, 393216
    buffer_load_dwordx4 v40, s[12:15], s39 offen lds
    s_add_u32 m0, s38, 7168
    s_add_u32 s39, s37, 458752
    buffer_load_dwordx4 v40, s[12:15], s39 offen lds
    s_add_u32 m0, s38, 8192
    s_add_u32 s39, s37, 524288
    buffer_load_dwordx4 v40, s[12:15], s39 offen lds
    s_add_u32 m0, s38, 9216
    s_add_u32 s39, s37, 589824
    buffer_load_dwordx4 v40, s[12:15], s39 offen lds
    s_add_u32 m0, s38, 10240
    s_add_u32 s39, s37, 655360
    buffer_load_dwordx4 v40, s[12:15], s39 offen lds
    s_add_u32 m0, s38, 11264
    s_add_u32 s39, s37, 720896
    buffer_load_dwordx4 v40, s[12:15], s39 offen lds
    s_add_u32 m0, s38, 12288
    s_add_u32 s39, s37, 786432
    buffer_load_dwordx4 v40, s[12:15], s39 offen lds
    s_add_u32 m0, s38, 13312
    s_add_u32 s39, s37, 851968
    buffer_load_dwordx4 v40, s[12:15], s39 offen lds
    s_add_u32 m0, s38, 14336
    s_add_u32 s39, s37, 917504
    buffer_load_dwordx4 v40, s[12:15], s39 offen lds
    s_add_u32 m0, s38, 15360
    s_add_u32 s39, s37, 983040
    buffer_load_dwordx4 v40, s[12:15], s39 offen lds
    s_waitcnt vmcnt(16)
    s_barrier
    s_lshr_b32 s37, s18, 1
    s_cmp_lg_u32 s37, 0
    s_cbranch_scc1 rce_10
    ds_read_b64_tr_b16 a[32:33], v41 offset:0
    ds_read_b64_tr_b16 a[34:35], v41 offset:256
    ds_read_b64_tr_b16 a[36:37], v41 offset:4096
    ds_read_b64_tr_b16 a[38:39], v41 offset:4352
    ds_read_b64_tr_b16 a[40:41], v41 offset:32
    ds_read_b64_tr_b16 a[42:43], v41 offset:288
    ds_read_b64_tr_b16 a[44:45], v41 offset:4128
    ds_read_b64_tr_b16 a[46:47], v41 offset:4384
    s_waitcnt lgkmcnt(0)
    ds_read_b64_tr_b16 a[48:49], v41 offset:64
    ds_read_b64_tr_b16 a[50:51], v41 offset:320
    ds_read_b64_tr_b16 a[52:53], v41 offset:4160
    ds_read_b64_tr_b16 a[54:55], v41 offset:4416
    ds_read_b64_tr_b16 a[56:57], v41 offset:96
    ds_read_b64_tr_b16 a[58:59], v41 offset:352
    ds_read_b64_tr_b16 a[60:61], v41 offset:4192
    ds_read_b64_tr_b16 a[62:63], v41 offset:4448
    s_waitcnt lgkmcnt(0)
    ds_read_b64_tr_b16 a[128:129], v41 offset:8192
    ds_read_b64_tr_b16 a[130:131], v41 offset:8448
    ds_read_b64_tr_b16 a[132:133], v41 offset:12288
    ds_read_b64_tr_b16 a[134:135], v41 offset:12544
    ds_read_b64_tr_b16 a[136:137], v41 offset:8224
    ds_read_b64_tr_b16 a[138:139], v41 offset:8480
    ds_read_b64_tr_b16 a[140:141], v41 offset:12320
    ds_read_b64_tr_b16 a[142:143], v41 offset:12576
    s_waitcnt lgkmcnt(0)
    ds_read_b64_tr_b16 a[144:145], v41 offset:8256
    ds_read_b64_tr_b16 a[146:147], v41 offset:8512
    ds_read_b64_tr_b16 a[148:149], v41 offset:12352
    ds_read_b64_tr_b16 a[150:151], v41 offset:12608
    ds_read_b64_tr_b16 a[152:153], v41 offset:8288
    ds_read_b64_tr_b16 a[154:155], v41 offset:8544
    ds_read_b64_tr_b16 a[156:157], v41 offset:12384
    ds_read_b64_tr_b16 a[158:159], v41 offset:12640
    s_waitcnt lgkmcnt(0)
    ds_read_b64_tr_b16 a[224:225], v41 offset:16384
    ds_read_b64_tr_b16 a[226:227], v41 offset:16640
    ds_read_b64_tr_b16 a[228:229], v41 offset:20480
    ds_read_b64_tr_b16 a[230:231], v41 offset:20736
    ds_read_b64_tr_b16 a[232:233], v41 offset:16416
    ds_read_b64_tr_b16 a[234:235], v41 offset:16672
    ds_read_b64_tr_b16 a[236:237], v41 offset:20512
    ds_read_b64_tr_b16 a[238:239], v41 offset:20768
    s_waitcnt lgkmcnt(0)
    ds_read_b64_tr_b16 a[240:241], v41 offset:16448
    ds_read_b64_tr_b16 a[242:243], v41 offset:16704
    ds_read_b64_tr_b16 a[244:245], v41 offset:20544
    ds_read_b64_tr_b16 a[246:247], v41 offset:20800
    ds_read_b64_tr_b16 a[248:249], v41 offset:16480
    ds_read_b64_tr_b16 a[250:251], v41 offset:16736
    ds_read_b64_tr_b16 a[252:253], v41 offset:20576
    ds_read_b64_tr_b16 a[254:255], v41 offset:20832
    s_waitcnt lgkmcnt(0)
    ds_read_b64_tr_b16 v[192:193], v41 offset:24576
    ds_read_b64_tr_b16 v[194:195], v41 offset:24832
    ds_read_b64_tr_b16 v[196:197], v41 offset:28672
    ds_read_b64_tr_b16 v[198:199], v41 offset:28928
    ds_read_b64_tr_b16 v[200:201], v41 offset:24608
    ds_read_b64_tr_b16 v[202:203], v41 offset:24864
    ds_read_b64_tr_b16 v[204:205], v41 offset:28704
    ds_read_b64_tr_b16 v[206:207], v41 offset:28960
    s_waitcnt lgkmcnt(0)
    ds_read_b64_tr_b16 v[208:209], v41 offset:24640
    ds_read_b64_tr_b16 v[210:211], v41 offset:24896
    ds_read_b64_tr_b16 v[212:213], v41 offset:28736
    ds_read_b64_tr_b16 v[214:215], v41 offset:28992
    ds_read_b64_tr_b16 v[216:217], v41 offset:24672
    ds_read_b64_tr_b16 v[218:219], v41 offset:24928
    ds_read_b64_tr_b16 v[220:221], v41 offset:28768
    ds_read_b64_tr_b16 v[222:223], v41 offset:29024
    s_waitcnt lgkmcnt(0)
rce_10:
    s_waitcnt lgkmcnt(0)
    s_barrier
    s_load_dwordx2 s[12:13], s[0:1], 32
    s_mov_b32 s14, 8388608
    s_mov_b32 s15, 0x00020000
    s_lshl_b32 s37, s19, 8
    s_lshl_b32 s38, s20, 7
    s_add_u32 s37, s37, s38
    s_lshl_b32 s38, s18, 20
    s_add_u32 s37, s37, s38
    s_add_u32 s37, s37, 0
    s_lshl_b32 s38, s18, 14
    s_add_u32 s38, s38, 0
    s_waitcnt lgkmcnt(0)
    s_add_u32 m0, s38, 0
    s_add_u32 s39, s37, 0
    buffer_load_dwordx4 v40, s[12:15], s39 offen lds
    s_add_u32 m0, s38, 1024
    s_add_u32 s39, s37, 65536
    buffer_load_dwordx4 v40, s[12:15], s39 offen lds
    s_add_u32 m0, s38, 2048
    s_add_u32 s39, s37, 131072
    buffer_load_dwordx4 v40, s[12:15], s39 offen lds
    s_add_u32 m0, s38, 3072
    s_add_u32 s39, s37, 196608
    buffer_load_dwordx4 v40, s[12:15], s39 offen lds
    s_add_u32 m0, s38, 4096
    s_add_u32 s39, s37, 262144
    buffer_load_dwordx4 v40, s[12:15], s39 offen lds
    s_add_u32 m0, s38, 5120
    s_add_u32 s39, s37, 327680
    buffer_load_dwordx4 v40, s[12:15], s39 offen lds
    s_add_u32 m0, s38, 6144
    s_add_u32 s39, s37, 393216
    buffer_load_dwordx4 v40, s[12:15], s39 offen lds
    s_add_u32 m0, s38, 7168
    s_add_u32 s39, s37, 458752
    buffer_load_dwordx4 v40, s[12:15], s39 offen lds
    s_add_u32 m0, s38, 8192
    s_add_u32 s39, s37, 524288
    buffer_load_dwordx4 v40, s[12:15], s39 offen lds
    s_add_u32 m0, s38, 9216
    s_add_u32 s39, s37, 589824
    buffer_load_dwordx4 v40, s[12:15], s39 offen lds
    s_add_u32 m0, s38, 10240
    s_add_u32 s39, s37, 655360
    buffer_load_dwordx4 v40, s[12:15], s39 offen lds
    s_add_u32 m0, s38, 11264
    s_add_u32 s39, s37, 720896
    buffer_load_dwordx4 v40, s[12:15], s39 offen lds
    s_add_u32 m0, s38, 12288
    s_add_u32 s39, s37, 786432
    buffer_load_dwordx4 v40, s[12:15], s39 offen lds
    s_add_u32 m0, s38, 13312
    s_add_u32 s39, s37, 851968
    buffer_load_dwordx4 v40, s[12:15], s39 offen lds
    s_add_u32 m0, s38, 14336
    s_add_u32 s39, s37, 917504
    buffer_load_dwordx4 v40, s[12:15], s39 offen lds
    s_add_u32 m0, s38, 15360
    s_add_u32 s39, s37, 983040
    buffer_load_dwordx4 v40, s[12:15], s39 offen lds
    s_waitcnt vmcnt(16)
    s_barrier
    s_lshr_b32 s37, s18, 1
    s_cmp_lg_u32 s37, 1
    s_cbranch_scc1 rce_11
    ds_read_b64_tr_b16 a[32:33], v42 offset:0
    ds_read_b64_tr_b16 a[34:35], v42 offset:256
    ds_read_b64_tr_b16 a[36:37], v42 offset:4096
    ds_read_b64_tr_b16 a[38:39], v42 offset:4352
    ds_read_b64_tr_b16 a[40:41], v42 offset:32
    ds_read_b64_tr_b16 a[42:43], v42 offset:288
    ds_read_b64_tr_b16 a[44:45], v42 offset:4128
    ds_read_b64_tr_b16 a[46:47], v42 offset:4384
    s_waitcnt lgkmcnt(0)
    ds_read_b64_tr_b16 a[48:49], v42 offset:64
    ds_read_b64_tr_b16 a[50:51], v42 offset:320
    ds_read_b64_tr_b16 a[52:53], v42 offset:4160
    ds_read_b64_tr_b16 a[54:55], v42 offset:4416
    ds_read_b64_tr_b16 a[56:57], v42 offset:96
    ds_read_b64_tr_b16 a[58:59], v42 offset:352
    ds_read_b64_tr_b16 a[60:61], v42 offset:4192
    ds_read_b64_tr_b16 a[62:63], v42 offset:4448
    s_waitcnt lgkmcnt(0)
    ds_read_b64_tr_b16 a[128:129], v42 offset:8192
    ds_read_b64_tr_b16 a[130:131], v42 offset:8448
    ds_read_b64_tr_b16 a[132:133], v42 offset:12288
    ds_read_b64_tr_b16 a[134:135], v42 offset:12544
    ds_read_b64_tr_b16 a[136:137], v42 offset:8224
    ds_read_b64_tr_b16 a[138:139], v42 offset:8480
    ds_read_b64_tr_b16 a[140:141], v42 offset:12320
    ds_read_b64_tr_b16 a[142:143], v42 offset:12576
    s_waitcnt lgkmcnt(0)
    ds_read_b64_tr_b16 a[144:145], v42 offset:8256
    ds_read_b64_tr_b16 a[146:147], v42 offset:8512
    ds_read_b64_tr_b16 a[148:149], v42 offset:12352
    ds_read_b64_tr_b16 a[150:151], v42 offset:12608
    ds_read_b64_tr_b16 a[152:153], v42 offset:8288
    ds_read_b64_tr_b16 a[154:155], v42 offset:8544
    ds_read_b64_tr_b16 a[156:157], v42 offset:12384
    ds_read_b64_tr_b16 a[158:159], v42 offset:12640
    s_waitcnt lgkmcnt(0)
    ds_read_b64_tr_b16 a[224:225], v42 offset:16384
    ds_read_b64_tr_b16 a[226:227], v42 offset:16640
    ds_read_b64_tr_b16 a[228:229], v42 offset:20480
    ds_read_b64_tr_b16 a[230:231], v42 offset:20736
    ds_read_b64_tr_b16 a[232:233], v42 offset:16416
    ds_read_b64_tr_b16 a[234:235], v42 offset:16672
    ds_read_b64_tr_b16 a[236:237], v42 offset:20512
    ds_read_b64_tr_b16 a[238:239], v42 offset:20768
    s_waitcnt lgkmcnt(0)
    ds_read_b64_tr_b16 a[240:241], v42 offset:16448
    ds_read_b64_tr_b16 a[242:243], v42 offset:16704
    ds_read_b64_tr_b16 a[244:245], v42 offset:20544
    ds_read_b64_tr_b16 a[246:247], v42 offset:20800
    ds_read_b64_tr_b16 a[248:249], v42 offset:16480
    ds_read_b64_tr_b16 a[250:251], v42 offset:16736
    ds_read_b64_tr_b16 a[252:253], v42 offset:20576
    ds_read_b64_tr_b16 a[254:255], v42 offset:20832
    s_waitcnt lgkmcnt(0)
    ds_read_b64_tr_b16 v[192:193], v42 offset:24576
    ds_read_b64_tr_b16 v[194:195], v42 offset:24832
    ds_read_b64_tr_b16 v[196:197], v42 offset:28672
    ds_read_b64_tr_b16 v[198:199], v42 offset:28928
    ds_read_b64_tr_b16 v[200:201], v42 offset:24608
    ds_read_b64_tr_b16 v[202:203], v42 offset:24864
    ds_read_b64_tr_b16 v[204:205], v42 offset:28704
    ds_read_b64_tr_b16 v[206:207], v42 offset:28960
    s_waitcnt lgkmcnt(0)
    ds_read_b64_tr_b16 v[208:209], v42 offset:24640
    ds_read_b64_tr_b16 v[210:211], v42 offset:24896
    ds_read_b64_tr_b16 v[212:213], v42 offset:28736
    ds_read_b64_tr_b16 v[214:215], v42 offset:28992
    ds_read_b64_tr_b16 v[216:217], v42 offset:24672
    ds_read_b64_tr_b16 v[218:219], v42 offset:24928
    ds_read_b64_tr_b16 v[220:221], v42 offset:28768
    ds_read_b64_tr_b16 v[222:223], v42 offset:29024
    s_waitcnt lgkmcnt(0)
rce_11:
    s_waitcnt lgkmcnt(0)
    s_barrier
    s_cmp_lg_u32 s18, 0
    s_cbranch_scc1 sg_12
    s_mov_b64 exec, 1
    v_mov_b32 v36, 1
    v_mov_b32 v37, 72
    global_atomic_add v37, v36, s[6:7] sc1
    s_mov_b64 exec, -1
sg_12:
    s_load_dwordx2 s[12:13], s[0:1], 32
    s_mov_b32 s14, 8388608
    s_mov_b32 s15, 0x00020000
    s_lshl_b32 s37, s19, 8
    s_lshl_b32 s38, s20, 7
    s_add_u32 s37, s37, s38
    s_lshl_b32 s38, s18, 20
    s_add_u32 s37, s37, s38
    s_add_u32 s37, s37, 4194304
    s_lshl_b32 s38, s18, 14
    s_add_u32 s38, s38, 65536
    s_waitcnt lgkmcnt(0)
    s_add_u32 m0, s38, 0
    s_add_u32 s39, s37, 0
    buffer_load_dwordx4 v40, s[12:15], s39 offen lds
    s_add_u32 m0, s38, 1024
    s_add_u32 s39, s37, 65536
    buffer_load_dwordx4 v40, s[12:15], s39 offen lds
    s_add_u32 m0, s38, 2048
    s_add_u32 s39, s37, 131072
    buffer_load_dwordx4 v40, s[12:15], s39 offen lds
    s_add_u32 m0, s38, 3072
    s_add_u32 s39, s37, 196608
    buffer_load_dwordx4 v40, s[12:15], s39 offen lds
    s_add_u32 m0, s38, 4096
    s_add_u32 s39, s37, 262144
    buffer_load_dwordx4 v40, s[12:15], s39 offen lds
    s_add_u32 m0, s38, 5120
    s_add_u32 s39, s37, 327680
    buffer_load_dwordx4 v40, s[12:15], s39 offen lds
    s_add_u32 m0, s38, 6144
    s_add_u32 s39, s37, 393216
    buffer_load_dwordx4 v40, s[12:15], s39 offen lds
    s_add_u32 m0, s38, 7168
    s_add_u32 s39, s37, 458752
    buffer_load_dwordx4 v40, s[12:15], s39 offen lds
    s_add_u32 m0, s38, 8192
    s_add_u32 s39, s37, 524288
    buffer_load_dwordx4 v40, s[12:15], s39 offen lds
    s_add_u32 m0, s38, 9216
    s_add_u32 s39, s37, 589824
    buffer_load_dwordx4 v40, s[12:15], s39 offen lds
    s_add_u32 m0, s38, 10240
    s_add_u32 s39, s37, 655360
    buffer_load_dwordx4 v40, s[12:15], s39 offen lds
    s_add_u32 m0, s38, 11264
    s_add_u32 s39, s37, 720896
    buffer_load_dwordx4 v40, s[12:15], s39 offen lds
    s_add_u32 m0, s38, 12288
    s_add_u32 s39, s37, 786432
    buffer_load_dwordx4 v40, s[12:15], s39 offen lds
    s_add_u32 m0, s38, 13312
    s_add_u32 s39, s37, 851968
    buffer_load_dwordx4 v40, s[12:15], s39 offen lds
    s_add_u32 m0, s38, 14336
    s_add_u32 s39, s37, 917504
    buffer_load_dwordx4 v40, s[12:15], s39 offen lds
    s_add_u32 m0, s38, 15360
    s_add_u32 s39, s37, 983040
    buffer_load_dwordx4 v40, s[12:15], s39 offen lds
    s_waitcnt vmcnt(16)
    s_barrier
    s_lshr_b32 s37, s18, 1
    s_cmp_lg_u32 s37, 0
    s_cbranch_scc1 rce_13
    ds_read_b64_tr_b16 a[64:65], v41 offset:0
    ds_read_b64_tr_b16 a[66:67], v41 offset:256
    ds_read_b64_tr_b16 a[68:69], v41 offset:4096
    ds_read_b64_tr_b16 a[70:71], v41 offset:4352
    ds_read_b64_tr_b16 a[72:73], v41 offset:32
    ds_read_b64_tr_b16 a[74:75], v41 offset:288
    ds_read_b64_tr_b16 a[76:77], v41 offset:4128
    ds_read_b64_tr_b16 a[78:79], v41 offset:4384
    s_waitcnt lgkmcnt(0)
    ds_read_b64_tr_b16 a[80:81], v41 offset:64
    ds_read_b64_tr_b16 a[82:83], v41 offset:320
    ds_read_b64_tr_b16 a[84:85], v41 offset:4160
    ds_read_b64_tr_b16 a[86:87], v41 offset:4416
    ds_read_b64_tr_b16 a[88:89], v41 offset:96
    ds_read_b64_tr_b16 a[90:91], v41 offset:352
    ds_read_b64_tr_b16 a[92:93], v41 offset:4192
    ds_read_b64_tr_b16 a[94:95], v41 offset:4448
    s_waitcnt lgkmcnt(0)
    ds_read_b64_tr_b16 a[160:161], v41 offset:8192
    ds_read_b64_tr_b16 a[162:163], v41 offset:8448
    ds_read_b64_tr_b16 a[164:165], v41 offset:12288
    ds_read_b64_tr_b16 a[166:167], v41 offset:12544
    ds_read_b64_tr_b16 a[168:169], v41 offset:8224
    ds_read_b64_tr_b16 a[170:171], v41 offset:8480
    ds_read_b64_tr_b16 a[172:173], v41 offset:12320
    ds_read_b64_tr_b16 a[174:175], v41 offset:12576
    s_waitcnt lgkmcnt(0)
    ds_read_b64_tr_b16 a[176:177], v41 offset:8256
    ds_read_b64_tr_b16 a[178:179], v41 offset:8512
    ds_read_b64_tr_b16 a[180:181], v41 offset:12352
    ds_read_b64_tr_b16 a[182:183], v41 offset:12608
    ds_read_b64_tr_b16 a[184:185], v41 offset:8288
    ds_read_b64_tr_b16 a[186:187], v41 offset:8544
    ds_read_b64_tr_b16 a[188:189], v41 offset:12384
    ds_read_b64_tr_b16 a[190:191], v41 offset:12640
    s_waitcnt lgkmcnt(0)
    ds_read_b64_tr_b16 v[128:129], v41 offset:16384
    ds_read_b64_tr_b16 v[130:131], v41 offset:16640
    ds_read_b64_tr_b16 v[132:133], v41 offset:20480
    ds_read_b64_tr_b16 v[134:135], v41 offset:20736
    ds_read_b64_tr_b16 v[136:137], v41 offset:16416
    ds_read_b64_tr_b16 v[138:139], v41 offset:16672
    ds_read_b64_tr_b16 v[140:141], v41 offset:20512
    ds_read_b64_tr_b16 v[142:143], v41 offset:20768
    s_waitcnt lgkmcnt(0)
    ds_read_b64_tr_b16 v[144:145], v41 offset:16448
    ds_read_b64_tr_b16 v[146:147], v41 offset:16704
    ds_read_b64_tr_b16 v[148:149], v41 offset:20544
    ds_read_b64_tr_b16 v[150:151], v41 offset:20800
    ds_read_b64_tr_b16 v[152:153], v41 offset:16480
    ds_read_b64_tr_b16 v[154:155], v41 offset:16736
    ds_read_b64_tr_b16 v[156:157], v41 offset:20576
    ds_read_b64_tr_b16 v[158:159], v41 offset:20832
    s_waitcnt lgkmcnt(0)
    ds_read_b64_tr_b16 v[224:225], v41 offset:24576
    ds_read_b64_tr_b16 v[226:227], v41 offset:24832
    ds_read_b64_tr_b16 v[228:229], v41 offset:28672
    ds_read_b64_tr_b16 v[230:231], v41 offset:28928
    ds_read_b64_tr_b16 v[232:233], v41 offset:24608
    ds_read_b64_tr_b16 v[234:235], v41 offset:24864
    ds_read_b64_tr_b16 v[236:237], v41 offset:28704
    ds_read_b64_tr_b16 v[238:239], v41 offset:28960
    s_waitcnt lgkmcnt(0)
    ds_read_b64_tr_b16 v[240:241], v41 offset:24640
    ds_read_b64_tr_b16 v[242:243], v41 offset:24896
    ds_read_b64_tr_b16 v[244:245], v41 offset:28736
    ds_read_b64_tr_b16 v[246:247], v41 offset:28992
    ds_read_b64_tr_b16 v[248:249], v41 offset:24672
    ds_read_b64_tr_b16 v[250:251], v41 offset:24928
    ds_read_b64_tr_b16 v[252:253], v41 offset:28768
    ds_read_b64_tr_b16 v[254:255], v41 offset:29024
    s_waitcnt lgkmcnt(0)
rce_13:
    s_waitcnt lgkmcnt(0)
    s_barrier
    s_load_dwordx2 s[12:13], s[0:1], 40
    s_mov_b32 s14, 8388608
    s_mov_b32 s15, 0x00020000
    s_lshl_b32 s37, s16, 22
    s_lshl_b32 s38, s17, 6
    s_add_u32 s37, s37, s38
    s_lshl_b32 s38, s18, 19
    s_add_u32 s37, s37, s38
    s_add_u32 s37, s37, 0
    s_lshl_b32 s38, s18, 14
    s_add_u32 s38, s38, 0
    s_waitcnt lgkmcnt(0)
    s_add_u32 m0, s38, 0
    s_add_u32 s39, s37, 0
    buffer_load_dwordx4 v43, s[12:15], s39 offen lds
    s_add_u32 m0, s38, 1024
    s_add_u32 s39, s37, 32768
    buffer_load_dwordx4 v43, s[12:15], s39 offen lds
    s_add_u32 m0, s38, 2048
    s_add_u32 s39, s37, 65536
    buffer_load_dwordx4 v43, s[12:15], s39 offen lds
    s_add_u32 m0, s38, 3072
    s_add_u32 s39, s37, 98304
    buffer_load_dwordx4 v43, s[12:15], s39 offen lds
    s_add_u32 m0, s38, 4096
    s_add_u32 s39, s37, 131072
    buffer_load_dwordx4 v43, s[12:15], s39 offen lds
    s_add_u32 m0, s38, 5120
    s_add_u32 s39, s37, 163840
    buffer_load_dwordx4 v43, s[12:15], s39 offen lds
    s_add_u32 m0, s38, 6144
    s_add_u32 s39, s37, 196608
    buffer_load_dwordx4 v43, s[12:15], s39 offen lds
    s_add_u32 m0, s38, 7168
    s_add_u32 s39, s37, 229376
    buffer_load_dwordx4 v43, s[12:15], s39 offen lds
    s_add_u32 m0, s38, 8192
    s_add_u32 s39, s37, 262144
    buffer_load_dwordx4 v43, s[12:15], s39 offen lds
    s_add_u32 m0, s38, 9216
    s_add_u32 s39, s37, 294912
    buffer_load_dwordx4 v43, s[12:15], s39 offen lds
    s_add_u32 m0, s38, 10240
    s_add_u32 s39, s37, 327680
    buffer_load_dwordx4 v43, s[12:15], s39 offen lds
    s_add_u32 m0, s38, 11264
    s_add_u32 s39, s37, 360448
    buffer_load_dwordx4 v43, s[12:15], s39 offen lds
    s_add_u32 m0, s38, 12288
    s_add_u32 s39, s37, 393216
    buffer_load_dwordx4 v43, s[12:15], s39 offen lds
    s_add_u32 m0, s38, 13312
    s_add_u32 s39, s37, 425984
    buffer_load_dwordx4 v43, s[12:15], s39 offen lds
    s_add_u32 m0, s38, 14336
    s_add_u32 s39, s37, 458752
    buffer_load_dwordx4 v43, s[12:15], s39 offen lds
    s_add_u32 m0, s38, 15360
    s_add_u32 s39, s37, 491520
    buffer_load_dwordx4 v43, s[12:15], s39 offen lds
    s_waitcnt vmcnt(16)
    s_barrier
    s_lshr_b32 s37, s18, 1
    s_cmp_lg_u32 s37, 1
    s_cbranch_scc1 rce_14
    ds_read_b64_tr_b16 a[64:65], v42 offset:0
    ds_read_b64_tr_b16 a[66:67], v42 offset:256
    ds_read_b64_tr_b16 a[68:69], v42 offset:4096
    ds_read_b64_tr_b16 a[70:71], v42 offset:4352
    ds_read_b64_tr_b16 a[72:73], v42 offset:32
    ds_read_b64_tr_b16 a[74:75], v42 offset:288
    ds_read_b64_tr_b16 a[76:77], v42 offset:4128
    ds_read_b64_tr_b16 a[78:79], v42 offset:4384
    s_waitcnt lgkmcnt(0)
    ds_read_b64_tr_b16 a[80:81], v42 offset:64
    ds_read_b64_tr_b16 a[82:83], v42 offset:320
    ds_read_b64_tr_b16 a[84:85], v42 offset:4160
    ds_read_b64_tr_b16 a[86:87], v42 offset:4416
    ds_read_b64_tr_b16 a[88:89], v42 offset:96
    ds_read_b64_tr_b16 a[90:91], v42 offset:352
    ds_read_b64_tr_b16 a[92:93], v42 offset:4192
    ds_read_b64_tr_b16 a[94:95], v42 offset:4448
    s_waitcnt lgkmcnt(0)
    ds_read_b64_tr_b16 a[160:161], v42 offset:8192
    ds_read_b64_tr_b16 a[162:163], v42 offset:8448
    ds_read_b64_tr_b16 a[164:165], v42 offset:12288
    ds_read_b64_tr_b16 a[166:167], v42 offset:12544
    ds_read_b64_tr_b16 a[168:169], v42 offset:8224
    ds_read_b64_tr_b16 a[170:171], v42 offset:8480
    ds_read_b64_tr_b16 a[172:173], v42 offset:12320
    ds_read_b64_tr_b16 a[174:175], v42 offset:12576
    s_waitcnt lgkmcnt(0)
    ds_read_b64_tr_b16 a[176:177], v42 offset:8256
    ds_read_b64_tr_b16 a[178:179], v42 offset:8512
    ds_read_b64_tr_b16 a[180:181], v42 offset:12352
    ds_read_b64_tr_b16 a[182:183], v42 offset:12608
    ds_read_b64_tr_b16 a[184:185], v42 offset:8288
    ds_read_b64_tr_b16 a[186:187], v42 offset:8544
    ds_read_b64_tr_b16 a[188:189], v42 offset:12384
    ds_read_b64_tr_b16 a[190:191], v42 offset:12640
    s_waitcnt lgkmcnt(0)
    ds_read_b64_tr_b16 v[128:129], v42 offset:16384
    ds_read_b64_tr_b16 v[130:131], v42 offset:16640
    ds_read_b64_tr_b16 v[132:133], v42 offset:20480
    ds_read_b64_tr_b16 v[134:135], v42 offset:20736
    ds_read_b64_tr_b16 v[136:137], v42 offset:16416
    ds_read_b64_tr_b16 v[138:139], v42 offset:16672
    ds_read_b64_tr_b16 v[140:141], v42 offset:20512
    ds_read_b64_tr_b16 v[142:143], v42 offset:20768
    s_waitcnt lgkmcnt(0)
    ds_read_b64_tr_b16 v[144:145], v42 offset:16448
    ds_read_b64_tr_b16 v[146:147], v42 offset:16704
    ds_read_b64_tr_b16 v[148:149], v42 offset:20544
    ds_read_b64_tr_b16 v[150:151], v42 offset:20800
    ds_read_b64_tr_b16 v[152:153], v42 offset:16480
    ds_read_b64_tr_b16 v[154:155], v42 offset:16736
    ds_read_b64_tr_b16 v[156:157], v42 offset:20576
    ds_read_b64_tr_b16 v[158:159], v42 offset:20832
    s_waitcnt lgkmcnt(0)
    ds_read_b64_tr_b16 v[224:225], v42 offset:24576
    ds_read_b64_tr_b16 v[226:227], v42 offset:24832
    ds_read_b64_tr_b16 v[228:229], v42 offset:28672
    ds_read_b64_tr_b16 v[230:231], v42 offset:28928
    ds_read_b64_tr_b16 v[232:233], v42 offset:24608
    ds_read_b64_tr_b16 v[234:235], v42 offset:24864
    ds_read_b64_tr_b16 v[236:237], v42 offset:28704
    ds_read_b64_tr_b16 v[238:239], v42 offset:28960
    s_waitcnt lgkmcnt(0)
    ds_read_b64_tr_b16 v[240:241], v42 offset:24640
    ds_read_b64_tr_b16 v[242:243], v42 offset:24896
    ds_read_b64_tr_b16 v[244:245], v42 offset:28736
    ds_read_b64_tr_b16 v[246:247], v42 offset:28992
    ds_read_b64_tr_b16 v[248:249], v42 offset:24672
    ds_read_b64_tr_b16 v[250:251], v42 offset:24928
    ds_read_b64_tr_b16 v[252:253], v42 offset:28768
    ds_read_b64_tr_b16 v[254:255], v42 offset:29024
    s_waitcnt lgkmcnt(0)
rce_14:
    s_waitcnt lgkmcnt(0)
    s_barrier
    s_load_dwordx2 s[12:13], s[0:1], 40
    s_mov_b32 s14, 8388608
    s_mov_b32 s15, 0x00020000
    s_lshl_b32 s37, s16, 22
    s_lshl_b32 s38, s17, 6
    s_add_u32 s37, s37, s38
    s_lshl_b32 s38, s18, 19
    s_add_u32 s37, s37, s38
    s_add_u32 s37, s37, 2097152
    s_lshl_b32 s38, s18, 14
    s_add_u32 s38, s38, 65536
    s_waitcnt lgkmcnt(0)
    s_add_u32 m0, s38, 0
    s_add_u32 s39, s37, 0
    buffer_load_dwordx4 v43, s[12:15], s39 offen lds
    s_add_u32 m0, s38, 1024
    s_add_u32 s39, s37, 32768
    buffer_load_dwordx4 v43, s[12:15], s39 offen lds
    s_add_u32 m0, s38, 2048
    s_add_u32 s39, s37, 65536
    buffer_load_dwordx4 v43, s[12:15], s39 offen lds
    s_add_u32 m0, s38, 3072
    s_add_u32 s39, s37, 98304
    buffer_load_dwordx4 v43, s[12:15], s39 offen lds
    s_add_u32 m0, s38, 4096
    s_add_u32 s39, s37, 131072
    buffer_load_dwordx4 v43, s[12:15], s39 offen lds
    s_add_u32 m0, s38, 5120
    s_add_u32 s39, s37, 163840
    buffer_load_dwordx4 v43, s[12:15], s39 offen lds
    s_add_u32 m0, s38, 6144
    s_add_u32 s39, s37, 196608
    buffer_load_dwordx4 v43, s[12:15], s39 offen lds
    s_add_u32 m0, s38, 7168
    s_add_u32 s39, s37, 229376
    buffer_load_dwordx4 v43, s[12:15], s39 offen lds
    s_add_u32 m0, s38, 8192
    s_add_u32 s39, s37, 262144
    buffer_load_dwordx4 v43, s[12:15], s39 offen lds
    s_add_u32 m0, s38, 9216
    s_add_u32 s39, s37, 294912
    buffer_load_dwordx4 v43, s[12:15], s39 offen lds
    s_add_u32 m0, s38, 10240
    s_add_u32 s39, s37, 327680
    buffer_load_dwordx4 v43, s[12:15], s39 offen lds
    s_add_u32 m0, s38, 11264
    s_add_u32 s39, s37, 360448
    buffer_load_dwordx4 v43, s[12:15], s39 offen lds
    s_add_u32 m0, s38, 12288
    s_add_u32 s39, s37, 393216
    buffer_load_dwordx4 v43, s[12:15], s39 offen lds
    s_add_u32 m0, s38, 13312
    s_add_u32 s39, s37, 425984
    buffer_load_dwordx4 v43, s[12:15], s39 offen lds
    s_add_u32 m0, s38, 14336
    s_add_u32 s39, s37, 458752
    buffer_load_dwordx4 v43, s[12:15], s39 offen lds
    s_add_u32 m0, s38, 15360
    s_add_u32 s39, s37, 491520
    buffer_load_dwordx4 v43, s[12:15], s39 offen lds
    s_mov_b32 s21, 0
    s_mov_b32 s41, 0
    v_mov_b32 v37, 68
zw_15:
    global_load_dword v36, v37, s[6:7] sc1
    s_add_u32 s41, s41, 1
    s_cmp_gt_u32 s41, 4194304
    s_cbranch_scc1 chain_abort
    s_waitcnt vmcnt(0)
    v_readfirstlane_b32 s37, v36
    s_nop 3
    s_cmp_lt_u32 s37, 192
    s_cbranch_scc1 zw_15
    s_lshr_b32 s37, s21, 2
    s_mul_i32 s37, s37, 384
    s_lshl_b32 s38, s19, 2
    s_add_u32 s37, s37, s38
    s_add_u32 s37, s37, 84082816
    v_mov_b32 v125, 0
    s_mov_b32 s41, 0
kv_16:
    buffer_load_dword v126, v125, s[8:11], s37 offen sc1
    buffer_load_dword v127, v125, s[8:11], s37 offen offset:128 sc1
    s_add_u32 s41, s41, 1
    s_cmp_gt_u32 s41, 4194304
    s_cbranch_scc1 chain_abort
    s_waitcnt vmcnt(0)
    v_and_b32 v126, v126, v127
    v_cmp_eq_u32 vcc, 0, v126
    s_cbranch_vccnz kv_16
kvok_17:
    s_waitcnt vmcnt(0)
    s_barrier
    ds_read_b64_tr_b16 v[48:49], v44 offset:0
    ds_read_b64_tr_b16 v[50:51], v44 offset:256
    ds_read_b64_tr_b16 v[52:53], v44 offset:2048
    ds_read_b64_tr_b16 v[54:55], v44 offset:2304
    ds_read_b64_tr_b16 v[56:57], v45 offset:0
    ds_read_b64_tr_b16 v[58:59], v45 offset:256
    ds_read_b64_tr_b16 v[60:61], v45 offset:2048
    ds_read_b64_tr_b16 v[62:63], v45 offset:2304
    s_waitcnt lgkmcnt(0)
    ds_read_b64_tr_b16 v[64:65], v44 offset:4096
    ds_read_b64_tr_b16 v[66:67], v44 offset:4352
    ds_read_b64_tr_b16 v[68:69], v44 offset:6144
    ds_read_b64_tr_b16 v[70:71], v44 offset:6400
    ds_read_b64_tr_b16 v[72:73], v45 offset:4096
    ds_read_b64_tr_b16 v[74:75], v45 offset:4352
    ds_read_b64_tr_b16 v[76:77], v45 offset:6144
    ds_read_b64_tr_b16 v[78:79], v45 offset:6400
    s_waitcnt lgkmcnt(0)
    ds_read_b64_tr_b16 v[80:81], v44 offset:8192
    ds_read_b64_tr_b16 v[82:83], v44 offset:8448
    ds_read_b64_tr_b16 v[84:85], v44 offset:10240
    ds_read_b64_tr_b16 v[86:87], v44 offset:10496
    ds_read_b64_tr_b16 v[88:89], v45 offset:8192
    ds_read_b64_tr_b16 v[90:91], v45 offset:8448
    ds_read_b64_tr_b16 v[92:93], v45 offset:10240
    ds_read_b64_tr_b16 v[94:95], v45 offset:10496
    s_waitcnt lgkmcnt(0)
    ds_read_b64_tr_b16 v[96:97], v44 offset:12288
    ds_read_b64_tr_b16 v[98:99], v44 offset:12544
    ds_read_b64_tr_b16 v[100:101], v44 offset:14336
    ds_read_b64_tr_b16 v[102:103], v44 offset:14592
    ds_read_b64_tr_b16 v[104:105], v45 offset:12288
    ds_read_b64_tr_b16 v[106:107], v45 offset:12544
    ds_read_b64_tr_b16 v[108:109], v45 offset:14336
    ds_read_b64_tr_b16 v[110:111], v45 offset:14592
    s_waitcnt lgkmcnt(0)
    ds_write_b128 v19, v[48:51] offset:0
    ds_write_b128 v19, v[52:55] offset:1024
    ds_write_b128 v19, v[56:59] offset:2048
    ds_write_b128 v19, v[60:63] offset:3072
    ds_write_b128 v19, v[64:67] offset:4096
    ds_write_b128 v19, v[68:71] offset:5120
    ds_write_b128 v19, v[72:75] offset:6144
    ds_write_b128 v19, v[76:79] offset:7168
    ds_write_b128 v19, v[80:83] offset:8192
    ds_write_b128 v19, v[84:87] offset:9216
    ds_write_b128 v19, v[88:91] offset:10240
    ds_write_b128 v19, v[92:95] offset:11264
    ds_write_b128 v19, v[96:99] offset:12288
    ds_write_b128 v19, v[100:103] offset:13312
    ds_write_b128 v19, v[104:107] offset:14336
    ds_write_b128 v19, v[108:111] offset:15360
    s_waitcnt lgkmcnt(0)
    ds_read_b64_tr_b16 v[48:49], v44 offset:16384
    ds_read_b64_tr_b16 v[50:51], v44 offset:16640
    ds_read_b64_tr_b16 v[52:53], v44 offset:18432
    ds_read_b64_tr_b16 v[54:55], v44 offset:18688
    ds_read_b64_tr_b16 v[56:57], v45 offset:16384
    ds_read_b64_tr_b16 v[58:59], v45 offset:16640
    ds_read_b64_tr_b16 v[60:61], v45 offset:18432
    ds_read_b64_tr_b16 v[62:63], v45 offset:18688
    s_waitcnt lgkmcnt(0)
    ds_read_b64_tr_b16 v[64:65], v44 offset:20480
    ds_read_b64_tr_b16 v[66:67], v44 offset:20736
    ds_read_b64_tr_b16 v[68:69], v44 offset:22528
    ds_read_b64_tr_b16 v[70:71], v44 offset:22784
    ds_read_b64_tr_b16 v[72:73], v45 offset:20480
    ds_read_b64_tr_b16 v[74:75], v45 offset:20736
    ds_read_b64_tr_b16 v[76:77], v45 offset:22528
    ds_read_b64_tr_b16 v[78:79], v45 offset:22784
    s_waitcnt lgkmcnt(0)
    ds_read_b64_tr_b16 v[80:81], v44 offset:24576
    ds_read_b64_tr_b16 v[82:83], v44 offset:24832
    ds_read_b64_tr_b16 v[84:85], v44 offset:26624
    ds_read_b64_tr_b16 v[86:87], v44 offset:26880
    ds_read_b64_tr_b16 v[88:89], v45 offset:24576
    ds_read_b64_tr_b16 v[90:91], v45 offset:24832
    ds_read_b64_tr_b16 v[92:93], v45 offset:26624
    ds_read_b64_tr_b16 v[94:95], v45 offset:26880
    s_waitcnt lgkmcnt(0)
    ds_read_b64_tr_b16 v[96:97], v44 offset:28672
    ds_read_b64_tr_b16 v[98:99], v44 offset:28928
    ds_read_b64_tr_b16 v[100:101], v44 offset:30720
    ds_read_b64_tr_b16 v[102:103], v44 offset:30976
    ds_read_b64_tr_b16 v[104:105], v45 offset:28672
    ds_read_b64_tr_b16 v[106:107], v45 offset:28928
    ds_read_b64_tr_b16 v[108:109], v45 offset:30720
    ds_read_b64_tr_b16 v[110:111], v45 offset:30976
    s_waitcnt lgkmcnt(0)
    ds_write_b128 v19, v[48:51] offset:16384
    ds_write_b128 v19, v[52:55] offset:17408
    ds_write_b128 v19, v[56:59] offset:18432
    ds_write_b128 v19, v[60:63] offset:19456
    ds_write_b128 v19, v[64:67] offset:20480
    ds_write_b128 v19, v[68:71] offset:21504
    ds_write_b128 v19, v[72:75] offset:22528
    ds_write_b128 v19, v[76:79] offset:23552
    ds_write_b128 v19, v[80:83] offset:24576
    ds_write_b128 v19, v[84:87] offset:25600
    ds_write_b128 v19, v[88:91] offset:26624
    ds_write_b128 v19, v[92:95] offset:27648
    ds_write_b128 v19, v[96:99] offset:28672
    ds_write_b128 v19, v[100:103] offset:29696
    ds_write_b128 v19, v[104:107] offset:30720
    ds_write_b128 v19, v[108:111] offset:31744
    s_waitcnt lgkmcnt(0)
    s_mov_b32 s41, 0
    v_mov_b32 v37, 64
pw_18:
    global_load_dword v36, v37, s[6:7] sc1
    s_waitcnt vmcnt(0)
    v_readfirstlane_b32 s37, v36
    s_add_u32 s41, s41, 1
    s_cmp_gt_u32 s41, 4194304
    s_cbranch_scc1 chain_abort
    s_cmp_lt_u32 s37, 256
    s_cbranch_scc1 pw_18
    s_barrier
    s_and_b32 s37, s21, 3
    s_lshl_b32 s38, s37, 14
    s_lshl_b32 s39, s18, 12
    s_add_u32 s38, s38, s39
    s_add_u32 s22, s90, s38
    s_add_u32 s29, s91, s38
    s_lshl_b32 s38, s37, 12
    s_add_u32 s25, s89, s38
    s_add_u32 s37, s21, 3
    s_and_b32 s37, s37, 3
    s_lshl_b32 s38, s37, 12
    s_add_u32 s30, s89, s38
    s_lshl_b32 s38, s18, 9
    s_add_u32 s30, s30, s38
    s_add_u32 s37, s21, 2
    s_and_b32 s37, s37, 3
    s_lshl_b32 s38, s37, 12
    s_add_u32 s26, s89, s38
    s_lshl_b32 s38, s37, 14
    s_add_u32 s24, s90, s38
    s_add_u32 s35, s24, 2097152
    s_lshl_b32 s38, s37, 15
    s_add_u32 s28, s92, s38
    s_sub_u32 s37, s21, 1
    s_lshl_b32 s38, s37, 16
    s_add_u32 s31, s86, s38
    s_add_u32 s32, s87, s38
    s_sub_u32 s37, s21, 2
    s_lshl_b32 s38, s37, 10
    s_add_u32 s33, s88, s38
    s_cmp_lt_u32 s21, 2
    s_cselect_b32 s33, 0x70000000, s33
    s_cmp_lt_u32 s21, 1
    s_cselect_b32 s31, 0x70000000, s31
    s_cselect_b32 s32, 0x70000000, s32
    s_lshl_b32 s34, s21, 18
    s_add_u32 s34, s34, s93
    s_and_b32 s37, s21, 3
    s_lshl_b32 s38, s37, 15
    s_add_u32 s27, s92, s38
    s_lshl_b32 s38, s18, 13
    s_add_u32 s36, s27, s38
    s_add_u32 s37, s21, 1
    s_and_b32 s37, s37, 3
    s_lshl_b32 s38, s37, 14
    s_add_u32 s23, s90, s38
chain_step:
    v_mov_b32 v72, 0
    v_mov_b32 v73, 0
    v_mov_b32 v74, 0
    v_mov_b32 v75, 0
    v_mov_b32 v76, 0
    v_mov_b32 v77, 0
    v_mov_b32 v78, 0
    v_mov_b32 v79, 0
    v_mov_b32 v80, 0
    v_mov_b32 v81, 0
    v_mov_b32 v82, 0
    v_mov_b32 v83, 0
    v_mov_b32 v84, 0
    v_mov_b32 v85, 0
    v_mov_b32 v86, 0
    v_mov_b32 v87, 0
    v_mov_b32 v88, 0
    v_mov_b32 v89, 0
    v_mov_b32 v90, 0
    v_mov_b32 v91, 0
    v_mov_b32 v92, 0
    v_mov_b32 v93, 0
    v_mov_b32 v94, 0
    v_mov_b32 v95, 0
    v_mov_b32 v96, 0
    v_mov_b32 v97, 0
    v_mov_b32 v98, 0
    v_mov_b32 v99, 0
    v_mov_b32 v100, 0
    v_mov_b32 v101, 0
    v_mov_b32 v102, 0
    v_mov_b32 v103, 0
    v_mov_b32 v104, 0
    v_mov_b32 v105, 0
    v_mov_b32 v106, 0
    v_mov_b32 v107, 0
    v_mov_b32 v108, 0
    v_mov_b32 v109, 0
    v_mov_b32 v110, 0
    v_mov_b32 v111, 0
    v_mov_b32 v112, 0
    v_mov_b32 v113, 0
    v_mov_b32 v114, 0
    v_mov_b32 v115, 0
    v_mov_b32 v116, 0
    v_mov_b32 v117, 0
    v_mov_b32 v118, 0
    v_mov_b32 v119, 0
    buffer_load_dwordx4 v[120:123], v9, s[8:11], s30 offen offset:2048 sc1
    v_mov_b32 v126, 1
    v_mov_b32 v127, 1
    s_and_b32 s37, s21, 3
    s_cmp_lg_u32 s37, 0
    s_cbranch_scc1 kq_19
    s_lshr_b32 s37, s21, 2
    s_mul_i32 s37, s37, 384
    s_lshl_b32 s38, s19, 2
    s_add_u32 s37, s37, s38
    s_add_u32 s37, s37, 84082816
    v_mov_b32 v125, 0
    buffer_load_dword v126, v125, s[8:11], s37 offen sc1
    buffer_load_dword v127, v125, s[8:11], s37 offen offset:128 sc1
kq_19:
    buffer_load_dwordx4 v[40:43], v0, s[8:11], s22 offen offset:0 sc1
    buffer_load_dwordx4 v[44:47], v0, s[8:11], s22 offen offset:1024 sc1
    buffer_load_dwordx4 v[48:51], v0, s[8:11], s22 offen offset:2048 sc1
    buffer_load_dwordx4 v[52:55], v0, s[8:11], s22 offen offset:3072 sc1
    s_sleep 5
    buffer_load_dwordx4 v[56:59], v0, s[8:11], s29 offen offset:0 sc1
    buffer_load_dwordx4 v[60:63], v0, s[8:11], s29 offen offset:1024 sc1
    buffer_load_dwordx4 v[64:67], v0, s[8:11], s29 offen offset:2048 sc1
    buffer_load_dwordx4 v[68:71], v0, s[8:11], s29 offen offset:3072 sc1
    s_waitcnt vmcnt(4)
    v_max3_u32 v36, v40, v44, v48
    v_max_u32 v36, v36, v52
    v_cmp_eq_u32 vcc, -1, v36
    s_cbranch_vccz p1e_20
    s_mov_b32 s41, 0
poll_21:
    buffer_load_dwordx4 v[40:43], v0, s[8:11], s22 offen offset:0 sc1
    buffer_load_dwordx4 v[44:47], v0, s[8:11], s22 offen offset:1024 sc1
    buffer_load_dwordx4 v[48:51], v0, s[8:11], s22 offen offset:2048 sc1
    buffer_load_dwordx4 v[52:55], v0, s[8:11], s22 offen offset:3072 sc1
    s_add_u32 s41, s41, 1
    s_cmp_gt_u32 s41, 4194304
    s_cbranch_scc1 chain_abort
    s_waitcnt vmcnt(0)
    v_max3_u32 v36, v40, v44, v48
    v_max_u32 v36, v36, v52
    v_cmp_eq_u32 vcc, -1, v36
    s_cbranch_vccnz poll_21
p1e_20:
    v_and_b32 v126, v126, v127
    v_cmp_eq_u32 vcc, 0, v126
    s_cbranch_vccz kvok_23
    s_lshr_b32 s37, s21, 2
    s_mul_i32 s37, s37, 384
    s_lshl_b32 s38, s19, 2
    s_add_u32 s37, s37, s38
    s_add_u32 s37, s37, 84082816
    v_mov_b32 v125, 0
    s_mov_b32 s41, 0
kv_22:
    buffer_load_dword v126, v125, s[8:11], s37 offen sc1
    buffer_load_dword v127, v125, s[8:11], s37 offen offset:128 sc1
    s_add_u32 s41, s41, 1
    s_cmp_gt_u32 s41, 4194304
    s_cbranch_scc1 chain_abort
    s_waitcnt vmcnt(0)
    v_and_b32 v126, v126, v127
    v_cmp_eq_u32 vcc, 0, v126
    s_cbranch_vccnz kv_22
kvok_23:
    s_cmp_eq_u32 s18, 0
    s_cbranch_scc1 w0p_24
    v_smfmac_f32_16x16x64_bf16 v[72:75], v[40:43], a[0:7], v12
    v_smfmac_f32_16x16x64_bf16 v[76:79], v[40:43], a[8:15], v12
    v_smfmac_f32_16x16x64_bf16 v[80:83], v[40:43], a[16:23], v12
    s_mov_b32 m0, s94
    s_nop 0
    buffer_load_dwordx4 v22, s[8:11], s34 offen sc1 lds
    v_smfmac_f32_16x16x64_bf16 v[84:87], v[40:43], a[24:31], v12
    v_smfmac_f32_16x16x64_bf16 v[88:91], v[40:43], a[32:39], v12
    v_smfmac_f32_16x16x64_bf16 v[92:95], v[40:43], a[40:47], v12
    buffer_load_dwordx4 v23, s[8:11], s34 offen offset:1024 sc1 lds
    v_smfmac_f32_16x16x64_bf16 v[96:99], v[40:43], a[48:55], v12
    v_smfmac_f32_16x16x64_bf16 v[100:103], v[40:43], a[56:63], v12
    v_smfmac_f32_16x16x64_bf16 v[104:107], v[40:43], a[64:71], v12
    buffer_load_dwordx4 v24, s[8:11], s34 offen offset:2048 sc1 lds
    v_smfmac_f32_16x16x64_bf16 v[108:111], v[40:43], a[72:79], v12
    v_smfmac_f32_16x16x64_bf16 v[112:115], v[40:43], a[80:87], v12
    v_smfmac_f32_16x16x64_bf16 v[116:119], v[40:43], a[88:95], v12
    buffer_load_dwordx4 v25, s[8:11], s34 offen offset:3072 sc1 lds
    v_smfmac_f32_16x16x64_bf16 v[72:75], v[44:47], a[96:103], v12
    v_smfmac_f32_16x16x64_bf16 v[76:79], v[44:47], a[104:111], v12
    v_smfmac_f32_16x16x64_bf16 v[80:83], v[44:47], a[112:119], v12
    buffer_store_dwordx4 v[120:123], v20, s[8:11], s31 offen sc1
    v_smfmac_f32_16x16x64_bf16 v[84:87], v[44:47], a[120:127], v12
    v_smfmac_f32_16x16x64_bf16 v[88:91], v[44:47], a[128:135], v12
    v_smfmac_f32_16x16x64_bf16 v[92:95], v[44:47], a[136:143], v12
    buffer_store_dword v32, v21, s[8:11], s32 offen sc1
    v_smfmac_f32_16x16x64_bf16 v[96:99], v[44:47], a[144:151], v12
    v_smfmac_f32_16x16x64_bf16 v[100:103], v[44:47], a[152:159], v12
    v_smfmac_f32_16x16x64_bf16 v[104:107], v[44:47], a[160:167], v12
    buffer_store_dword v34, v31, s[8:11], s33 offen sc1
    v_smfmac_f32_16x16x64_bf16 v[108:111], v[44:47], a[168:175], v12
    v_smfmac_f32_16x16x64_bf16 v[112:115], v[44:47], a[176:183], v12
    v_smfmac_f32_16x16x64_bf16 v[116:119], v[44:47], a[184:191], v12
    v_mov_b32 v124, -1
    v_mov_b32 v125, -1
    v_smfmac_f32_16x16x64_bf16 v[72:75], v[48:51], a[192:199], v12
    v_smfmac_f32_16x16x64_bf16 v[76:79], v[48:51], a[200:207], v12
    v_smfmac_f32_16x16x64_bf16 v[80:83], v[48:51], a[208:215], v12
    v_mov_b32 v126, -1
    v_mov_b32 v127, -1
    v_smfmac_f32_16x16x64_bf16 v[84:87], v[48:51], a[216:223], v12
    v_smfmac_f32_16x16x64_bf16 v[88:91], v[48:51], a[224:231], v12
    v_smfmac_f32_16x16x64_bf16 v[92:95], v[48:51], a[232:239], v12
    buffer_store_dwordx4 v[124:127], v26, s[8:11], s26 offen
    v_smfmac_f32_16x16x64_bf16 v[96:99], v[48:51], a[240:247], v12
    v_smfmac_f32_16x16x64_bf16 v[100:103], v[48:51], a[248:255], v12
    v_smfmac_f32_16x16x64_bf16 v[104:107], v[48:51], v[128:135], v12
    buffer_store_dwordx4 v[124:127], v27, s[8:11], s28 offen
    v_smfmac_f32_16x16x64_bf16 v[108:111], v[48:51], v[136:143], v12
    v_smfmac_f32_16x16x64_bf16 v[112:115], v[48:51], v[144:151], v12
    v_smfmac_f32_16x16x64_bf16 v[116:119], v[48:51], v[152:159], v12
    v_smfmac_f32_16x16x64_bf16 v[72:75], v[52:55], v[160:167], v12
    v_smfmac_f32_16x16x64_bf16 v[76:79], v[52:55], v[168:175], v12
    v_smfmac_f32_16x16x64_bf16 v[80:83], v[52:55], v[176:183], v12
    v_smfmac_f32_16x16x64_bf16 v[84:87], v[52:55], v[184:191], v12
    v_smfmac_f32_16x16x64_bf16 v[88:91], v[52:55], v[192:199], v12
    v_smfmac_f32_16x16x64_bf16 v[92:95], v[52:55], v[200:207], v12
    v_smfmac_f32_16x16x64_bf16 v[96:99], v[52:55], v[208:215], v12
    v_smfmac_f32_16x16x64_bf16 v[100:103], v[52:55], v[216:223], v12
    v_smfmac_f32_16x16x64_bf16 v[104:107], v[52:55], v[224:231], v12
    v_smfmac_f32_16x16x64_bf16 v[108:111], v[52:55], v[232:239], v12
    v_smfmac_f32_16x16x64_bf16 v[112:115], v[52:55], v[240:247], v12
    v_smfmac_f32_16x16x64_bf16 v[116:119], v[52:55], v[248:255], v12
    s_waitcnt vmcnt(9)
    s_branch w0j_25
w0p_24:
    v_smfmac_f32_16x16x64_bf16 v[72:75], v[40:43], a[0:7], v12
    v_smfmac_f32_16x16x64_bf16 v[76:79], v[40:43], a[8:15], v12
    v_smfmac_f32_16x16x64_bf16 v[80:83], v[40:43], a[16:23], v12
    buffer_store_dwordx4 v[120:123], v20, s[8:11], s31 offen sc1
    v_smfmac_f32_16x16x64_bf16 v[84:87], v[40:43], a[24:31], v12
    v_smfmac_f32_16x16x64_bf16 v[88:91], v[40:43], a[32:39], v12
    v_smfmac_f32_16x16x64_bf16 v[92:95], v[40:43], a[40:47], v12
    buffer_store_dword v32, v21, s[8:11], s32 offen sc1
    v_smfmac_f32_16x16x64_bf16 v[96:99], v[40:43], a[48:55], v12
    v_smfmac_f32_16x16x64_bf16 v[100:103], v[40:43], a[56:63], v12
    v_smfmac_f32_16x16x64_bf16 v[104:107], v[40:43], a[64:71], v12
    buffer_store_dword v34, v31, s[8:11], s33 offen sc1
    v_smfmac_f32_16x16x64_bf16 v[108:111], v[40:43], a[72:79], v12
    v_smfmac_f32_16x16x64_bf16 v[112:115], v[40:43], a[80:87], v12
    v_smfmac_f32_16x16x64_bf16 v[116:119], v[40:43], a[88:95], v12
    v_mov_b32 v124, -1
    v_mov_b32 v125, -1
    v_smfmac_f32_16x16x64_bf16 v[72:75], v[44:47], a[96:103], v12
    v_smfmac_f32_16x16x64_bf16 v[76:79], v[44:47], a[104:111], v12
    v_smfmac_f32_16x16x64_bf16 v[80:83], v[44:47], a[112:119], v12
    v_mov_b32 v126, -1
    v_mov_b32 v127, -1
    v_smfmac_f32_16x16x64_bf16 v[84:87], v[44:47], a[120:127], v12
    v_smfmac_f32_16x16x64_bf16 v[88:91], v[44:47], a[128:135], v12
    v_smfmac_f32_16x16x64_bf16 v[92:95], v[44:47], a[136:143], v12
    buffer_store_dwordx4 v[124:127], v26, s[8:11], s26 offen
    v_smfmac_f32_16x16x64_bf16 v[96:99], v[44:47], a[144:151], v12
    v_smfmac_f32_16x16x64_bf16 v[100:103], v[44:47], a[152:159], v12
    v_smfmac_f32_16x16x64_bf16 v[104:107], v[44:47], a[160:167], v12
    buffer_store_dwordx4 v[124:127], v27, s[8:11], s28 offen
    v_smfmac_f32_16x16x64_bf16 v[108:111], v[44:47], a[168:175], v12
    v_smfmac_f32_16x16x64_bf16 v[112:115], v[44:47], a[176:183], v12
    v_smfmac_f32_16x16x64_bf16 v[116:119], v[44:47], a[184:191], v12
    buffer_store_dwordx4 v[124:127], v28, s[8:11], s24 offen
    v_smfmac_f32_16x16x64_bf16 v[72:75], v[48:51], a[192:199], v12
    v_smfmac_f32_16x16x64_bf16 v[76:79], v[48:51], a[200:207], v12
    v_smfmac_f32_16x16x64_bf16 v[80:83], v[48:51], a[208:215], v12
    buffer_store_dwordx4 v[124:127], v28, s[8:11], s35 offen sc1
    v_smfmac_f32_16x16x64_bf16 v[84:87], v[48:51], a[216:223], v12
    v_smfmac_f32_16x16x64_bf16 v[88:91], v[48:51], a[224:231], v12
    v_smfmac_f32_16x16x64_bf16 v[92:95], v[48:51], a[232:239], v12
    v_smfmac_f32_16x16x64_bf16 v[96:99], v[48:51], a[240:247], v12
    v_smfmac_f32_16x16x64_bf16 v[100:103], v[48:51], a[248:255], v12
    v_smfmac_f32_16x16x64_bf16 v[104:107], v[48:51], v[128:135], v12
    v_smfmac_f32_16x16x64_bf16 v[108:111], v[48:51], v[136:143], v12
    v_smfmac_f32_16x16x64_bf16 v[112:115], v[48:51], v[144:151], v12
    v_smfmac_f32_16x16x64_bf16 v[116:119], v[48:51], v[152:159], v12
    v_smfmac_f32_16x16x64_bf16 v[72:75], v[52:55], v[160:167], v12
    v_smfmac_f32_16x16x64_bf16 v[76:79], v[52:55], v[168:175], v12
    v_smfmac_f32_16x16x64_bf16 v[80:83], v[52:55], v[176:183], v12
    v_smfmac_f32_16x16x64_bf16 v[84:87], v[52:55], v[184:191], v12
    v_smfmac_f32_16x16x64_bf16 v[88:91], v[52:55], v[192:199], v12
    v_smfmac_f32_16x16x64_bf16 v[92:95], v[52:55], v[200:207], v12
    v_smfmac_f32_16x16x64_bf16 v[96:99], v[52:55], v[208:215], v12
    v_smfmac_f32_16x16x64_bf16 v[100:103], v[52:55], v[216:223], v12
    v_smfmac_f32_16x16x64_bf16 v[104:107], v[52:55], v[224:231], v12
    v_smfmac_f32_16x16x64_bf16 v[108:111], v[52:55], v[232:239], v12
    v_smfmac_f32_16x16x64_bf16 v[112:115], v[52:55], v[240:247], v12
    v_smfmac_f32_16x16x64_bf16 v[116:119], v[52:55], v[248:255], v12
    s_waitcnt vmcnt(7)
w0j_25:
    v_max3_u32 v36, v56, v60, v64
    v_max_u32 v36, v36, v68
    v_cmp_eq_u32 vcc, -1, v36
    s_cbranch_vccz rk_26
    s_mov_b32 s41, 0
poll_27:
    buffer_load_dwordx4 v[56:59], v0, s[8:11], s29 offen offset:0 sc1
    buffer_load_dwordx4 v[60:63], v0, s[8:11], s29 offen offset:1024 sc1
    buffer_load_dwordx4 v[64:67], v0, s[8:11], s29 offen offset:2048 sc1
    buffer_load_dwordx4 v[68:71], v0, s[8:11], s29 offen offset:3072 sc1
    s_add_u32 s41, s41, 1
    s_cmp_gt_u32 s41, 4194304
    s_cbranch_scc1 chain_abort
    s_waitcnt vmcnt(0)
    v_max3_u32 v36, v56, v60, v64
    v_max_u32 v36, v36, v68
    v_cmp_eq_u32 vcc, -1, v36
    s_cbranch_vccnz poll_27
rk_26:
    s_cmp_eq_u32 s18, 1
    s_cbranch_scc1 pv1__29
    s_cmp_eq_u32 s18, 2
    s_cbranch_scc1 pv2__30
    s_cmp_eq_u32 s18, 3
    s_cbranch_scc1 pv3__31
pv0__28:
    v_smfmac_f32_16x16x64_bf16 v[76:79], v[56:59], a[8:15], v12
    v_smfmac_f32_16x16x64_bf16 v[92:95], v[56:59], a[40:47], v12
    v_smfmac_f32_16x16x64_bf16 v[76:79], v[60:63], a[104:111], v12
    v_smfmac_f32_16x16x64_bf16 v[92:95], v[60:63], a[136:143], v12
    v_smfmac_f32_16x16x64_bf16 v[76:79], v[64:67], a[200:207], v12
    v_smfmac_f32_16x16x64_bf16 v[92:95], v[64:67], a[232:239], v12
    v_smfmac_f32_16x16x64_bf16 v[76:79], v[68:71], v[168:175], v12
    v_smfmac_f32_16x16x64_bf16 v[92:95], v[68:71], v[200:207], v12
    v_smfmac_f32_16x16x64_bf16 v[80:83], v[56:59], a[16:23], v12
    v_smfmac_f32_16x16x64_bf16 v[96:99], v[56:59], a[48:55], v12
    v_smfmac_f32_16x16x64_bf16 v[80:83], v[60:63], a[112:119], v12
    v_smfmac_f32_16x16x64_bf16 v[96:99], v[60:63], a[144:151], v12
    v_smfmac_f32_16x16x64_bf16 v[80:83], v[64:67], a[208:215], v12
    v_smfmac_f32_16x16x64_bf16 v[96:99], v[64:67], a[240:247], v12
    v_smfmac_f32_16x16x64_bf16 v[80:83], v[68:71], v[176:183], v12
    v_smfmac_f32_16x16x64_bf16 v[96:99], v[68:71], v[208:215], v12
    v_pk_add_f32 v[76:77], v[76:77], v[78:79]
    v_pk_add_f32 v[78:79], v[92:93], v[94:95]
    v_smfmac_f32_16x16x64_bf16 v[84:87], v[56:59], a[24:31], v12
    ds_write_b128 v2, v[76:79]
    v_smfmac_f32_16x16x64_bf16 v[100:103], v[56:59], a[56:63], v12
    v_smfmac_f32_16x16x64_bf16 v[84:87], v[60:63], a[120:127], v12
    v_smfmac_f32_16x16x64_bf16 v[100:103], v[60:63], a[152:159], v12
    v_smfmac_f32_16x16x64_bf16 v[84:87], v[64:67], a[216:223], v12
    v_smfmac_f32_16x16x64_bf16 v[100:103], v[64:67], a[248:255], v12
    v_smfmac_f32_16x16x64_bf16 v[84:87], v[68:71], v[184:191], v12
    v_smfmac_f32_16x16x64_bf16 v[100:103], v[68:71], v[216:223], v12
    v_pk_add_f32 v[80:81], v[80:81], v[82:83]
    v_pk_add_f32 v[82:83], v[96:97], v[98:99]
    v_smfmac_f32_16x16x64_bf16 v[72:75], v[56:59], a[0:7], v12
    ds_write_b128 v3, v[80:83]
    v_smfmac_f32_16x16x64_bf16 v[88:91], v[56:59], a[32:39], v12
    v_smfmac_f32_16x16x64_bf16 v[72:75], v[60:63], a[96:103], v12
    v_smfmac_f32_16x16x64_bf16 v[88:91], v[60:63], a[128:135], v12
    v_smfmac_f32_16x16x64_bf16 v[72:75], v[64:67], a[192:199], v12
    v_smfmac_f32_16x16x64_bf16 v[88:91], v[64:67], a[224:231], v12
    v_smfmac_f32_16x16x64_bf16 v[72:75], v[68:71], v[160:167], v12
    v_smfmac_f32_16x16x64_bf16 v[88:91], v[68:71], v[192:199], v12
    v_pk_add_f32 v[84:85], v[84:85], v[86:87]
    v_pk_add_f32 v[86:87], v[100:101], v[102:103]
    ds_write_b128 v4, v[84:87]
    s_waitcnt vmcnt(5) lgkmcnt(0)
    s_barrier
    ds_read_b128 v[40:43], v5 offset:0
    ds_read_b128 v[44:47], v5 offset:1024
    ds_read_b128 v[48:51], v5 offset:2048
    s_nop 2
    v_pk_add_f32 v[72:73], v[72:73], v[74:75]
    v_pk_add_f32 v[74:75], v[88:89], v[90:91]
    s_waitcnt lgkmcnt(0)
    v_pk_add_f32 v[52:53], v[72:73], v[40:41]
    v_pk_add_f32 v[54:55], v[74:75], v[42:43]
    s_branch pvc_32
pv1__29:
    v_smfmac_f32_16x16x64_bf16 v[80:83], v[56:59], a[16:23], v12
    v_smfmac_f32_16x16x64_bf16 v[96:99], v[56:59], a[48:55], v12
    v_smfmac_f32_16x16x64_bf16 v[80:83], v[60:63], a[112:119], v12
    v_smfmac_f32_16x16x64_bf16 v[96:99], v[60:63], a[144:151], v12
    v_smfmac_f32_16x16x64_bf16 v[80:83], v[64:67], a[208:215], v12
    v_smfmac_f32_16x16x64_bf16 v[96:99], v[64:67], a[240:247], v12
    v_smfmac_f32_16x16x64_bf16 v[80:83], v[68:71], v[176:183], v12
    v_smfmac_f32_16x16x64_bf16 v[96:99], v[68:71], v[208:215], v12
    v_smfmac_f32_16x16x64_bf16 v[84:87], v[56:59], a[24:31], v12
    v_smfmac_f32_16x16x64_bf16 v[100:103], v[56:59], a[56:63], v12
    v_smfmac_f32_16x16x64_bf16 v[84:87], v[60:63], a[120:127], v12
    v_smfmac_f32_16x16x64_bf16 v[100:103], v[60:63], a[152:159], v12
    v_smfmac_f32_16x16x64_bf16 v[84:87], v[64:67], a[216:223], v12
    v_smfmac_f32_16x16x64_bf16 v[100:103], v[64:67], a[248:255], v12
    v_smfmac_f32_16x16x64_bf16 v[84:87], v[68:71], v[184:191], v12
    v_smfmac_f32_16x16x64_bf16 v[100:103], v[68:71], v[216:223], v12
    v_pk_add_f32 v[80:81], v[80:81], v[82:83]
    v_pk_add_f32 v[82:83], v[96:97], v[98:99]
    v_smfmac_f32_16x16x64_bf16 v[72:75], v[56:59], a[0:7], v12
    ds_write_b128 v3, v[80:83]
    v_smfmac_f32_16x16x64_bf16 v[88:91], v[56:59], a[32:39], v12
    v_smfmac_f32_16x16x64_bf16 v[72:75], v[60:63], a[96:103], v12
    v_smfmac_f32_16x16x64_bf16 v[88:91], v[60:63], a[128:135], v12
    v_smfmac_f32_16x16x64_bf16 v[72:75], v[64:67], a[192:199], v12
    v_smfmac_f32_16x16x64_bf16 v[88:91], v[64:67], a[224:231], v12
    v_smfmac_f32_16x16x64_bf16 v[72:75], v[68:71], v[160:167], v12
    v_smfmac_f32_16x16x64_bf16 v[88:91], v[68:71], v[192:199], v12
    v_pk_add_f32 v[84:85], v[84:85], v[86:87]
    v_pk_add_f32 v[86:87], v[100:101], v[102:103]
    v_smfmac_f32_16x16x64_bf16 v[76:79], v[56:59], a[8:15], v12
    ds_write_b128 v4, v[84:87]
    v_smfmac_f32_16x16x64_bf16 v[92:95], v[56:59], a[40:47], v12
    v_smfmac_f32_16x16x64_bf16 v[76:79], v[60:63], a[104:111], v12
    v_smfmac_f32_16x16x64_bf16 v[92:95], v[60:63], a[136:143], v12
    v_smfmac_f32_16x16x64_bf16 v[76:79], v[64:67], a[200:207], v12
    v_smfmac_f32_16x16x64_bf16 v[92:95], v[64:67], a[232:239], v12
    v_smfmac_f32_16x16x64_bf16 v[76:79], v[68:71], v[168:175], v12
    v_smfmac_f32_16x16x64_bf16 v[92:95], v[68:71], v[200:207], v12
    v_pk_add_f32 v[72:73], v[72:73], v[74:75]
    v_pk_add_f32 v[74:75], v[88:89], v[90:91]
    ds_write_b128 v1, v[72:75]
    s_waitcnt vmcnt(5) lgkmcnt(0)
    s_barrier
    ds_read_b128 v[40:43], v5 offset:0
    ds_read_b128 v[44:47], v5 offset:1024
    ds_read_b128 v[48:51], v5 offset:2048
    s_nop 2
    v_pk_add_f32 v[76:77], v[76:77], v[78:79]
    v_pk_add_f32 v[78:79], v[92:93], v[94:95]
    s_waitcnt lgkmcnt(0)
    v_pk_add_f32 v[52:53], v[76:77], v[40:41]
    v_pk_add_f32 v[54:55], v[78:79], v[42:43]
    s_branch pvc_32
pv2__30:
    v_smfmac_f32_16x16x64_bf16 v[84:87], v[56:59], a[24:31], v12
    v_smfmac_f32_16x16x64_bf16 v[100:103], v[56:59], a[56:63], v12
    v_smfmac_f32_16x16x64_bf16 v[84:87], v[60:63], a[120:127], v12
    v_smfmac_f32_16x16x64_bf16 v[100:103], v[60:63], a[152:159], v12
    v_smfmac_f32_16x16x64_bf16 v[84:87], v[64:67], a[216:223], v12
    v_smfmac_f32_16x16x64_bf16 v[100:103], v[64:67], a[248:255], v12
    v_smfmac_f32_16x16x64_bf16 v[84:87], v[68:71], v[184:191], v12
    v_smfmac_f32_16x16x64_bf16 v[100:103], v[68:71], v[216:223], v12
    v_smfmac_f32_16x16x64_bf16 v[72:75], v[56:59], a[0:7], v12
    v_smfmac_f32_16x16x64_bf16 v[88:91], v[56:59], a[32:39], v12
    v_smfmac_f32_16x16x64_bf16 v[72:75], v[60:63], a[96:103], v12
    v_smfmac_f32_16x16x64_bf16 v[88:91], v[60:63], a[128:135], v12
    v_smfmac_f32_16x16x64_bf16 v[72:75], v[64:67], a[192:199], v12
    v_smfmac_f32_16x16x64_bf16 v[88:91], v[64:67], a[224:231], v12
    v_smfmac_f32_16x16x64_bf16 v[72:75], v[68:71], v[160:167], v12
    v_smfmac_f32_16x16x64_bf16 v[88:91], v[68:71], v[192:199], v12
    v_pk_add_f32 v[84:85], v[84:85], v[86:87]
    v_pk_add_f32 v[86:87], v[100:101], v[102:103]
    v_smfmac_f32_16x16x64_bf16 v[76:79], v[56:59], a[8:15], v12
    ds_write_b128 v4, v[84:87]
    v_smfmac_f32_16x16x64_bf16 v[92:95], v[56:59], a[40:47], v12
    v_smfmac_f32_16x16x64_bf16 v[76:79], v[60:63], a[104:111], v12
    v_smfmac_f32_16x16x64_bf16 v[92:95], v[60:63], a[136:143], v12
    v_smfmac_f32_16x16x64_bf16 v[76:79], v[64:67], a[200:207], v12
    v_smfmac_f32_16x16x64_bf16 v[92:95], v[64:67], a[232:239], v12
    v_smfmac_f32_16x16x64_bf16 v[76:79], v[68:71], v[168:175], v12
    v_smfmac_f32_16x16x64_bf16 v[92:95], v[68:71], v[200:207], v12
    v_pk_add_f32 v[72:73], v[72:73], v[74:75]
    v_pk_add_f32 v[74:75], v[88:89], v[90:91]
    v_smfmac_f32_16x16x64_bf16 v[80:83], v[56:59], a[16:23], v12
    ds_write_b128 v1, v[72:75]
    v_smfmac_f32_16x16x64_bf16 v[96:99], v[56:59], a[48:55], v12
    v_smfmac_f32_16x16x64_bf16 v[80:83], v[60:63], a[112:119], v12
    v_smfmac_f32_16x16x64_bf16 v[96:99], v[60:63], a[144:151], v12
    v_smfmac_f32_16x16x64_bf16 v[80:83], v[64:67], a[208:215], v12
    v_smfmac_f32_16x16x64_bf16 v[96:99], v[64:67], a[240:247], v12
    v_smfmac_f32_16x16x64_bf16 v[80:83], v[68:71], v[176:183], v12
    v_smfmac_f32_16x16x64_bf16 v[96:99], v[68:71], v[208:215], v12
    v_pk_add_f32 v[76:77], v[76:77], v[78:79]
    v_pk_add_f32 v[78:79], v[92:93], v[94:95]
    ds_write_b128 v2, v[76:79]
    s_waitcnt vmcnt(5) lgkmcnt(0)
    s_barrier
    ds_read_b128 v[40:43], v5 offset:0
    ds_read_b128 v[44:47], v5 offset:1024
    ds_read_b128 v[48:51], v5 offset:2048
    s_nop 2
    v_pk_add_f32 v[80:81], v[80:81], v[82:83]
    v_pk_add_f32 v[82:83], v[96:97], v[98:99]
    s_waitcnt lgkmcnt(0)
    v_pk_add_f32 v[52:53], v[80:81], v[40:41]
    v_pk_add_f32 v[54:55], v[82:83], v[42:43]
    s_branch pvc_32
pv3__31:
    v_smfmac_f32_16x16x64_bf16 v[72:75], v[56:59], a[0:7], v12
    v_smfmac_f32_16x16x64_bf16 v[88:91], v[56:59], a[32:39], v12
    v_smfmac_f32_16x16x64_bf16 v[72:75], v[60:63], a[96:103], v12
    v_smfmac_f32_16x16x64_bf16 v[88:91], v[60:63], a[128:135], v12
    v_smfmac_f32_16x16x64_bf16 v[72:75], v[64:67], a[192:199], v12
    v_smfmac_f32_16x16x64_bf16 v[88:91], v[64:67], a[224:231], v12
    v_smfmac_f32_16x16x64_bf16 v[72:75], v[68:71], v[160:167], v12
    v_smfmac_f32_16x16x64_bf16 v[88:91], v[68:71], v[192:199], v12
    v_smfmac_f32_16x16x64_bf16 v[76:79], v[56:59], a[8:15], v12
    v_smfmac_f32_16x16x64_bf16 v[92:95], v[56:59], a[40:47], v12
    v_smfmac_f32_16x16x64_bf16 v[76:79], v[60:63], a[104:111], v12
    v_smfmac_f32_16x16x64_bf16 v[92:95], v[60:63], a[136:143], v12
    v_smfmac_f32_16x16x64_bf16 v[76:79], v[64:67], a[200:207], v12
    v_smfmac_f32_16x16x64_bf16 v[92:95], v[64:67], a[232:239], v12
    v_smfmac_f32_16x16x64_bf16 v[76:79], v[68:71], v[168:175], v12
    v_smfmac_f32_16x16x64_bf16 v[92:95], v[68:71], v[200:207], v12
    v_pk_add_f32 v[72:73], v[72:73], v[74:75]
    v_pk_add_f32 v[74:75], v[88:89], v[90:91]
    v_smfmac_f32_16x16x64_bf16 v[80:83], v[56:59], a[16:23], v12
    ds_write_b128 v1, v[72:75]
    v_smfmac_f32_16x16x64_bf16 v[96:99], v[56:59], a[48:55], v12
    v_smfmac_f32_16x16x64_bf16 v[80:83], v[60:63], a[112:119], v12
    v_smfmac_f32_16x16x64_bf16 v[96:99], v[60:63], a[144:151], v12
    v_smfmac_f32_16x16x64_bf16 v[80:83], v[64:67], a[208:215], v12
    v_smfmac_f32_16x16x64_bf16 v[96:99], v[64:67], a[240:247], v12
    v_smfmac_f32_16x16x64_bf16 v[80:83], v[68:71], v[176:183], v12
    v_smfmac_f32_16x16x64_bf16 v[96:99], v[68:71], v[208:215], v12
    v_pk_add_f32 v[76:77], v[76:77], v[78:79]
    v_pk_add_f32 v[78:79], v[92:93], v[94:95]
    v_smfmac_f32_16x16x64_bf16 v[84:87], v[56:59], a[24:31], v12
    ds_write_b128 v2, v[76:79]
    v_smfmac_f32_16x16x64_bf16 v[100:103], v[56:59], a[56:63], v12
    v_smfmac_f32_16x16x64_bf16 v[84:87], v[60:63], a[120:127], v12
    v_smfmac_f32_16x16x64_bf16 v[100:103], v[60:63], a[152:159], v12
    v_smfmac_f32_16x16x64_bf16 v[84:87], v[64:67], a[216:223], v12
    v_smfmac_f32_16x16x64_bf16 v[100:103], v[64:67], a[248:255], v12
    v_smfmac_f32_16x16x64_bf16 v[84:87], v[68:71], v[184:191], v12
    v_smfmac_f32_16x16x64_bf16 v[100:103], v[68:71], v[216:223], v12
    v_pk_add_f32 v[80:81], v[80:81], v[82:83]
    v_pk_add_f32 v[82:83], v[96:97], v[98:99]
    ds_write_b128 v3, v[80:83]
    s_waitcnt vmcnt(5) lgkmcnt(0)
    s_barrier
    ds_read_b128 v[40:43], v5 offset:0
    ds_read_b128 v[44:47], v5 offset:1024
    ds_read_b128 v[48:51], v5 offset:2048
    s_nop 2
    v_pk_add_f32 v[84:85], v[84:85], v[86:87]
    v_pk_add_f32 v[86:87], v[100:101], v[102:103]
    s_waitcnt lgkmcnt(0)
    v_pk_add_f32 v[52:53], v[84:85], v[40:41]
    v_pk_add_f32 v[54:55], v[86:87], v[42:43]
pvc_32:
    v_pk_add_f32 v[44:45], v[44:45], v[48:49]
    v_pk_add_f32 v[46:47], v[46:47], v[50:51]
    v_pk_add_f32 v[52:53], v[52:53], v[44:45]
    v_pk_add_f32 v[54:55], v[54:55], v[46:47]
    v_cvt_pk_bf16_f32 v40, v52, v53
    v_cvt_pk_bf16_f32 v41, v54, v55
    v_pk_min_u16 v40, v40, s47
    v_pk_min_u16 v41, v41, s47
    buffer_store_short v40, v8, s[8:11], s25 offen
    buffer_store_short_d16_hi v40, v8, s[8:11], s25 offen offset:16
    buffer_store_short v41, v8, s[8:11], s25 offen offset:2048
    buffer_store_short_d16_hi v41, v8, s[8:11], s25 offen offset:2064
    s_lshl_b32 s38, s18, 10
    v_add_u32 v38, s38, v0
    v_add_u32 v39, 131072, v38
    ds_read_b128 v[72:75], v14 offset:0
    ds_read_b128 v[76:79], v15 offset:0
    ds_read_b128 v[80:83], v16 offset:0
    ds_read_b128 v[84:87], v17 offset:0
    ds_read_b128 v[88:91], v14 offset:4096
    ds_read_b128 v[92:95], v15 offset:4096
    ds_read_b128 v[96:99], v16 offset:4096
    ds_read_b128 v[100:103], v17 offset:4096
    v_smfmac_f32_16x16x64_bf16 v[104:107], v[56:59], a[64:71], v12
    v_smfmac_f32_16x16x64_bf16 v[108:111], v[56:59], a[72:79], v12
    v_smfmac_f32_16x16x64_bf16 v[112:115], v[56:59], a[80:87], v12
    v_smfmac_f32_16x16x64_bf16 v[116:119], v[56:59], a[88:95], v12
    v_smfmac_f32_16x16x64_bf16 v[104:107], v[60:63], a[160:167], v12
    v_smfmac_f32_16x16x64_bf16 v[108:111], v[60:63], a[168:175], v12
    v_smfmac_f32_16x16x64_bf16 v[112:115], v[60:63], a[176:183], v12
    v_smfmac_f32_16x16x64_bf16 v[116:119], v[60:63], a[184:191], v12
    v_smfmac_f32_16x16x64_bf16 v[104:107], v[64:67], v[128:135], v12
    v_smfmac_f32_16x16x64_bf16 v[108:111], v[64:67], v[136:143], v12
    v_smfmac_f32_16x16x64_bf16 v[112:115], v[64:67], v[144:151], v12
    v_smfmac_f32_16x16x64_bf16 v[116:119], v[64:67], v[152:159], v12
    v_smfmac_f32_16x16x64_bf16 v[104:107], v[68:71], v[224:231], v12
    v_smfmac_f32_16x16x64_bf16 v[108:111], v[68:71], v[232:239], v12
    v_smfmac_f32_16x16x64_bf16 v[112:115], v[68:71], v[240:247], v12
    v_smfmac_f32_16x16x64_bf16 v[116:119], v[68:71], v[248:255], v12
    buffer_load_dwordx4 v[120:123], v38, s[8:11], s25 offen sc1
    s_nop 7
    v_pk_add_f32 v[104:105], v[104:105], v[106:107]
    v_pk_add_f32 v[106:107], v[108:109], v[110:111]
    ds_write_b128 v6, v[104:107]
    v_pk_add_f32 v[112:113], v[112:113], v[114:115]
    v_pk_add_f32 v[114:115], v[116:117], v[118:119]
    ds_write_b128 v6, v[112:115] offset:1024
    ds_read_b64_tr_b16 v[116:117], v18
    ds_read_b64_tr_b16 v[118:119], v18 offset:2048
    s_waitcnt vmcnt(0)
    v_max_u32 v36, v120, v122
    v_cmp_eq_u32 vcc, -1, v36
    s_cbranch_vccz q4_33
    s_mov_b32 s41, 0
poll_34:
    buffer_load_dwordx4 v[120:123], v38, s[8:11], s25 offen sc1
    s_add_u32 s41, s41, 1
    s_cmp_gt_u32 s41, 4194304
    s_cbranch_scc1 chain_abort
    s_waitcnt vmcnt(0)
    v_max_u32 v36, v120, v122
    v_cmp_eq_u32 vcc, -1, v36
    s_cbranch_vccnz poll_34
q4_33:
    ds_write_b128 v39, v[120:123]
    s_waitcnt lgkmcnt(0)
    s_barrier
    ds_read_b128 v[40:43], v10 offset:0
    ds_read_b128 v[56:59], v13 offset:0
    ds_read_b128 v[44:47], v10 offset:512
    ds_read_b128 v[60:63], v13 offset:512
    ds_read_b128 v[48:51], v10 offset:1024
    ds_read_b128 v[64:67], v13 offset:1024
    ds_read_b128 v[52:55], v10 offset:1536
    ds_read_b128 v[68:71], v13 offset:1536
    s_waitcnt lgkmcnt(6)
    v_mfma_f32_16x16x32_bf16 v[108:111], v[72:75], v[40:43], 0
    v_mfma_f32_16x16x32_bf16 v[112:115], v[88:91], v[40:43], 0
    v_mfma_f32_16x16x32_bf16 v[104:107], v[56:59], v[40:43], 0
    s_waitcnt lgkmcnt(4)
    v_mfma_f32_16x16x32_bf16 v[108:111], v[76:79], v[44:47], v[108:111]
    v_mfma_f32_16x16x32_bf16 v[112:115], v[92:95], v[44:47], v[112:115]
    v_mfma_f32_16x16x32_bf16 v[104:107], v[60:63], v[44:47], v[104:107]
    s_waitcnt lgkmcnt(2)
    v_mfma_f32_16x16x32_bf16 v[108:111], v[80:83], v[48:51], v[108:111]
    v_mfma_f32_16x16x32_bf16 v[112:115], v[96:99], v[48:51], v[112:115]
    v_mfma_f32_16x16x32_bf16 v[104:107], v[64:67], v[48:51], v[104:107]
    s_waitcnt lgkmcnt(0)
    v_mfma_f32_16x16x32_bf16 v[108:111], v[84:87], v[52:55], v[108:111]
    v_mfma_f32_16x16x32_bf16 v[112:115], v[100:103], v[52:55], v[112:115]
    v_mfma_f32_16x16x32_bf16 v[104:107], v[68:71], v[52:55], v[104:107]
    ds_read_b64 v[72:73], v7 offset:0
    ds_read_b64 v[74:75], v7 offset:2048
    ds_read_b64 v[76:77], v7 offset:4096
    ds_read_b64 v[78:79], v7 offset:6144
    s_nop 2
    v_max3_f32 v36, v108, v109, v110
    v_max3_f32 v37, v111, v112, v113
    v_max3_f32 v36, v36, v114, v115
    v_max3_f32 v37, v37, v104, v105
    v_max_f32 v36, v36, v37
    v_mov_b32 v37, v36
    s_nop 1
    v_permlane32_swap_b32 v36, v37
    s_nop 0
    v_max_f32 v36, v36, v37
    v_mov_b32 v37, v36
    s_nop 1
    v_permlane16_swap_b32 v36, v37
    s_nop 0
    v_max_f32 v36, v36, v37
    v_mul_f32 v36, s46, v36
    s_waitcnt lgkmcnt(0)
    v_pk_add_f32 v[72:73], v[72:73], v[74:75]
    v_pk_add_f32 v[76:77], v[76:77], v[78:79]
    v_pk_add_f32 v[72:73], v[72:73], v[76:77]
    v_cvt_pk_bf16_f32 v32, v72, v73
    s_cmp_eq_u32 s21, 63
    s_cbranch_scc1 chain_last
    v_mov_b32 v37, v36
    v_pk_fma_f32 v[108:109], v[108:109], s[56:57], v[36:37] neg_lo:[0,0,1] neg_hi:[0,0,1]
    v_pk_fma_f32 v[110:111], v[110:111], s[56:57], v[36:37] neg_lo:[0,0,1] neg_hi:[0,0,1]
    v_pk_fma_f32 v[112:113], v[112:113], s[56:57], v[36:37] neg_lo:[0,0,1] neg_hi:[0,0,1]
    v_pk_fma_f32 v[114:115], v[114:115], s[56:57], v[36:37] neg_lo:[0,0,1] neg_hi:[0,0,1]
    v_pk_fma_f32 v[104:105], v[104:105], s[56:57], v[36:37] neg_lo:[0,0,1] neg_hi:[0,0,1]
    v_exp_f32 v108, v108
    v_exp_f32 v109, v109
    v_exp_f32 v110, v110
    v_exp_f32 v111, v111
    v_exp_f32 v112, v112
    v_exp_f32 v113, v113
    v_exp_f32 v114, v114
    v_exp_f32 v115, v115
    v_exp_f32 v104, v104
    v_exp_f32 v105, v105
    v_cvt_pk_bf16_f32 v56, v108, v109
    v_cvt_pk_bf16_f32 v57, v110, v111
    v_cvt_pk_bf16_f32 v58, v112, v113
    v_cvt_pk_bf16_f32 v59, v114, v115
    v_cvt_pk_bf16_f32 v60, v104, v105
    v_mov_b32 v61, 0
    s_nop 0
    v_mfma_f32_16x16x32_bf16 v[64:67], v[116:119], v[56:59], 0
    v_mfma_f32_16x16x16_bf16 v[68:71], v[32:33], v[60:61], 0
    v_mfma_f32_16x16x16_bf16 v[120:123], v[34:35], v[56:57], 0
    v_mfma_f32_16x16x16_bf16 v[120:123], v[34:35], v[58:59], v[120:123]
    v_mfma_f32_16x16x16_bf16 v[120:123], v[34:35], v[60:61], v[120:123]
    ds_read_b128 v[96:99], v19 offset:0
    ds_read_b128 v[100:103], v19 offset:1024
    ds_read_b128 v[104:107], v19 offset:2048
    ds_read_b128 v[108:111], v19 offset:3072
    s_nop 3
    v_rcp_f32 v36, v120
    v_pk_add_f32 v[64:65], v[64:65], v[68:69]
    v_pk_add_f32 v[66:67], v[66:67], v[70:71]
    v_mul_f32 v64, v64, v36
    v_mul_f32 v65, v65, v36
    v_mul_f32 v66, v66, v36
    v_mul_f32 v67, v67, v36
    v_cvt_pk_bf16_f32 v64, v64, v65
    v_cvt_pk_bf16_f32 v65, v66, v67
    v_pk_min_u16 v64, v64, s47
    v_pk_min_u16 v65, v65, s47
    buffer_store_dwordx2 v[64:65], v11, s[8:11], s27 offen
    ds_read_b128 v[112:115], v19 offset:4096
    ds_read_b128 v[116:119], v19 offset:5120
    ds_read_b128 v[120:123], v19 offset:6144
    ds_read_b128 v[124:127], v19 offset:7168
    ds_read_b128 v[40:43], v19 offset:8192
    ds_read_b128 v[44:47], v19 offset:9216
    ds_read_b128 v[48:51], v19 offset:10240
    ds_read_b128 v[52:55], v19 offset:11264
    v_mov_b32 v56, 0
    v_mov_b32 v92, 0
    v_mov_b32 v57, 0
    v_mov_b32 v93, 0
    v_mov_b32 v58, 0
    v_mov_b32 v94, 0
    v_mov_b32 v59, 0
    v_mov_b32 v95, 0
    s_add_u32 s40, s21, 1
    s_and_b32 s37, s40, 3
    s_lshl_b32 s38, s37, 14
    s_lshl_b32 s39, s18, 12
    s_add_u32 s38, s38, s39
    s_add_u32 s22, s90, s38
    s_add_u32 s29, s91, s38
    s_lshl_b32 s38, s37, 12
    s_add_u32 s25, s89, s38
    s_add_u32 s37, s40, 3
    s_and_b32 s37, s37, 3
    s_lshl_b32 s38, s37, 12
    s_add_u32 s30, s89, s38
    s_lshl_b32 s38, s18, 9
    s_add_u32 s30, s30, s38
    s_add_u32 s37, s40, 2
    s_and_b32 s37, s37, 3
    s_lshl_b32 s38, s37, 12
    s_add_u32 s26, s89, s38
    s_lshl_b32 s38, s37, 14
    s_add_u32 s24, s90, s38
    s_add_u32 s35, s24, 2097152
    s_lshl_b32 s38, s37, 15
    s_add_u32 s28, s92, s38
    s_sub_u32 s37, s40, 1
    s_lshl_b32 s38, s37, 16
    s_add_u32 s31, s86, s38
    s_add_u32 s32, s87, s38
    s_sub_u32 s37, s40, 2
    s_lshl_b32 s38, s37, 10
    s_add_u32 s33, s88, s38
    s_cmp_lt_u32 s40, 2
    s_cselect_b32 s33, 0x70000000, s33
    s_cmp_lt_u32 s40, 1
    s_cselect_b32 s31, 0x70000000, s31
    s_cselect_b32 s32, 0x70000000, s32
    s_lshl_b32 s34, s40, 18
    s_add_u32 s34, s34, s93
    s_add_u32 s39, s36, 4096
    s_mov_b32 s41, 0
poll_35:
    buffer_load_dwordx4 v[60:63], v0, s[8:11], s36 offen offset:0 sc1
    buffer_load_dwordx4 v[64:67], v0, s[8:11], s36 offen offset:1024 sc1
    buffer_load_dwordx4 v[68:71], v0, s[8:11], s36 offen offset:2048 sc1
    buffer_load_dwordx4 v[72:75], v0, s[8:11], s36 offen offset:3072 sc1
    buffer_load_dwordx4 v[76:79], v0, s[8:11], s39 offen offset:0 sc1
    buffer_load_dwordx4 v[80:83], v0, s[8:11], s39 offen offset:1024 sc1
    buffer_load_dwordx4 v[84:87], v0, s[8:11], s39 offen offset:2048 sc1
    buffer_load_dwordx4 v[88:91], v0, s[8:11], s39 offen offset:3072 sc1
    s_add_u32 s41, s41, 1
    s_cmp_gt_u32 s41, 4194304
    s_cbranch_scc1 chain_abort
    s_waitcnt vmcnt(0)
    v_max3_u32 v36, v60, v62, v64
    v_max3_u32 v36, v36, v66, v68
    v_max3_u32 v36, v36, v70, v72
    v_max3_u32 v36, v36, v74, v76
    v_max3_u32 v36, v36, v78, v80
    v_max3_u32 v36, v36, v82, v84
    v_max3_u32 v36, v36, v86, v88
    v_max_u32 v36, v36, v90
    v_cmp_eq_u32 vcc, -1, v36
    s_cbranch_vccnz poll_35
    s_waitcnt lgkmcnt(0)
    v_smfmac_f32_16x16x64_bf16 v[56:59], v[60:63], v[96:103], v12
    ds_read_b128 v[96:99], v19 offset:12288
    ds_read_b128 v[100:103], v19 offset:13312
    v_smfmac_f32_16x16x64_bf16 v[92:95], v[60:63], v[104:111], v12
    ds_read_b128 v[104:107], v19 offset:14336
    ds_read_b128 v[108:111], v19 offset:15360
    v_smfmac_f32_16x16x64_bf16 v[56:59], v[64:67], v[112:119], v12
    ds_read_b128 v[112:115], v19 offset:16384
    ds_read_b128 v[116:119], v19 offset:17408
    v_smfmac_f32_16x16x64_bf16 v[92:95], v[64:67], v[120:127], v12
    ds_read_b128 v[120:123], v19 offset:18432
    ds_read_b128 v[124:127], v19 offset:19456
    v_smfmac_f32_16x16x64_bf16 v[56:59], v[68:71], v[40:47], v12
    ds_read_b128 v[40:43], v19 offset:20480
    ds_read_b128 v[44:47], v19 offset:21504
    v_smfmac_f32_16x16x64_bf16 v[92:95], v[68:71], v[48:55], v12
    ds_read_b128 v[48:51], v19 offset:22528
    ds_read_b128 v[52:55], v19 offset:23552
    s_waitcnt lgkmcnt(10)
    v_smfmac_f32_16x16x64_bf16 v[56:59], v[72:75], v[96:103], v12
    ds_read_b128 v[96:99], v19 offset:24576
    ds_read_b128 v[100:103], v19 offset:25600
    s_waitcnt lgkmcnt(10)
    v_smfmac_f32_16x16x64_bf16 v[92:95], v[72:75], v[104:111], v12
    ds_read_b128 v[104:107], v19 offset:26624
    ds_read_b128 v[108:111], v19 offset:27648
    s_waitcnt lgkmcnt(10)
    v_smfmac_f32_16x16x64_bf16 v[56:59], v[76:79], v[112:119], v12
    ds_read_b128 v[112:115], v19 offset:28672
    ds_read_b128 v[116:119], v19 offset:29696
    s_waitcnt lgkmcnt(10)
    v_smfmac_f32_16x16x64_bf16 v[92:95], v[76:79], v[120:127], v12
    ds_read_b128 v[120:123], v19 offset:30720
    ds_read_b128 v[124:127], v19 offset:31744
    s_waitcnt lgkmcnt(10)
    v_smfmac_f32_16x16x64_bf16 v[56:59], v[80:83], v[40:47], v12
    s_waitcnt lgkmcnt(8)
    v_smfmac_f32_16x16x64_bf16 v[92:95], v[80:83], v[48:55], v12
    s_waitcnt lgkmcnt(6)
    v_smfmac_f32_16x16x64_bf16 v[56:59], v[84:87], v[96:103], v12
    s_waitcnt lgkmcnt(4)
    v_smfmac_f32_16x16x64_bf16 v[92:95], v[84:87], v[104:111], v12
    s_waitcnt lgkmcnt(2)
    v_smfmac_f32_16x16x64_bf16 v[56:59], v[88:91], v[112:119], v12
    s_waitcnt lgkmcnt(0)
    v_smfmac_f32_16x16x64_bf16 v[92:95], v[88:91], v[120:127], v12
    s_nop 8
    v_pk_add_f32 v[56:57], v[56:57], v[58:59]
    v_pk_add_f32 v[92:93], v[92:93], v[94:95]
    ds_write_b32 v29, v56
    ds_write_b32 v29, v57 offset:128
    ds_write_b32 v29, v92 offset:64
    ds_write_b32 v29, v93 offset:192
    s_waitcnt lgkmcnt(0)
    s_barrier
    s_cmp_lg_u32 s18, 0
    s_cbranch_scc1 rw1_36
    ds_read_b128 v[40:43], v30 offset:0
    ds_read_b128 v[44:47], v30 offset:16
    ds_read_b128 v[48:51], v30 offset:1024
    ds_read_b128 v[52:55], v30 offset:1040
    ds_read_b128 v[56:59], v30 offset:2048
    ds_read_b128 v[60:63], v30 offset:2064
    ds_read_b128 v[64:67], v30 offset:3072
    ds_read_b128 v[68:71], v30 offset:3088
    s_waitcnt lgkmcnt(4)
    v_pk_add_f32 v[40:41], v[40:41], v[48:49]
    v_pk_add_f32 v[42:43], v[42:43], v[50:51]
    v_pk_add_f32 v[44:45], v[44:45], v[52:53]
    v_pk_add_f32 v[46:47], v[46:47], v[54:55]
    s_waitcnt lgkmcnt(2)
    v_pk_add_f32 v[40:41], v[40:41], v[56:57]
    v_pk_add_f32 v[42:43], v[42:43], v[58:59]
    v_pk_add_f32 v[44:45], v[44:45], v[60:61]
    v_pk_add_f32 v[46:47], v[46:47], v[62:63]
    s_waitcnt lgkmcnt(0)
    v_pk_add_f32 v[40:41], v[40:41], v[64:65]
    v_pk_add_f32 v[42:43], v[42:43], v[66:67]
    v_pk_add_f32 v[44:45], v[44:45], v[68:69]
    v_pk_add_f32 v[46:47], v[46:47], v[70:71]
    v_cvt_pk_bf16_f32 v48, v40, v41
    v_cvt_pk_bf16_f32 v49, v42, v43
    v_cvt_pk_bf16_f32 v50, v44, v45
    v_cvt_pk_bf16_f32 v51, v46, v47
    v_pk_min_u16 v48, v48, s47
    v_pk_min_u16 v49, v49, s47
    v_pk_min_u16 v50, v50, s47
    v_pk_min_u16 v51, v51, s47
    s_add_u32 s39, s23, 2097152
    buffer_store_dwordx4 v[48:51], v28, s[8:11], s23 offen
    buffer_store_dwordx4 v[48:51], v28, s[8:11], s39 offen sc1
rw1_36:
    s_add_u32 s40, s21, 1
    s_and_b32 s37, s40, 3
    s_lshl_b32 s38, s37, 15
    s_add_u32 s27, s92, s38
    s_lshl_b32 s38, s18, 13
    s_add_u32 s36, s27, s38
    s_add_u32 s37, s40, 1
    s_and_b32 s37, s37, 3
    s_lshl_b32 s38, s37, 14
    s_add_u32 s23, s90, s38
    s_barrier
    s_add_u32 s21, s21, 1
    s_cmp_lt_u32 s21, 64
    s_cbranch_scc1 chain_step
    s_branch chain_fin
chain_last:
    s_mov_b32 s40, 64
    s_and_b32 s37, s40, 3
    s_lshl_b32 s38, s37, 14
    s_lshl_b32 s39, s18, 12
    s_add_u32 s38, s38, s39
    s_add_u32 s22, s90, s38
    s_add_u32 s29, s91, s38
    s_lshl_b32 s38, s37, 12
    s_add_u32 s25, s89, s38
    s_add_u32 s37, s40, 3
    s_and_b32 s37, s37, 3
    s_lshl_b32 s38, s37, 12
    s_add_u32 s30, s89, s38
    s_lshl_b32 s38, s18, 9
    s_add_u32 s30, s30, s38
    s_add_u32 s37, s40, 2
    s_and_b32 s37, s37, 3
    s_lshl_b32 s38, s37, 12
    s_add_u32 s26, s89, s38
    s_lshl_b32 s38, s37, 14
    s_add_u32 s24, s90, s38
    s_add_u32 s35, s24, 2097152
    s_lshl_b32 s38, s37, 15
    s_add_u32 s28, s92, s38
    s_sub_u32 s37, s40, 1
    s_lshl_b32 s38, s37, 16
    s_add_u32 s31, s86, s38
    s_add_u32 s32, s87, s38
    s_sub_u32 s37, s40, 2
    s_lshl_b32 s38, s37, 10
    s_add_u32 s33, s88, s38
    s_cmp_lt_u32 s40, 2
    s_cselect_b32 s33, 0x70000000, s33
    s_cmp_lt_u32 s40, 1
    s_cselect_b32 s31, 0x70000000, s31
    s_cselect_b32 s32, 0x70000000, s32
    s_lshl_b32 s34, s40, 18
    s_add_u32 s34, s34, s93
chain_fin:
    buffer_load_dwordx4 v[120:123], v9, s[8:11], s30 offen offset:2048 sc1
    buffer_store_dword v34, v31, s[8:11], s33 offen sc1
    buffer_store_dword v32, v21, s[8:11], s32 offen sc1
    s_waitcnt vmcnt(2)
    buffer_store_dwordx4 v[120:123], v20, s[8:11], s31 offen sc1
    s_waitcnt vmcnt(0)
    s_add_u32 s38, s33, 1024
    buffer_store_dword v34, v31, s[8:11], s38 offen sc1
    s_waitcnt vmcnt(0)
    s_mov_b64 exec, -1
    s_branch chain_to_worker
chain_abort:
    s_mov_b64 exec, 1
    v_mov_b32 v36, 1
    v_mov_b32 v37, 128
    global_atomic_add v37, v36, s[6:7] sc1
    s_waitcnt vmcnt(0)
    s_endpgm
chain_to_worker:
    v_mbcnt_lo_u32_b32 v0, -1, 0
    v_mbcnt_hi_u32_b32 v0, -1, v0
    s_lshl_b32 s44, s18, 6
    v_add_u32 v0, s44, v0
    s_add_u32 s80, s16, 6
    s_mov_b32 s81, s17
    s_mov_b32 s82, 8
    s_mov_b32 s12, s8
    s_mov_b32 s13, s9
    s_mov_b32 s14, s10
    s_mov_b32 s15, s11
    s_mov_b32 s16, s8
    s_mov_b32 s17, s9
    s_mov_b32 s18, s10
    s_mov_b32 s19, s11
    s_mov_b32 s20, s8
    s_mov_b32 s21, s9
    s_mov_b32 s22, s10
    s_mov_b32 s23, s11
    s_mov_b32 s24, s8
    s_mov_b32 s25, s9
    s_mov_b32 s26, s10
    s_mov_b32 s27, s11
    s_mov_b32 s97, 0
    s_barrier
    s_branch streams
worker:
    s_sub_u32 s80, s16, 2
    s_mov_b32 s81, s17
    s_cmp_ge_u32 s80, 6
    s_cbranch_scc1 L_exit_main
    s_mov_b32 s82, 0
    s_mov_b32 s12, s8
    s_mov_b32 s13, s9
    s_mov_b32 s14, s10
    s_mov_b32 s15, s11
    s_mov_b32 s16, s8
    s_mov_b32 s17, s9
    s_mov_b32 s18, s10
    s_mov_b32 s19, s11
    s_mov_b32 s20, s8
    s_mov_b32 s21, s9
    s_mov_b32 s22, s10
    s_mov_b32 s23, s11
    s_mov_b32 s24, s8
    s_mov_b32 s25, s9
    s_mov_b32 s26, s10
    s_mov_b32 s27, s11
    s_mov_b32 s58, 0
    s_mov_b32 s59, 0
    s_mov_b32 s91, 0
    s_mov_b32 s97, 0
    s_lshl_b32 s85, s80, 5
    s_add_u32 s85, s85, s81
    v_mov_b32 v8, 0
    v_mov_b32 v9, 0
    v_mov_b32 v10, 0
    v_mov_b32 v11, 0
    v_lshlrev_b32 v12, 4, v0
    s_cmp_ge_u32 s85, 32
    s_cbranch_scc1 z_37
    s_lshl_b32 s44, s85, 12
    s_add_u32 s44, s44, 84017152
    buffer_store_dwordx4 v[8:11], v12, s[8:11], s44 offen sc1
z_37:
    s_cmp_lg_u32 s85, 32
    s_cbranch_scc1 z_38
    s_mov_b32 s44, 100663296
    buffer_store_dwordx4 v[8:11], v12, s[8:11], s44 offen sc1
    s_mov_b32 s44, 104861696
    buffer_store_dwordx4 v[8:11], v12, s[8:11], s44 offen sc1
z_38:
    s_waitcnt vmcnt(0)
    s_barrier
    v_cmp_eq_u32 vcc, 0, v0
    s_and_saveexec_b64 s[92:93], vcc
    s_cbranch_execz z_39
    v_mov_b32 v250, 68
    v_mov_b32 v251, 1
    global_atomic_add v250, v251, s[6:7] sc1
z_39:
    s_mov_b64 exec, s[92:93]
    s_load_dwordx2 s[24:25], s[0:1], 0
    s_mov_b32 s26, 4194304
    s_mov_b32 s27, 0x00020000
    s_waitcnt lgkmcnt(0)
    s_mov_b32 s97, s85
ln_item:
    s_lshl_b32 s55, s97, 3
    v_and_b32 v1, 63, v0
    v_lshrrev_b32 v2, 6, v0
    s_nop 0
    v_readfirstlane_b32 s41, v2
    v_lshlrev_b32 v3, 4, v1
    v_lshlrev_b32 v4, 5, v1
    s_nop 1
    s_mul_i32 s44, s41, 2
    s_add_u32 s44, s44, s55
    s_lshl_b32 s45, s44, 11
    s_add_u32 s46, s45, 0
    buffer_load_dwordx4 v[64:67], v3, s[24:27], s46 offen
    buffer_load_dwordx4 v[68:71], v3, s[24:27], s46 offen offset:1024
    s_add_u32 s46, s45, 2048
    buffer_load_dwordx4 v[72:75], v3, s[24:27], s46 offen
    buffer_load_dwordx4 v[76:79], v3, s[24:27], s46 offen offset:1024
    v_and_b32 v1, 63, v0
    v_lshrrev_b32 v2, 6, v0
    s_nop 0
    v_readfirstlane_b32 s41, v2
    v_lshlrev_b32 v3, 4, v1
    v_lshlrev_b32 v4, 5, v1
    s_nop 1
    s_mul_i32 s44, s41, 2
    s_add_u32 s44, s44, s55
    s_lshl_b32 s45, s44, 11
    s_waitcnt vmcnt(0)
    v_lshlrev_b32 v96, 16, v64
    v_and_b32 v97, 0xffff0000, v64
    v_lshlrev_b32 v98, 16, v65
    v_and_b32 v99, 0xffff0000, v65
    v_lshlrev_b32 v100, 16, v66
    v_and_b32 v101, 0xffff0000, v66
    v_lshlrev_b32 v102, 16, v67
    v_and_b32 v103, 0xffff0000, v67
    v_lshlrev_b32 v104, 16, v68
    v_and_b32 v105, 0xffff0000, v68
    v_lshlrev_b32 v106, 16, v69
    v_and_b32 v107, 0xffff0000, v69
    v_lshlrev_b32 v108, 16, v70
    v_and_b32 v109, 0xffff0000, v70
    v_lshlrev_b32 v110, 16, v71
    v_and_b32 v111, 0xffff0000, v71
    v_add_f32 v8, v96, v97
    v_add_f32 v8, v8, v98
    v_add_f32 v8, v8, v99
    v_add_f32 v8, v8, v100
    v_add_f32 v8, v8, v101
    v_add_f32 v8, v8, v102
    v_add_f32 v8, v8, v103
    v_add_f32 v8, v8, v104
    v_add_f32 v8, v8, v105
    v_add_f32 v8, v8, v106
    v_add_f32 v8, v8, v107
    v_add_f32 v8, v8, v108
    v_add_f32 v8, v8, v109
    v_add_f32 v8, v8, v110
    v_add_f32 v8, v8, v111
    s_nop 1
    v_add_f32_dpp v8, v8, v8 row_ror:8 row_mask:0xf bank_mask:0xf
    s_nop 1
    v_add_f32_dpp v8, v8, v8 row_ror:4 row_mask:0xf bank_mask:0xf
    s_nop 1
    v_add_f32_dpp v8, v8, v8 row_ror:2 row_mask:0xf bank_mask:0xf
    s_nop 1
    v_add_f32_dpp v8, v8, v8 row_ror:1 row_mask:0xf bank_mask:0xf
    v_mov_b32 v9, v8
    s_nop 1
    v_permlane16_swap_b32 v8, v9
    s_nop 0
    v_add_f32 v8, v8, v9
    v_mov_b32 v9, v8
    s_nop 1
    v_permlane32_swap_b32 v8, v9
    s_nop 0
    v_add_f32 v8, v8, v9
    v_mul_f32 v8, 0x3a800000, v8
    v_sub_f32 v11, v96, v8
    v_mul_f32 v10, v11, v11
    v_sub_f32 v11, v97, v8
    v_fmac_f32 v10, v11, v11
    v_sub_f32 v11, v98, v8
    v_fmac_f32 v10, v11, v11
    v_sub_f32 v11, v99, v8
    v_fmac_f32 v10, v11, v11
    v_sub_f32 v11, v100, v8
    v_fmac_f32 v10, v11, v11
    v_sub_f32 v11, v101, v8
    v_fmac_f32 v10, v11, v11
    v_sub_f32 v11, v102, v8
    v_fmac_f32 v10, v11, v11
    v_sub_f32 v11, v103, v8
    v_fmac_f32 v10, v11, v11
    v_sub_f32 v11, v104, v8
    v_fmac_f32 v10, v11, v11
    v_sub_f32 v11, v105, v8
    v_fmac_f32 v10, v11, v11
    v_sub_f32 v11, v106, v8
    v_fmac_f32 v10, v11, v11
    v_sub_f32 v11, v107, v8
    v_fmac_f32 v10, v11, v11
    v_sub_f32 v11, v108, v8
    v_fmac_f32 v10, v11, v11
    v_sub_f32 v11, v109, v8
    v_fmac_f32 v10, v11, v11
    v_sub_f32 v11, v110, v8
    v_fmac_f32 v10, v11, v11
    v_sub_f32 v11, v111, v8
    v_fmac_f32 v10, v11, v11
    s_nop 1
    v_add_f32_dpp v10, v10, v10 row_ror:8 row_mask:0xf bank_mask:0xf
    s_nop 1
    v_add_f32_dpp v10, v10, v10 row_ror:4 row_mask:0xf bank_mask:0xf
    s_nop 1
    v_add_f32_dpp v10, v10, v10 row_ror:2 row_mask:0xf bank_mask:0xf
    s_nop 1
    v_add_f32_dpp v10, v10, v10 row_ror:1 row_mask:0xf bank_mask:0xf
    v_mov_b32 v9, v10
    s_nop 1
    v_permlane16_swap_b32 v10, v9
    s_nop 0
    v_add_f32 v10, v10, v9
    v_mov_b32 v9, v10
    s_nop 1
    v_permlane32_swap_b32 v10, v9
    s_nop 0
    v_add_f32 v10, v10, v9
    v_mul_f32 v10, 0x3a800000, v10
    v_cvt_pk_bf16_f32 v9, v10, v10
    v_lshlrev_b32 v10, 16, v9
    v_cvt_pk_bf16_f32 v9, v8, v8
    v_lshlrev_b32 v8, 16, v9
    v_add_f32 v10, 0x3727c5ac, v10
    v_cvt_pk_bf16_f32 v9, v10, v10
    v_lshlrev_b32 v10, 16, v9
    v_sqrt_f32 v10, v10
    s_nop 0
    v_cvt_pk_bf16_f32 v9, v10, v10
    v_lshlrev_b32 v10, 16, v9
    v_rcp_f32 v10, v10
    v_sub_f32 v96, v96, v8
    v_sub_f32 v97, v97, v8
    v_sub_f32 v98, v98, v8
    v_sub_f32 v99, v99, v8
    v_sub_f32 v100, v100, v8
    v_sub_f32 v101, v101, v8
    v_sub_f32 v102, v102, v8
    v_sub_f32 v103, v103, v8
    v_sub_f32 v104, v104, v8
    v_sub_f32 v105, v105, v8
    v_sub_f32 v106, v106, v8
    v_sub_f32 v107, v107, v8
    v_sub_f32 v108, v108, v8
    v_sub_f32 v109, v109, v8
    v_sub_f32 v110, v110, v8
    v_sub_f32 v111, v111, v8
    v_cvt_pk_bf16_f32 v9, v96, v97
    v_lshlrev_b32 v96, 16, v9
    v_and_b32 v97, 0xffff0000, v9
    v_cvt_pk_bf16_f32 v9, v98, v99
    v_lshlrev_b32 v98, 16, v9
    v_and_b32 v99, 0xffff0000, v9
    v_cvt_pk_bf16_f32 v9, v100, v101
    v_lshlrev_b32 v100, 16, v9
    v_and_b32 v101, 0xffff0000, v9
    v_cvt_pk_bf16_f32 v9, v102, v103
    v_lshlrev_b32 v102, 16, v9
    v_and_b32 v103, 0xffff0000, v9
    v_cvt_pk_bf16_f32 v9, v104, v105
    v_lshlrev_b32 v104, 16, v9
    v_and_b32 v105, 0xffff0000, v9
    v_cvt_pk_bf16_f32 v9, v106, v107
    v_lshlrev_b32 v106, 16, v9
    v_and_b32 v107, 0xffff0000, v9
    v_cvt_pk_bf16_f32 v9, v108, v109
    v_lshlrev_b32 v108, 16, v9
    v_and_b32 v109, 0xffff0000, v9
    v_cvt_pk_bf16_f32 v9, v110, v111
    v_lshlrev_b32 v110, 16, v9
    v_and_b32 v111, 0xffff0000, v9
    v_mul_f32 v96, v96, v10
    v_mul_f32 v97, v97, v10
    v_mul_f32 v98, v98, v10
    v_mul_f32 v99, v99, v10
    v_mul_f32 v100, v100, v10
    v_mul_f32 v101, v101, v10
    v_mul_f32 v102, v102, v10
    v_mul_f32 v103, v103, v10
    v_mul_f32 v104, v104, v10
    v_mul_f32 v105, v105, v10
    v_mul_f32 v106, v106, v10
    v_mul_f32 v107, v107, v10
    v_mul_f32 v108, v108, v10
    v_mul_f32 v109, v109, v10
    v_mul_f32 v110, v110, v10
    v_mul_f32 v111, v111, v10
    v_cvt_pk_bf16_f32 v48, v96, v97
    v_cvt_pk_bf16_f32 v49, v98, v99
    v_cvt_pk_bf16_f32 v50, v100, v101
    v_cvt_pk_bf16_f32 v51, v102, v103
    v_cvt_pk_bf16_f32 v52, v104, v105
    v_cvt_pk_bf16_f32 v53, v106, v107
    v_cvt_pk_bf16_f32 v54, v108, v109
    v_cvt_pk_bf16_f32 v55, v110, v111
    s_add_u32 s46, s45, 0
    buffer_store_dwordx4 v[48:51], v3, s[8:11], s46 offen sc1
    buffer_store_dwordx4 v[52:55], v3, s[8:11], s46 offen offset:1024 sc1
    s_nop 1
    v_lshlrev_b32 v96, 16, v72
    v_and_b32 v97, 0xffff0000, v72
    v_lshlrev_b32 v98, 16, v73
    v_and_b32 v99, 0xffff0000, v73
    v_lshlrev_b32 v100, 16, v74
    v_and_b32 v101, 0xffff0000, v74
    v_lshlrev_b32 v102, 16, v75
    v_and_b32 v103, 0xffff0000, v75
    v_lshlrev_b32 v104, 16, v76
    v_and_b32 v105, 0xffff0000, v76
    v_lshlrev_b32 v106, 16, v77
    v_and_b32 v107, 0xffff0000, v77
    v_lshlrev_b32 v108, 16, v78
    v_and_b32 v109, 0xffff0000, v78
    v_lshlrev_b32 v110, 16, v79
    v_and_b32 v111, 0xffff0000, v79
    v_add_f32 v8, v96, v97
    v_add_f32 v8, v8, v98
    v_add_f32 v8, v8, v99
    v_add_f32 v8, v8, v100
    v_add_f32 v8, v8, v101
    v_add_f32 v8, v8, v102
    v_add_f32 v8, v8, v103
    v_add_f32 v8, v8, v104
    v_add_f32 v8, v8, v105
    v_add_f32 v8, v8, v106
    v_add_f32 v8, v8, v107
    v_add_f32 v8, v8, v108
    v_add_f32 v8, v8, v109
    v_add_f32 v8, v8, v110
    v_add_f32 v8, v8, v111
    s_nop 1
    v_add_f32_dpp v8, v8, v8 row_ror:8 row_mask:0xf bank_mask:0xf
    s_nop 1
    v_add_f32_dpp v8, v8, v8 row_ror:4 row_mask:0xf bank_mask:0xf
    s_nop 1
    v_add_f32_dpp v8, v8, v8 row_ror:2 row_mask:0xf bank_mask:0xf
    s_nop 1
    v_add_f32_dpp v8, v8, v8 row_ror:1 row_mask:0xf bank_mask:0xf
    v_mov_b32 v9, v8
    s_nop 1
    v_permlane16_swap_b32 v8, v9
    s_nop 0
    v_add_f32 v8, v8, v9
    v_mov_b32 v9, v8
    s_nop 1
    v_permlane32_swap_b32 v8, v9
    s_nop 0
    v_add_f32 v8, v8, v9
    v_mul_f32 v8, 0x3a800000, v8
    v_sub_f32 v11, v96, v8
    v_mul_f32 v10, v11, v11
    v_sub_f32 v11, v97, v8
    v_fmac_f32 v10, v11, v11
    v_sub_f32 v11, v98, v8
    v_fmac_f32 v10, v11, v11
    v_sub_f32 v11, v99, v8
    v_fmac_f32 v10, v11, v11
    v_sub_f32 v11, v100, v8
    v_fmac_f32 v10, v11, v11
    v_sub_f32 v11, v101, v8
    v_fmac_f32 v10, v11, v11
    v_sub_f32 v11, v102, v8
    v_fmac_f32 v10, v11, v11
    v_sub_f32 v11, v103, v8
    v_fmac_f32 v10, v11, v11
    v_sub_f32 v11, v104, v8
    v_fmac_f32 v10, v11, v11
    v_sub_f32 v11, v105, v8
    v_fmac_f32 v10, v11, v11
    v_sub_f32 v11, v106, v8
    v_fmac_f32 v10, v11, v11
    v_sub_f32 v11, v107, v8
    v_fmac_f32 v10, v11, v11
    v_sub_f32 v11, v108, v8
    v_fmac_f32 v10, v11, v11
    v_sub_f32 v11, v109, v8
    v_fmac_f32 v10, v11, v11
    v_sub_f32 v11, v110, v8
    v_fmac_f32 v10, v11, v11
    v_sub_f32 v11, v111, v8
    v_fmac_f32 v10, v11, v11
    s_nop 1
    v_add_f32_dpp v10, v10, v10 row_ror:8 row_mask:0xf bank_mask:0xf
    s_nop 1
    v_add_f32_dpp v10, v10, v10 row_ror:4 row_mask:0xf bank_mask:0xf
    s_nop 1
    v_add_f32_dpp v10, v10, v10 row_ror:2 row_mask:0xf bank_mask:0xf
    s_nop 1
    v_add_f32_dpp v10, v10, v10 row_ror:1 row_mask:0xf bank_mask:0xf
    v_mov_b32 v9, v10
    s_nop 1
    v_permlane16_swap_b32 v10, v9
    s_nop 0
    v_add_f32 v10, v10, v9
    v_mov_b32 v9, v10
    s_nop 1
    v_permlane32_swap_b32 v10, v9
    s_nop 0
    v_add_f32 v10, v10, v9
    v_mul_f32 v10, 0x3a800000, v10
    v_cvt_pk_bf16_f32 v9, v10, v10
    v_lshlrev_b32 v10, 16, v9
    v_cvt_pk_bf16_f32 v9, v8, v8
    v_lshlrev_b32 v8, 16, v9
    v_add_f32 v10, 0x3727c5ac, v10
    v_cvt_pk_bf16_f32 v9, v10, v10
    v_lshlrev_b32 v10, 16, v9
    v_sqrt_f32 v10, v10
    s_nop 0
    v_cvt_pk_bf16_f32 v9, v10, v10
    v_lshlrev_b32 v10, 16, v9
    v_rcp_f32 v10, v10
    v_sub_f32 v96, v96, v8
    v_sub_f32 v97, v97, v8
    v_sub_f32 v98, v98, v8
    v_sub_f32 v99, v99, v8
    v_sub_f32 v100, v100, v8
    v_sub_f32 v101, v101, v8
    v_sub_f32 v102, v102, v8
    v_sub_f32 v103, v103, v8
    v_sub_f32 v104, v104, v8
    v_sub_f32 v105, v105, v8
    v_sub_f32 v106, v106, v8
    v_sub_f32 v107, v107, v8
    v_sub_f32 v108, v108, v8
    v_sub_f32 v109, v109, v8
    v_sub_f32 v110, v110, v8
    v_sub_f32 v111, v111, v8
    v_cvt_pk_bf16_f32 v9, v96, v97
    v_lshlrev_b32 v96, 16, v9
    v_and_b32 v97, 0xffff0000, v9
    v_cvt_pk_bf16_f32 v9, v98, v99
    v_lshlrev_b32 v98, 16, v9
    v_and_b32 v99, 0xffff0000, v9
    v_cvt_pk_bf16_f32 v9, v100, v101
    v_lshlrev_b32 v100, 16, v9
    v_and_b32 v101, 0xffff0000, v9
    v_cvt_pk_bf16_f32 v9, v102, v103
    v_lshlrev_b32 v102, 16, v9
    v_and_b32 v103, 0xffff0000, v9
    v_cvt_pk_bf16_f32 v9, v104, v105
    v_lshlrev_b32 v104, 16, v9
    v_and_b32 v105, 0xffff0000, v9
    v_cvt_pk_bf16_f32 v9, v106, v107
    v_lshlrev_b32 v106, 16, v9
    v_and_b32 v107, 0xffff0000, v9
    v_cvt_pk_bf16_f32 v9, v108, v109
    v_lshlrev_b32 v108, 16, v9
    v_and_b32 v109, 0xffff0000, v9
    v_cvt_pk_bf16_f32 v9, v110, v111
    v_lshlrev_b32 v110, 16, v9
    v_and_b32 v111, 0xffff0000, v9
    v_mul_f32 v96, v96, v10
    v_mul_f32 v97, v97, v10
    v_mul_f32 v98, v98, v10
    v_mul_f32 v99, v99, v10
    v_mul_f32 v100, v100, v10
    v_mul_f32 v101, v101, v10
    v_mul_f32 v102, v102, v10
    v_mul_f32 v103, v103, v10
    v_mul_f32 v104, v104, v10
    v_mul_f32 v105, v105, v10
    v_mul_f32 v106, v106, v10
    v_mul_f32 v107, v107, v10
    v_mul_f32 v108, v108, v10
    v_mul_f32 v109, v109, v10
    v_mul_f32 v110, v110, v10
    v_mul_f32 v111, v111, v10
    v_cvt_pk_bf16_f32 v48, v96, v97
    v_cvt_pk_bf16_f32 v49, v98, v99
    v_cvt_pk_bf16_f32 v50, v100, v101
    v_cvt_pk_bf16_f32 v51, v102, v103
    v_cvt_pk_bf16_f32 v52, v104, v105
    v_cvt_pk_bf16_f32 v53, v106, v107
    v_cvt_pk_bf16_f32 v54, v108, v109
    v_cvt_pk_bf16_f32 v55, v110, v111
    s_add_u32 s46, s45, 2048
    buffer_store_dwordx4 v[48:51], v3, s[8:11], s46 offen sc1
    buffer_store_dwordx4 v[52:55], v3, s[8:11], s46 offen offset:1024 sc1
    s_nop 1
    s_mov_b32 s90, 0
    v_mov_b32 v250, 68
zw_40:
    global_load_dword v251, v250, s[6:7] sc1
    s_add_u32 s90, s90, 1
    s_cmp_gt_u32 s90, 4194304
    s_cbranch_scc1 worker_abort
    s_waitcnt vmcnt(0)
    v_readfirstlane_b32 s44, v251
    s_nop 3
    s_cmp_lt_u32 s44, 192
    s_cbranch_scc1 zw_40
    s_lshl_b32 s44, s97, 2
    s_add_u32 s83, s44, 84125824
    s_waitcnt vmcnt(0)
    s_barrier
    v_cmp_eq_u32 vcc, 0, v0
    s_and_saveexec_b64 s[92:93], vcc
    s_cbranch_execz sf_41
    v_mov_b32 v250, 0
    v_mov_b32 v251, 1
    buffer_store_dword v251, v250, s[8:11], s83 offen sc1
sf_41:
    s_mov_b64 exec, s[92:93]
    s_add_u32 s97, s97, 192
    s_cmp_lt_u32 s97, 256
    s_cbranch_scc1 ln_item
    s_mov_b32 s97, 0
    s_mov_b32 s24, s8
    s_mov_b32 s25, s9
    s_mov_b32 s26, s10
    s_mov_b32 s27, s11
qkv_next:
    s_cmp_ge_u32 s82, 8
    s_cbranch_scc1 streams
    s_lshr_b32 s94, s81, 4
    s_lshl_b32 s44, s82, 1
    s_add_u32 s94, s94, s44
    s_and_b32 s45, s81, 15
    s_cmp_lt_u32 s80, 4
    s_cselect_b32 s46, 11, 10
    s_cmp_lt_u32 s45, s46
    s_cbranch_scc0 qkv_q
    s_mul_i32 s47, s45, 6
    s_add_u32 s47, s47, s80
    s_lshr_b32 s96, s47, 5
    s_add_u32 s96, s96, 1
    s_and_b32 s95, s47, 31
    s_branch qkv_go
qkv_q:
    s_sub_u32 s47, s45, s46
    s_mul_i32 s48, s80, 5
    s_sub_u32 s49, s80, 4
    s_mul_i32 s49, s49, 6
    s_add_u32 s49, s49, 20
    s_cmp_lt_u32 s80, 4
    s_cselect_b32 s48, s48, s49
    s_add_u32 s95, s47, s48
    s_mov_b32 s96, 0
qkv_go:
    s_add_u32 s82, s82, 1
    s_lshl_b32 s44, s96, 3
    s_add_u32 s44, s44, 16
    s_load_dwordx2 s[16:17], s[0:1], s44
    s_mov_b32 s18, 8388608
    s_mov_b32 s19, 0x00020000
    s_mov_b32 s12, s8
    s_mov_b32 s13, s9
    s_mov_b32 s14, s10
    s_mov_b32 s15, s11
    s_mov_b32 s20, s8
    s_mov_b32 s21, s9
    s_mov_b32 s22, s10
    s_mov_b32 s23, s11
    s_mov_b32 s31, 2048
    s_mov_b32 s32, 8192
    s_mov_b32 s33, 8192
    s_mov_b32 s34, 16
    s_mov_b32 s51, 0
    s_mov_b32 s40, 0
    s_mul_i32 s28, s94, 262144
    s_add_u32 s28, s28, 0
    s_lshl_b32 s29, s95, 8
    s_mul_i32 s30, s94, 1048576
    s_add_u32 s30, s30, s29
    s_lshl_b32 s44, s96, 24
    s_add_u32 s30, s30, s44
    s_add_u32 s30, s30, 4194304
    s_mul_i32 s44, s94, 3
    s_add_u32 s44, s44, s96
    s_lshl_b32 s44, s44, 5
    s_add_u32 s44, s44, s95
    s_lshl_b32 s44, s44, 2
    s_add_u32 s83, s44, 84082688
    s_mov_b32 s84, 1
    s_and_b32 s75, s81, 15
    s_mov_b32 s76, 8
    s_waitcnt lgkmcnt(0)
    s_cmp_lg_u32 s82, 1
    s_cbranch_scc1 qkv_dep
    s_cmp_lt_u32 s81, 16
    s_cselect_b32 s44, 1, 0
    s_cmp_lg_u32 s96, 0
    s_cselect_b32 s44, s44, 0
    s_cmp_eq_u32 s44, 1
    s_cbranch_scc1 hs_43
    s_cmp_lt_u32 s81, 16
    s_cbranch_scc1 np_44
    s_lshl_b32 s44, s80, 4
    s_add_u32 s44, s44, s81
    s_sub_u32 s44, s44, 16
    s_lshl_b32 s44, s44, 8
    v_add_u32 v220, s44, v0
    v_lshlrev_b32 v220, 7, v220
    s_load_dwordx2 s[24:25], s[0:1], 40
    s_mov_b32 s26, 8388608
    s_mov_b32 s27, 0x00020000
    s_waitcnt lgkmcnt(0)
    v_add_u32 v221, 0, v220
    buffer_load_dword v224, v221, s[24:27], 0 offen
    v_add_u32 v221, 3145728, v220
    buffer_load_dword v225, v221, s[24:27], 0 offen
    v_add_u32 v221, 6291456, v220
    buffer_load_dword v226, v221, s[24:27], 0 offen
    s_load_dwordx2 s[24:25], s[0:1], 0
    s_mov_b32 s26, 4194304
    s_mov_b32 s27, 0x00020000
    s_waitcnt lgkmcnt(0)
np_44:
    s_mov_b32 s90, 0
    v_mov_b32 v250, 72
h_42:
    global_load_dword v251, v250, s[6:7] sc1
    s_add_u32 s90, s90, 1
    s_cmp_gt_u32 s90, 4194304
    s_cbranch_scc1 worker_abort
    s_waitcnt vmcnt(0)
    v_readfirstlane_b32 s44, v251
    s_nop 3
    s_cmp_ge_u32 s44, 64
    s_cbranch_scc1 hs_43
    s_sleep 8
    s_branch h_42
hs_43:
    v_and_b32 v1, 63, v0
    v_lshrrev_b32 v24, 6, v0
    s_nop 0
    v_readfirstlane_b32 s41, v24
    v_lshrrev_b32 v2, 4, v1
    v_and_b32 v3, 15, v1
    s_nop 1
    v_lshrrev_b32 v24, 1, v3
    v_and_b32 v27, 1, v3
    s_lshl_b32 s44, s41, 4
    v_xor_b32 v25, v24, v2
    v_lshlrev_b32 v25, 5, v25
    v_lshl_add_u32 v25, v27, 4, v25
    s_add_u32 s45, s44, 0
    v_add_u32 v26, s45, v2
    v_mul_lo_u32 v26, v26, s32
    v_add_u32 v26, v26, v25
    v_subrev_u32 v12, 0, v26
    v_xor_b32 v25, v24, v2
    v_lshlrev_b32 v25, 5, v25
    v_lshl_add_u32 v25, v27, 4, v25
    s_add_u32 s45, s44, 4
    v_add_u32 v26, s45, v2
    v_mul_lo_u32 v26, v26, s32
    v_add_u32 v26, v26, v25
    v_subrev_u32 v13, 1024, v26
    v_xor_b32 v25, v24, v2
    v_xor_b32 v25, 4, v25
    v_lshlrev_b32 v25, 5, v25
    v_lshl_add_u32 v25, v27, 4, v25
    s_add_u32 s45, s44, 8
    v_add_u32 v26, s45, v2
    v_mul_lo_u32 v26, v26, s32
    v_add_u32 v26, v26, v25
    v_subrev_u32 v14, 2048, v26
    v_xor_b32 v25, v24, v2
    v_xor_b32 v25, 4, v25
    v_lshlrev_b32 v25, 5, v25
    v_lshl_add_u32 v25, v27, 4, v25
    s_add_u32 s45, s44, 12
    v_add_u32 v26, s45, v2
    v_mul_lo_u32 v26, v26, s32
    v_add_u32 v26, v26, v25
    v_subrev_u32 v15, 3072, v26
    v_lshrrev_b32 v24, 2, v3
    v_and_b32 v25, 1, v2
    v_lshl_add_u32 v25, v25, 2, v24
    v_lshl_add_u32 v24, v2, 3, v24
    v_lshlrev_b32 v24, 8, v24
    v_and_b32 v26, 3, v3
    v_lshl_add_u32 v24, v26, 3, v24
    s_lshl_b32 s44, s41, 1
    s_add_u32 s45, s44, 0
    v_xor_b32 v26, s45, v25
    v_lshl_add_u32 v16, v26, 5, v24
    s_add_u32 s45, s44, 1
    v_xor_b32 v26, s45, v25
    v_lshl_add_u32 v17, v26, 5, v24
    s_lshl_b32 s39, s32, 6
    s_lshl_b32 s55, s41, 12
    s_mov_b32 s48, s29
    s_mov_b32 s35, 0
    v_add_u32 v18, 65536, v16
    v_add_u32 v19, 65536, v17
    s_cmp_lt_u32 s35, s34
    s_cselect_b32 s47, s48, 0x70000000
    s_add_u32 m0, s55, 0
    s_add_u32 s35, s35, 1
    buffer_load_dwordx4 v12, s[16:19], s47 offen offset:0 lds
    buffer_load_dwordx4 v13, s[16:19], s47 offen offset:1024 lds
    buffer_load_dwordx4 v14, s[16:19], s47 offen offset:2048 lds
    buffer_load_dwordx4 v15, s[16:19], s47 offen offset:3072 lds
    s_add_u32 s48, s48, s39
    s_cmp_lt_u32 s35, s34
    s_cselect_b32 s47, s48, 0x70000000
    s_add_u32 m0, s55, 16384
    s_add_u32 s35, s35, 1
    buffer_load_dwordx4 v12, s[16:19], s47 offen offset:0 lds
    buffer_load_dwordx4 v13, s[16:19], s47 offen offset:1024 lds
    buffer_load_dwordx4 v14, s[16:19], s47 offen offset:2048 lds
    buffer_load_dwordx4 v15, s[16:19], s47 offen offset:3072 lds
    s_add_u32 s48, s48, s39
    s_cmp_lt_u32 s35, s34
    s_cselect_b32 s47, s48, 0x70000000
    s_add_u32 m0, s55, 32768
    s_add_u32 s35, s35, 1
    buffer_load_dwordx4 v12, s[16:19], s47 offen offset:0 lds
    buffer_load_dwordx4 v13, s[16:19], s47 offen offset:1024 lds
    buffer_load_dwordx4 v14, s[16:19], s47 offen offset:2048 lds
    buffer_load_dwordx4 v15, s[16:19], s47 offen offset:3072 lds
    s_add_u32 s48, s48, s39
    s_cmp_lt_u32 s35, s34
    s_cselect_b32 s47, s48, 0x70000000
    s_add_u32 m0, s55, 49152
    s_add_u32 s35, s35, 1
    buffer_load_dwordx4 v12, s[16:19], s47 offen offset:0 lds
    buffer_load_dwordx4 v13, s[16:19], s47 offen offset:1024 lds
    buffer_load_dwordx4 v14, s[16:19], s47 offen offset:2048 lds
    buffer_load_dwordx4 v15, s[16:19], s47 offen offset:3072 lds
    s_add_u32 s48, s48, s39
    s_cmp_lt_u32 s35, s34
    s_cselect_b32 s47, s48, 0x70000000
    s_add_u32 m0, s55, 65536
    s_add_u32 s35, s35, 1
    buffer_load_dwordx4 v12, s[16:19], s47 offen offset:0 lds
    buffer_load_dwordx4 v13, s[16:19], s47 offen offset:1024 lds
    buffer_load_dwordx4 v14, s[16:19], s47 offen offset:2048 lds
    buffer_load_dwordx4 v15, s[16:19], s47 offen offset:3072 lds
    s_add_u32 s48, s48, s39
    s_cmp_lt_u32 s35, s34
    s_cselect_b32 s47, s48, 0x70000000
    s_add_u32 m0, s55, 81920
    s_add_u32 s35, s35, 1
    buffer_load_dwordx4 v12, s[16:19], s47 offen offset:0 lds
    buffer_load_dwordx4 v13, s[16:19], s47 offen offset:1024 lds
    buffer_load_dwordx4 v14, s[16:19], s47 offen offset:2048 lds
    buffer_load_dwordx4 v15, s[16:19], s47 offen offset:3072 lds
    s_add_u32 s48, s48, s39
    s_cmp_lt_u32 s35, s34
    s_cselect_b32 s47, s48, 0x70000000
    s_add_u32 m0, s55, 98304
    s_add_u32 s35, s35, 1
    buffer_load_dwordx4 v12, s[16:19], s47 offen offset:0 lds
    buffer_load_dwordx4 v13, s[16:19], s47 offen offset:1024 lds
    buffer_load_dwordx4 v14, s[16:19], s47 offen offset:2048 lds
    buffer_load_dwordx4 v15, s[16:19], s47 offen offset:3072 lds
    s_add_u32 s48, s48, s39
    s_cmp_lt_u32 s35, s34
    s_cselect_b32 s47, s48, 0x70000000
    s_add_u32 m0, s55, 114688
    s_add_u32 s35, s35, 1
    buffer_load_dwordx4 v12, s[16:19], s47 offen offset:0 lds
    buffer_load_dwordx4 v13, s[16:19], s47 offen offset:1024 lds
    buffer_load_dwordx4 v14, s[16:19], s47 offen offset:2048 lds
    buffer_load_dwordx4 v15, s[16:19], s47 offen offset:3072 lds
    s_add_u32 s48, s48, s39
    s_waitcnt vmcnt(16)
    s_barrier
    ds_read_b64_tr_b16 a[0:1], v16 offset:0
    ds_read_b64_tr_b16 a[2:3], v16 offset:1024
    ds_read_b64_tr_b16 a[4:5], v17 offset:0
    ds_read_b64_tr_b16 a[6:7], v17 offset:1024
    ds_read_b64_tr_b16 a[8:9], v16 offset:8192
    ds_read_b64_tr_b16 a[10:11], v16 offset:9216
    ds_read_b64_tr_b16 a[12:13], v17 offset:8192
    ds_read_b64_tr_b16 a[14:15], v17 offset:9216
    s_waitcnt lgkmcnt(0)
    ds_read_b64_tr_b16 a[16:17], v16 offset:16384
    ds_read_b64_tr_b16 a[18:19], v16 offset:17408
    ds_read_b64_tr_b16 a[20:21], v17 offset:16384
    ds_read_b64_tr_b16 a[22:23], v17 offset:17408
    ds_read_b64_tr_b16 a[24:25], v16 offset:24576
    ds_read_b64_tr_b16 a[26:27], v16 offset:25600
    ds_read_b64_tr_b16 a[28:29], v17 offset:24576
    ds_read_b64_tr_b16 a[30:31], v17 offset:25600
    s_waitcnt lgkmcnt(0)
    ds_read_b64_tr_b16 a[32:33], v16 offset:32768
    ds_read_b64_tr_b16 a[34:35], v16 offset:33792
    ds_read_b64_tr_b16 a[36:37], v17 offset:32768
    ds_read_b64_tr_b16 a[38:39], v17 offset:33792
    ds_read_b64_tr_b16 a[40:41], v16 offset:40960
    ds_read_b64_tr_b16 a[42:43], v16 offset:41984
    ds_read_b64_tr_b16 a[44:45], v17 offset:40960
    ds_read_b64_tr_b16 a[46:47], v17 offset:41984
    s_waitcnt lgkmcnt(0)
    ds_read_b64_tr_b16 a[48:49], v16 offset:49152
    ds_read_b64_tr_b16 a[50:51], v16 offset:50176
    ds_read_b64_tr_b16 a[52:53], v17 offset:49152
    ds_read_b64_tr_b16 a[54:55], v17 offset:50176
    ds_read_b64_tr_b16 a[56:57], v16 offset:57344
    ds_read_b64_tr_b16 a[58:59], v16 offset:58368
    ds_read_b64_tr_b16 a[60:61], v17 offset:57344
    ds_read_b64_tr_b16 a[62:63], v17 offset:58368
    s_waitcnt lgkmcnt(0)
    s_barrier
    s_cmp_lt_u32 s35, s34
    s_cselect_b32 s47, s48, 0x70000000
    s_add_u32 m0, s55, 0
    s_add_u32 s35, s35, 1
    buffer_load_dwordx4 v12, s[16:19], s47 offen offset:0 lds
    buffer_load_dwordx4 v13, s[16:19], s47 offen offset:1024 lds
    buffer_load_dwordx4 v14, s[16:19], s47 offen offset:2048 lds
    buffer_load_dwordx4 v15, s[16:19], s47 offen offset:3072 lds
    s_add_u32 s48, s48, s39
    s_cmp_lt_u32 s35, s34
    s_cselect_b32 s47, s48, 0x70000000
    s_add_u32 m0, s55, 16384
    s_add_u32 s35, s35, 1
    buffer_load_dwordx4 v12, s[16:19], s47 offen offset:0 lds
    buffer_load_dwordx4 v13, s[16:19], s47 offen offset:1024 lds
    buffer_load_dwordx4 v14, s[16:19], s47 offen offset:2048 lds
    buffer_load_dwordx4 v15, s[16:19], s47 offen offset:3072 lds
    s_add_u32 s48, s48, s39
    s_cmp_lt_u32 s35, s34
    s_cselect_b32 s47, s48, 0x70000000
    s_add_u32 m0, s55, 32768
    s_add_u32 s35, s35, 1
    buffer_load_dwordx4 v12, s[16:19], s47 offen offset:0 lds
    buffer_load_dwordx4 v13, s[16:19], s47 offen offset:1024 lds
    buffer_load_dwordx4 v14, s[16:19], s47 offen offset:2048 lds
    buffer_load_dwordx4 v15, s[16:19], s47 offen offset:3072 lds
    s_add_u32 s48, s48, s39
    s_cmp_lt_u32 s35, s34
    s_cselect_b32 s47, s48, 0x70000000
    s_add_u32 m0, s55, 49152
    s_add_u32 s35, s35, 1
    buffer_load_dwordx4 v12, s[16:19], s47 offen offset:0 lds
    buffer_load_dwordx4 v13, s[16:19], s47 offen offset:1024 lds
    buffer_load_dwordx4 v14, s[16:19], s47 offen offset:2048 lds
    buffer_load_dwordx4 v15, s[16:19], s47 offen offset:3072 lds
    s_add_u32 s48, s48, s39
    s_waitcnt vmcnt(16)
    s_barrier
    ds_read_b64_tr_b16 a[64:65], v18 offset:0
    ds_read_b64_tr_b16 a[66:67], v18 offset:1024
    ds_read_b64_tr_b16 a[68:69], v19 offset:0
    ds_read_b64_tr_b16 a[70:71], v19 offset:1024
    ds_read_b64_tr_b16 a[72:73], v18 offset:8192
    ds_read_b64_tr_b16 a[74:75], v18 offset:9216
    ds_read_b64_tr_b16 a[76:77], v19 offset:8192
    ds_read_b64_tr_b16 a[78:79], v19 offset:9216
    s_waitcnt lgkmcnt(0)
    ds_read_b64_tr_b16 a[80:81], v18 offset:16384
    ds_read_b64_tr_b16 a[82:83], v18 offset:17408
    ds_read_b64_tr_b16 a[84:85], v19 offset:16384
    ds_read_b64_tr_b16 a[86:87], v19 offset:17408
    ds_read_b64_tr_b16 a[88:89], v18 offset:24576
    ds_read_b64_tr_b16 a[90:91], v18 offset:25600
    ds_read_b64_tr_b16 a[92:93], v19 offset:24576
    ds_read_b64_tr_b16 a[94:95], v19 offset:25600
    s_waitcnt lgkmcnt(0)
    ds_read_b64_tr_b16 a[96:97], v18 offset:32768
    ds_read_b64_tr_b16 a[98:99], v18 offset:33792
    ds_read_b64_tr_b16 a[100:101], v19 offset:32768
    ds_read_b64_tr_b16 a[102:103], v19 offset:33792
    ds_read_b64_tr_b16 a[104:105], v18 offset:40960
    ds_read_b64_tr_b16 a[106:107], v18 offset:41984
    ds_read_b64_tr_b16 a[108:109], v19 offset:40960
    ds_read_b64_tr_b16 a[110:111], v19 offset:41984
    s_waitcnt lgkmcnt(0)
    ds_read_b64_tr_b16 a[112:113], v18 offset:49152
    ds_read_b64_tr_b16 a[114:115], v18 offset:50176
    ds_read_b64_tr_b16 a[116:117], v19 offset:49152
    ds_read_b64_tr_b16 a[118:119], v19 offset:50176
    ds_read_b64_tr_b16 a[120:121], v18 offset:57344
    ds_read_b64_tr_b16 a[122:123], v18 offset:58368
    ds_read_b64_tr_b16 a[124:125], v19 offset:57344
    ds_read_b64_tr_b16 a[126:127], v19 offset:58368
    s_waitcnt lgkmcnt(0)
    s_barrier
    s_cmp_lt_u32 s35, s34
    s_cselect_b32 s47, s48, 0x70000000
    s_add_u32 m0, s55, 65536
    s_add_u32 s35, s35, 1
    buffer_load_dwordx4 v12, s[16:19], s47 offen offset:0 lds
    buffer_load_dwordx4 v13, s[16:19], s47 offen offset:1024 lds
    buffer_load_dwordx4 v14, s[16:19], s47 offen offset:2048 lds
    buffer_load_dwordx4 v15, s[16:19], s47 offen offset:3072 lds
    s_add_u32 s48, s48, s39
    s_cmp_lt_u32 s35, s34
    s_cselect_b32 s47, s48, 0x70000000
    s_add_u32 m0, s55, 81920
    s_add_u32 s35, s35, 1
    buffer_load_dwordx4 v12, s[16:19], s47 offen offset:0 lds
    buffer_load_dwordx4 v13, s[16:19], s47 offen offset:1024 lds
    buffer_load_dwordx4 v14, s[16:19], s47 offen offset:2048 lds
    buffer_load_dwordx4 v15, s[16:19], s47 offen offset:3072 lds
    s_add_u32 s48, s48, s39
    s_cmp_lt_u32 s35, s34
    s_cselect_b32 s47, s48, 0x70000000
    s_add_u32 m0, s55, 98304
    s_add_u32 s35, s35, 1
    buffer_load_dwordx4 v12, s[16:19], s47 offen offset:0 lds
    buffer_load_dwordx4 v13, s[16:19], s47 offen offset:1024 lds
    buffer_load_dwordx4 v14, s[16:19], s47 offen offset:2048 lds
    buffer_load_dwordx4 v15, s[16:19], s47 offen offset:3072 lds
    s_add_u32 s48, s48, s39
    s_cmp_lt_u32 s35, s34
    s_cselect_b32 s47, s48, 0x70000000
    s_add_u32 m0, s55, 114688
    s_add_u32 s35, s35, 1
    buffer_load_dwordx4 v12, s[16:19], s47 offen offset:0 lds
    buffer_load_dwordx4 v13, s[16:19], s47 offen offset:1024 lds
    buffer_load_dwordx4 v14, s[16:19], s47 offen offset:2048 lds
    buffer_load_dwordx4 v15, s[16:19], s47 offen offset:3072 lds
    s_add_u32 s48, s48, s39
    s_waitcnt vmcnt(16)
    s_barrier
    ds_read_b64_tr_b16 a[128:129], v16 offset:0
    ds_read_b64_tr_b16 a[130:131], v16 offset:1024
    ds_read_b64_tr_b16 a[132:133], v17 offset:0
    ds_read_b64_tr_b16 a[134:135], v17 offset:1024
    ds_read_b64_tr_b16 a[136:137], v16 offset:8192
    ds_read_b64_tr_b16 a[138:139], v16 offset:9216
    ds_read_b64_tr_b16 a[140:141], v17 offset:8192
    ds_read_b64_tr_b16 a[142:143], v17 offset:9216
    s_waitcnt lgkmcnt(0)
    ds_read_b64_tr_b16 a[144:145], v16 offset:16384
    ds_read_b64_tr_b16 a[146:147], v16 offset:17408
    ds_read_b64_tr_b16 a[148:149], v17 offset:16384
    ds_read_b64_tr_b16 a[150:151], v17 offset:17408
    ds_read_b64_tr_b16 a[152:153], v16 offset:24576
    ds_read_b64_tr_b16 a[154:155], v16 offset:25600
    ds_read_b64_tr_b16 a[156:157], v17 offset:24576
    ds_read_b64_tr_b16 a[158:159], v17 offset:25600
    s_waitcnt lgkmcnt(0)
    ds_read_b64_tr_b16 a[160:161], v16 offset:32768
    ds_read_b64_tr_b16 a[162:163], v16 offset:33792
    ds_read_b64_tr_b16 a[164:165], v17 offset:32768
    ds_read_b64_tr_b16 a[166:167], v17 offset:33792
    ds_read_b64_tr_b16 a[168:169], v16 offset:40960
    ds_read_b64_tr_b16 a[170:171], v16 offset:41984
    ds_read_b64_tr_b16 a[172:173], v17 offset:40960
    ds_read_b64_tr_b16 a[174:175], v17 offset:41984
    s_waitcnt lgkmcnt(0)
    ds_read_b64_tr_b16 a[176:177], v16 offset:49152
    ds_read_b64_tr_b16 a[178:179], v16 offset:50176
    ds_read_b64_tr_b16 a[180:181], v17 offset:49152
    ds_read_b64_tr_b16 a[182:183], v17 offset:50176
    ds_read_b64_tr_b16 a[184:185], v16 offset:57344
    ds_read_b64_tr_b16 a[186:187], v16 offset:58368
    ds_read_b64_tr_b16 a[188:189], v17 offset:57344
    ds_read_b64_tr_b16 a[190:191], v17 offset:58368
    s_waitcnt lgkmcnt(0)
    s_barrier
    s_waitcnt vmcnt(0)
    s_barrier
    ds_read_b64_tr_b16 a[192:193], v18 offset:0
    ds_read_b64_tr_b16 a[194:195], v18 offset:1024
    ds_read_b64_tr_b16 a[196:197], v19 offset:0
    ds_read_b64_tr_b16 a[198:199], v19 offset:1024
    ds_read_b64_tr_b16 a[200:201], v18 offset:8192
    ds_read_b64_tr_b16 a[202:203], v18 offset:9216
    ds_read_b64_tr_b16 a[204:205], v19 offset:8192
    ds_read_b64_tr_b16 a[206:207], v19 offset:9216
    s_waitcnt lgkmcnt(0)
    ds_read_b64_tr_b16 a[208:209], v18 offset:16384
    ds_read_b64_tr_b16 a[210:211], v18 offset:17408
    ds_read_b64_tr_b16 a[212:213], v19 offset:16384
    ds_read_b64_tr_b16 a[214:215], v19 offset:17408
    ds_read_b64_tr_b16 a[216:217], v18 offset:24576
    ds_read_b64_tr_b16 a[218:219], v18 offset:25600
    ds_read_b64_tr_b16 a[220:221], v19 offset:24576
    ds_read_b64_tr_b16 a[222:223], v19 offset:25600
    s_waitcnt lgkmcnt(0)
    ds_read_b64_tr_b16 a[224:225], v18 offset:32768
    ds_read_b64_tr_b16 a[226:227], v18 offset:33792
    ds_read_b64_tr_b16 a[228:229], v19 offset:32768
    ds_read_b64_tr_b16 a[230:231], v19 offset:33792
    ds_read_b64_tr_b16 a[232:233], v18 offset:40960
    ds_read_b64_tr_b16 a[234:235], v18 offset:41984
    ds_read_b64_tr_b16 a[236:237], v19 offset:40960
    ds_read_b64_tr_b16 a[238:239], v19 offset:41984
    s_waitcnt lgkmcnt(0)
    ds_read_b64_tr_b16 a[240:241], v18 offset:49152
    ds_read_b64_tr_b16 a[242:243], v18 offset:50176
    ds_read_b64_tr_b16 a[244:245], v19 offset:49152
    ds_read_b64_tr_b16 a[246:247], v19 offset:50176
    ds_read_b64_tr_b16 a[248:249], v18 offset:57344
    ds_read_b64_tr_b16 a[250:251], v18 offset:58368
    ds_read_b64_tr_b16 a[252:253], v19 offset:57344
    ds_read_b64_tr_b16 a[254:255], v19 offset:58368
    s_waitcnt lgkmcnt(0)
    s_barrier
qkv_dep:
    s_lshl_b32 s88, s94, 6
    s_add_u32 s88, s88, 84125824
    s_mov_b32 s89, 16
    v_and_b32 v1, 63, v0
    v_lshrrev_b32 v24, 6, v0
    s_nop 0
    v_readfirstlane_b32 s41, v24
    v_lshrrev_b32 v2, 4, v1
    v_and_b32 v3, 15, v1
    s_nop 1
    v_lshrrev_b32 v24, 3, v1
    v_and_b32 v25, 7, v1
    v_xor_b32 v25, v25, v24
    v_lshlrev_b32 v25, 4, v25
    s_mul_i32 s44, s41, 32
    s_add_u32 s45, s44, 0
    v_add_u32 v26, s45, v24
    v_mul_lo_u32 v26, v26, s31
    v_add_u32 v26, v26, v25
    v_subrev_u32 v4, 0, v26
    s_add_u32 s45, s44, 8
    v_add_u32 v26, s45, v24
    v_mul_lo_u32 v26, v26, s31
    v_add_u32 v26, v26, v25
    v_subrev_u32 v5, 1024, v26
    s_add_u32 s45, s44, 16
    v_add_u32 v26, s45, v24
    v_mul_lo_u32 v26, v26, s31
    v_add_u32 v26, v26, v25
    v_subrev_u32 v6, 2048, v26
    s_add_u32 s45, s44, 24
    v_add_u32 v26, s45, v24
    v_mul_lo_u32 v26, v26, s31
    v_add_u32 v26, v26, v25
    v_subrev_u32 v7, 3072, v26
    s_mul_i32 s54, s41, 4096
    v_and_b32 v24, 7, v3
    v_xor_b32 v24, v24, v2
    v_lshlrev_b32 v24, 4, v24
    v_lshl_add_u32 v8, v3, 7, v24
    v_xor_b32 v9, 64, v8
    v_add_u32 v10, 65536, v8
    v_add_u32 v11, 65536, v9
    v_lshrrev_b32 v250, 6, v0
    s_nop 0
    v_readfirstlane_b32 s90, v250
    s_nop 3
    s_cmp_lg_u32 s90, 0
    s_cbranch_scc1 wf_45
    v_cmp_gt_u32 vcc, s89, v0
    s_mov_b64 s[92:93], vcc
    v_lshlrev_b32 v250, 2, v0
    s_mov_b32 s90, 0
    s_mov_b64 exec, s[92:93]
wl_46:
    buffer_load_dword v251, v250, s[8:11], s88 offen sc1
    s_add_u32 s90, s90, 1
    s_cmp_gt_u32 s90, 4194304
    s_cbranch_scc1 worker_abort
    s_waitcnt vmcnt(0)
    v_cmp_eq_u32 vcc, 0, v251
    s_cbranch_vccz wl_46_ok
    s_sleep 4
    s_branch wl_46
wl_46_ok:
    s_mov_b64 exec, -1
wf_45:
    s_barrier
    s_branch gemm_main
streams:
    s_getpc_b64 s[86:87]
q_pc:
    s_add_u32 s86, s86, qtable-q_pc
    s_addc_u32 s87, s87, 0
    s_lshl_b32 s44, s80, 5
    s_add_u32 s44, s44, s81
    s_lshl_b32 s44, s44, 4
    s_load_dword s58, s[86:87], s44
    s_add_u32 s45, s44, 4
    s_load_dword s59, s[86:87], s45
    s_add_u32 s46, s44, 8
    s_load_dword s91, s[86:87], s46
    s_waitcnt lgkmcnt(0)
    s_lshr_b32 s46, s58, 28
    s_cmp_eq_u32 s46, 1
    s_cbranch_scc1 att_loop
    s_cmp_eq_u32 s46, 10
    s_cbranch_scc1 u_rowloop
ms_next:
    s_cmp_lg_u32 s58, 0
    s_cbranch_scc1 ms_have
    s_mov_b32 s58, s59
    s_mov_b32 s59, s91
    s_mov_b32 s91, 0
    s_or_b32 s44, s58, s59
    s_cmp_eq_u32 s44, 0
    s_cbranch_scc1 L_exit_main
    s_branch ms_next
ms_have:
    s_bfe_u32 s94, s58, 0x60016
    s_bfe_u32 s95, s58, 0x50011
    s_bfe_u32 s96, s58, 0x3000e
    s_bfe_u32 s78, s58, 0x60008
    s_bfe_u32 s79, s58, 0x50003
    s_lshl_b32 s70, s94, 6
    s_mov_b32 s71, 0
    s_lshr_b32 s49, s58, 28
    s_cmp_lg_u32 s49, 2
    s_cbranch_scc1 mt_47
    s_load_dwordx2 s[16:17], s[0:1], 40
    s_mov_b32 s18, 8388608
    s_mov_b32 s19, 0x00020000
    s_waitcnt lgkmcnt(0)
    s_mov_b32 s12, s8
    s_mov_b32 s13, s9
    s_mov_b32 s14, s10
    s_mov_b32 s15, s11
    s_mov_b32 s20, s8
    s_mov_b32 s21, s9
    s_mov_b32 s22, s10
    s_mov_b32 s23, s11
    s_mov_b32 s24, s8
    s_mov_b32 s25, s9
    s_mov_b32 s26, s10
    s_mov_b32 s27, s11
    s_lshl_b32 s44, s94, 6
    s_lshl_b32 s45, s96, 3
    s_add_u32 s44, s44, s45
    s_add_u32 s44, s44, s95
    s_lshl_b32 s44, s44, 2
    s_add_u32 s83, s44, 84093184
    s_mov_b32 s31, 8192
    s_mov_b32 s32, 2048
    s_mov_b32 s33, 2048
    s_mov_b32 s34, 0
    s_mov_b32 s51, 0
    s_mov_b32 s40, 0
    s_mov_b32 s34, s79
    s_mov_b32 s75, s95
    s_mov_b32 s76, 16
    s_mul_i32 s28, s70, 8192
    s_lshl_b32 s44, s78, 7
    s_add_u32 s28, s28, s44
    s_add_u32 s28, s28, 62914560
    s_mul_i32 s29, s78, 131072
    s_lshl_b32 s44, s95, 8
    s_add_u32 s29, s29, s44
    s_lshl_b32 s30, s70, 11
    s_add_u32 s30, s30, s44
    s_lshl_b32 s44, s96, 22
    s_add_u32 s30, s30, s44
    s_add_u32 s30, s30, 134217728
mt_47:
    s_cmp_lg_u32 s49, 8
    s_cbranch_scc1 mt_48
    s_load_dwordx2 s[16:17], s[0:1], 88
    s_mov_b32 s18, 7340032
    s_mov_b32 s19, 0x00020000
    s_waitcnt lgkmcnt(0)
    s_mov_b32 s12, s8
    s_mov_b32 s13, s9
    s_mov_b32 s14, s10
    s_mov_b32 s15, s11
    s_mov_b32 s20, s8
    s_mov_b32 s21, s9
    s_mov_b32 s22, s10
    s_mov_b32 s23, s11
    s_mov_b32 s24, s8
    s_mov_b32 s25, s9
    s_mov_b32 s26, s10
    s_mov_b32 s27, s11
    s_lshl_b32 s44, s94, 6
    s_lshl_b32 s45, s96, 3
    s_add_u32 s44, s44, s45
    s_add_u32 s44, s44, s95
    s_lshl_b32 s44, s44, 2
    s_add_u32 s83, s44, 84117120
    s_mov_b32 s31, 7168
    s_mov_b32 s32, 2048
    s_mov_b32 s33, 2048
    s_mov_b32 s34, 0
    s_mov_b32 s51, 0
    s_mov_b32 s40, 0
    s_mov_b32 s34, s79
    s_mov_b32 s75, s95
    s_mov_b32 s76, 16
    s_mul_i32 s28, s70, 7168
    s_lshl_b32 s44, s78, 7
    s_add_u32 s28, s28, s44
    s_add_u32 s28, s28, 115343360
    s_mul_i32 s29, s78, 131072
    s_lshl_b32 s44, s95, 8
    s_add_u32 s29, s29, s44
    s_lshl_b32 s30, s70, 11
    s_add_u32 s30, s30, s44
    s_lshl_b32 s44, s96, 22
    s_add_u32 s30, s30, s44
    s_add_u32 s30, s30, 167772160
mt_48:
    s_cmp_lg_u32 s49, 4
    s_cbranch_scc1 mt_49
    s_load_dwordx2 s[16:17], s[0:1], 64
    s_mov_b32 s18, 2097152
    s_mov_b32 s19, 0x00020000
    s_waitcnt lgkmcnt(0)
    s_mov_b32 s12, s8
    s_mov_b32 s13, s9
    s_mov_b32 s14, s10
    s_mov_b32 s15, s11
    s_mov_b32 s20, s8
    s_mov_b32 s21, s9
    s_mov_b32 s22, s10
    s_mov_b32 s23, s11
    s_mov_b32 s24, s8
    s_mov_b32 s25, s9
    s_mov_b32 s26, s10
    s_mov_b32 s27, s11
    s_mul_i32 s44, s94, 8
    s_add_u32 s44, s44, s95
    s_lshl_b32 s44, s44, 2
    s_add_u32 s83, s44, 84106240
    s_mov_b32 s31, 2048
    s_mov_b32 s32, 2048
    s_mov_b32 s33, 2048
    s_mov_b32 s34, 16
    s_mov_b32 s51, 0
    s_mov_b32 s40, 1
    s_mov_b32 s75, s78
    s_cmp_eq_u32 s79, 7
    s_cselect_b32 s76, 19, 16
    s_lshl_b32 s28, s70, 11
    s_add_u32 s28, s28, 96468992
    s_lshl_b32 s29, s95, 8
    s_mul_i32 s30, s70, 2048
    s_add_u32 s30, s30, s29
    s_add_u32 s30, s30, 100667392
mt_49:
    s_cmp_lg_u32 s49, 5
    s_cbranch_scc1 mt_50
    s_load_dwordx2 s[16:17], s[0:1], 72
    s_mov_b32 s18, 2097152
    s_mov_b32 s19, 0x00020000
    s_waitcnt lgkmcnt(0)
    s_mov_b32 s12, s8
    s_mov_b32 s13, s9
    s_mov_b32 s14, s10
    s_mov_b32 s15, s11
    s_mov_b32 s20, s8
    s_mov_b32 s21, s9
    s_mov_b32 s22, s10
    s_mov_b32 s23, s11
    s_mov_b32 s24, s8
    s_mov_b32 s25, s9
    s_mov_b32 s26, s10
    s_mov_b32 s27, s11
    s_mul_i32 s44, s94, 8
    s_add_u32 s44, s44, s95
    s_lshl_b32 s44, s44, 2
    s_add_u32 s83, s44, 84107328
    s_mov_b32 s31, 2048
    s_mov_b32 s32, 2048
    s_mov_b32 s33, 2048
    s_mov_b32 s34, 16
    s_mov_b32 s51, 2048
    s_mov_b32 s40, 2
    s_mov_b32 s75, s78
    s_cmp_eq_u32 s79, 7
    s_cselect_b32 s76, 19, 16
    s_lshl_b32 s28, s70, 11
    s_add_u32 s28, s28, 100665344
    s_lshl_b32 s29, s95, 8
    s_mul_i32 s30, s70, 2048
    s_add_u32 s30, s30, s29
    s_add_u32 s38, s30, 92274688
    s_add_u32 s30, s30, 106954752
mt_50:
    s_cmp_lg_u32 s49, 7
    s_cbranch_scc1 mt_51
    s_load_dwordx2 s[16:17], s[0:1], 80
    s_mov_b32 s18, 7340032
    s_mov_b32 s19, 0x00020000
    s_waitcnt lgkmcnt(0)
    s_mov_b32 s12, s8
    s_mov_b32 s13, s9
    s_mov_b32 s14, s10
    s_mov_b32 s15, s11
    s_mov_b32 s20, s8
    s_mov_b32 s21, s9
    s_mov_b32 s22, s10
    s_mov_b32 s23, s11
    s_mov_b32 s24, s8
    s_mov_b32 s25, s9
    s_mov_b32 s26, s10
    s_mov_b32 s27, s11
    s_mul_i32 s44, s94, 32
    s_add_u32 s44, s44, s95
    s_lshl_b32 s44, s44, 2
    s_add_u32 s83, s44, 84112768
    s_mov_b32 s31, 2048
    s_mov_b32 s32, 7168
    s_mov_b32 s33, 7168
    s_mov_b32 s34, 16
    s_mov_b32 s51, 0
    s_mov_b32 s40, 1
    s_mov_b32 s75, s78
    s_cmp_eq_u32 s79, 7
    s_cselect_b32 s76, 19, 16
    s_lshl_b32 s28, s70, 11
    s_add_u32 s28, s28, 111149056
    s_lshl_b32 s29, s95, 8
    s_mul_i32 s30, s70, 7168
    s_add_u32 s30, s30, s29
    s_add_u32 s30, s30, 115343360
mt_51:
    v_and_b32 v1, 63, v0
    v_lshrrev_b32 v24, 6, v0
    s_nop 0
    v_readfirstlane_b32 s41, v24
    v_lshrrev_b32 v2, 4, v1
    v_and_b32 v3, 15, v1
    s_nop 1
    v_lshrrev_b32 v24, 1, v3
    v_and_b32 v27, 1, v3
    s_lshl_b32 s44, s41, 4
    v_xor_b32 v25, v24, v2
    v_lshlrev_b32 v25, 5, v25
    v_lshl_add_u32 v25, v27, 4, v25
    s_add_u32 s45, s44, 0
    v_add_u32 v26, s45, v2
    v_mul_lo_u32 v26, v26, s32
    v_add_u32 v26, v26, v25
    v_subrev_u32 v12, 0, v26
    v_xor_b32 v25, v24, v2
    v_lshlrev_b32 v25, 5, v25
    v_lshl_add_u32 v25, v27, 4, v25
    s_add_u32 s45, s44, 4
    v_add_u32 v26, s45, v2
    v_mul_lo_u32 v26, v26, s32
    v_add_u32 v26, v26, v25
    v_subrev_u32 v13, 1024, v26
    v_xor_b32 v25, v24, v2
    v_xor_b32 v25, 4, v25
    v_lshlrev_b32 v25, 5, v25
    v_lshl_add_u32 v25, v27, 4, v25
    s_add_u32 s45, s44, 8
    v_add_u32 v26, s45, v2
    v_mul_lo_u32 v26, v26, s32
    v_add_u32 v26, v26, v25
    v_subrev_u32 v14, 2048, v26
    v_xor_b32 v25, v24, v2
    v_xor_b32 v25, 4, v25
    v_lshlrev_b32 v25, 5, v25
    v_lshl_add_u32 v25, v27, 4, v25
    s_add_u32 s45, s44, 12
    v_add_u32 v26, s45, v2
    v_mul_lo_u32 v26, v26, s32
    v_add_u32 v26, v26, v25
    v_subrev_u32 v15, 3072, v26
    v_lshrrev_b32 v24, 2, v3
    v_and_b32 v25, 1, v2
    v_lshl_add_u32 v25, v25, 2, v24
    v_lshl_add_u32 v24, v2, 3, v24
    v_lshlrev_b32 v24, 8, v24
    v_and_b32 v26, 3, v3
    v_lshl_add_u32 v24, v26, 3, v24
    s_lshl_b32 s44, s41, 1
    s_add_u32 s45, s44, 0
    v_xor_b32 v26, s45, v25
    v_lshl_add_u32 v16, v26, 5, v24
    s_add_u32 s45, s44, 1
    v_xor_b32 v26, s45, v25
    v_lshl_add_u32 v17, v26, 5, v24
    s_lshl_b32 s39, s32, 6
    s_lshl_b32 s55, s41, 12
    s_mov_b32 s48, s29
    s_mov_b32 s35, 0
    v_add_u32 v18, 65536, v16
    v_add_u32 v19, 65536, v17
    s_cmp_lt_u32 s35, s34
    s_cselect_b32 s47, s48, 0x70000000
    s_add_u32 m0, s55, 0
    s_add_u32 s35, s35, 1
    buffer_load_dwordx4 v12, s[16:19], s47 offen offset:0 lds
    buffer_load_dwordx4 v13, s[16:19], s47 offen offset:1024 lds
    buffer_load_dwordx4 v14, s[16:19], s47 offen offset:2048 lds
    buffer_load_dwordx4 v15, s[16:19], s47 offen offset:3072 lds
    s_add_u32 s48, s48, s39
    s_cmp_lt_u32 s35, s34
    s_cselect_b32 s47, s48, 0x70000000
    s_add_u32 m0, s55, 16384
    s_add_u32 s35, s35, 1
    buffer_load_dwordx4 v12, s[16:19], s47 offen offset:0 lds
    buffer_load_dwordx4 v13, s[16:19], s47 offen offset:1024 lds
    buffer_load_dwordx4 v14, s[16:19], s47 offen offset:2048 lds
    buffer_load_dwordx4 v15, s[16:19], s47 offen offset:3072 lds
    s_add_u32 s48, s48, s39
    s_cmp_lt_u32 s35, s34
    s_cselect_b32 s47, s48, 0x70000000
    s_add_u32 m0, s55, 32768
    s_add_u32 s35, s35, 1
    buffer_load_dwordx4 v12, s[16:19], s47 offen offset:0 lds
    buffer_load_dwordx4 v13, s[16:19], s47 offen offset:1024 lds
    buffer_load_dwordx4 v14, s[16:19], s47 offen offset:2048 lds
    buffer_load_dwordx4 v15, s[16:19], s47 offen offset:3072 lds
    s_add_u32 s48, s48, s39
    s_cmp_lt_u32 s35, s34
    s_cselect_b32 s47, s48, 0x70000000
    s_add_u32 m0, s55, 49152
    s_add_u32 s35, s35, 1
    buffer_load_dwordx4 v12, s[16:19], s47 offen offset:0 lds
    buffer_load_dwordx4 v13, s[16:19], s47 offen offset:1024 lds
    buffer_load_dwordx4 v14, s[16:19], s47 offen offset:2048 lds
    buffer_load_dwordx4 v15, s[16:19], s47 offen offset:3072 lds
    s_add_u32 s48, s48, s39
    s_cmp_lt_u32 s35, s34
    s_cselect_b32 s47, s48, 0x70000000
    s_add_u32 m0, s55, 65536
    s_add_u32 s35, s35, 1
    buffer_load_dwordx4 v12, s[16:19], s47 offen offset:0 lds
    buffer_load_dwordx4 v13, s[16:19], s47 offen offset:1024 lds
    buffer_load_dwordx4 v14, s[16:19], s47 offen offset:2048 lds
    buffer_load_dwordx4 v15, s[16:19], s47 offen offset:3072 lds
    s_add_u32 s48, s48, s39
    s_cmp_lt_u32 s35, s34
    s_cselect_b32 s47, s48, 0x70000000
    s_add_u32 m0, s55, 81920
    s_add_u32 s35, s35, 1
    buffer_load_dwordx4 v12, s[16:19], s47 offen offset:0 lds
    buffer_load_dwordx4 v13, s[16:19], s47 offen offset:1024 lds
    buffer_load_dwordx4 v14, s[16:19], s47 offen offset:2048 lds
    buffer_load_dwordx4 v15, s[16:19], s47 offen offset:3072 lds
    s_add_u32 s48, s48, s39
    s_cmp_lt_u32 s35, s34
    s_cselect_b32 s47, s48, 0x70000000
    s_add_u32 m0, s55, 98304
    s_add_u32 s35, s35, 1
    buffer_load_dwordx4 v12, s[16:19], s47 offen offset:0 lds
    buffer_load_dwordx4 v13, s[16:19], s47 offen offset:1024 lds
    buffer_load_dwordx4 v14, s[16:19], s47 offen offset:2048 lds
    buffer_load_dwordx4 v15, s[16:19], s47 offen offset:3072 lds
    s_add_u32 s48, s48, s39
    s_cmp_lt_u32 s35, s34
    s_cselect_b32 s47, s48, 0x70000000
    s_add_u32 m0, s55, 114688
    s_add_u32 s35, s35, 1
    buffer_load_dwordx4 v12, s[16:19], s47 offen offset:0 lds
    buffer_load_dwordx4 v13, s[16:19], s47 offen offset:1024 lds
    buffer_load_dwordx4 v14, s[16:19], s47 offen offset:2048 lds
    buffer_load_dwordx4 v15, s[16:19], s47 offen offset:3072 lds
    s_add_u32 s48, s48, s39
    s_waitcnt vmcnt(16)
    s_barrier
    ds_read_b64_tr_b16 a[0:1], v16 offset:0
    ds_read_b64_tr_b16 a[2:3], v16 offset:1024
    ds_read_b64_tr_b16 a[4:5], v17 offset:0
    ds_read_b64_tr_b16 a[6:7], v17 offset:1024
    ds_read_b64_tr_b16 a[8:9], v16 offset:8192
    ds_read_b64_tr_b16 a[10:11], v16 offset:9216
    ds_read_b64_tr_b16 a[12:13], v17 offset:8192
    ds_read_b64_tr_b16 a[14:15], v17 offset:9216
    s_waitcnt lgkmcnt(0)
    ds_read_b64_tr_b16 a[16:17], v16 offset:16384
    ds_read_b64_tr_b16 a[18:19], v16 offset:17408
    ds_read_b64_tr_b16 a[20:21], v17 offset:16384
    ds_read_b64_tr_b16 a[22:23], v17 offset:17408
    ds_read_b64_tr_b16 a[24:25], v16 offset:24576
    ds_read_b64_tr_b16 a[26:27], v16 offset:25600
    ds_read_b64_tr_b16 a[28:29], v17 offset:24576
    ds_read_b64_tr_b16 a[30:31], v17 offset:25600
    s_waitcnt lgkmcnt(0)
    ds_read_b64_tr_b16 a[32:33], v16 offset:32768
    ds_read_b64_tr_b16 a[34:35], v16 offset:33792
    ds_read_b64_tr_b16 a[36:37], v17 offset:32768
    ds_read_b64_tr_b16 a[38:39], v17 offset:33792
    ds_read_b64_tr_b16 a[40:41], v16 offset:40960
    ds_read_b64_tr_b16 a[42:43], v16 offset:41984
    ds_read_b64_tr_b16 a[44:45], v17 offset:40960
    ds_read_b64_tr_b16 a[46:47], v17 offset:41984
    s_waitcnt lgkmcnt(0)
    ds_read_b64_tr_b16 a[48:49], v16 offset:49152
    ds_read_b64_tr_b16 a[50:51], v16 offset:50176
    ds_read_b64_tr_b16 a[52:53], v17 offset:49152
    ds_read_b64_tr_b16 a[54:55], v17 offset:50176
    ds_read_b64_tr_b16 a[56:57], v16 offset:57344
    ds_read_b64_tr_b16 a[58:59], v16 offset:58368
    ds_read_b64_tr_b16 a[60:61], v17 offset:57344
    ds_read_b64_tr_b16 a[62:63], v17 offset:58368
    s_waitcnt lgkmcnt(0)
    s_barrier
    s_cmp_lt_u32 s35, s34
    s_cselect_b32 s47, s48, 0x70000000
    s_add_u32 m0, s55, 0
    s_add_u32 s35, s35, 1
    buffer_load_dwordx4 v12, s[16:19], s47 offen offset:0 lds
    buffer_load_dwordx4 v13, s[16:19], s47 offen offset:1024 lds
    buffer_load_dwordx4 v14, s[16:19], s47 offen offset:2048 lds
    buffer_load_dwordx4 v15, s[16:19], s47 offen offset:3072 lds
    s_add_u32 s48, s48, s39
    s_cmp_lt_u32 s35, s34
    s_cselect_b32 s47, s48, 0x70000000
    s_add_u32 m0, s55, 16384
    s_add_u32 s35, s35, 1
    buffer_load_dwordx4 v12, s[16:19], s47 offen offset:0 lds
    buffer_load_dwordx4 v13, s[16:19], s47 offen offset:1024 lds
    buffer_load_dwordx4 v14, s[16:19], s47 offen offset:2048 lds
    buffer_load_dwordx4 v15, s[16:19], s47 offen offset:3072 lds
    s_add_u32 s48, s48, s39
    s_cmp_lt_u32 s35, s34
    s_cselect_b32 s47, s48, 0x70000000
    s_add_u32 m0, s55, 32768
    s_add_u32 s35, s35, 1
    buffer_load_dwordx4 v12, s[16:19], s47 offen offset:0 lds
    buffer_load_dwordx4 v13, s[16:19], s47 offen offset:1024 lds
    buffer_load_dwordx4 v14, s[16:19], s47 offen offset:2048 lds
    buffer_load_dwordx4 v15, s[16:19], s47 offen offset:3072 lds
    s_add_u32 s48, s48, s39
    s_cmp_lt_u32 s35, s34
    s_cselect_b32 s47, s48, 0x70000000
    s_add_u32 m0, s55, 49152
    s_add_u32 s35, s35, 1
    buffer_load_dwordx4 v12, s[16:19], s47 offen offset:0 lds
    buffer_load_dwordx4 v13, s[16:19], s47 offen offset:1024 lds
    buffer_load_dwordx4 v14, s[16:19], s47 offen offset:2048 lds
    buffer_load_dwordx4 v15, s[16:19], s47 offen offset:3072 lds
    s_add_u32 s48, s48, s39
    s_waitcnt vmcnt(16)
    s_barrier
    ds_read_b64_tr_b16 a[64:65], v18 offset:0
    ds_read_b64_tr_b16 a[66:67], v18 offset:1024
    ds_read_b64_tr_b16 a[68:69], v19 offset:0
    ds_read_b64_tr_b16 a[70:71], v19 offset:1024
    ds_read_b64_tr_b16 a[72:73], v18 offset:8192
    ds_read_b64_tr_b16 a[74:75], v18 offset:9216
    ds_read_b64_tr_b16 a[76:77], v19 offset:8192
    ds_read_b64_tr_b16 a[78:79], v19 offset:9216
    s_waitcnt lgkmcnt(0)
    ds_read_b64_tr_b16 a[80:81], v18 offset:16384
    ds_read_b64_tr_b16 a[82:83], v18 offset:17408
    ds_read_b64_tr_b16 a[84:85], v19 offset:16384
    ds_read_b64_tr_b16 a[86:87], v19 offset:17408
    ds_read_b64_tr_b16 a[88:89], v18 offset:24576
    ds_read_b64_tr_b16 a[90:91], v18 offset:25600
    ds_read_b64_tr_b16 a[92:93], v19 offset:24576
    ds_read_b64_tr_b16 a[94:95], v19 offset:25600
    s_waitcnt lgkmcnt(0)
    ds_read_b64_tr_b16 a[96:97], v18 offset:32768
    ds_read_b64_tr_b16 a[98:99], v18 offset:33792
    ds_read_b64_tr_b16 a[100:101], v19 offset:32768
    ds_read_b64_tr_b16 a[102:103], v19 offset:33792
    ds_read_b64_tr_b16 a[104:105], v18 offset:40960
    ds_read_b64_tr_b16 a[106:107], v18 offset:41984
    ds_read_b64_tr_b16 a[108:109], v19 offset:40960
    ds_read_b64_tr_b16 a[110:111], v19 offset:41984
    s_waitcnt lgkmcnt(0)
    ds_read_b64_tr_b16 a[112:113], v18 offset:49152
    ds_read_b64_tr_b16 a[114:115], v18 offset:50176
    ds_read_b64_tr_b16 a[116:117], v19 offset:49152
    ds_read_b64_tr_b16 a[118:119], v19 offset:50176
    ds_read_b64_tr_b16 a[120:121], v18 offset:57344
    ds_read_b64_tr_b16 a[122:123], v18 offset:58368
    ds_read_b64_tr_b16 a[124:125], v19 offset:57344
    ds_read_b64_tr_b16 a[126:127], v19 offset:58368
    s_waitcnt lgkmcnt(0)
    s_barrier
    s_cmp_lt_u32 s35, s34
    s_cselect_b32 s47, s48, 0x70000000
    s_add_u32 m0, s55, 65536
    s_add_u32 s35, s35, 1
    buffer_load_dwordx4 v12, s[16:19], s47 offen offset:0 lds
    buffer_load_dwordx4 v13, s[16:19], s47 offen offset:1024 lds
    buffer_load_dwordx4 v14, s[16:19], s47 offen offset:2048 lds
    buffer_load_dwordx4 v15, s[16:19], s47 offen offset:3072 lds
    s_add_u32 s48, s48, s39
    s_cmp_lt_u32 s35, s34
    s_cselect_b32 s47, s48, 0x70000000
    s_add_u32 m0, s55, 81920
    s_add_u32 s35, s35, 1
    buffer_load_dwordx4 v12, s[16:19], s47 offen offset:0 lds
    buffer_load_dwordx4 v13, s[16:19], s47 offen offset:1024 lds
    buffer_load_dwordx4 v14, s[16:19], s47 offen offset:2048 lds
    buffer_load_dwordx4 v15, s[16:19], s47 offen offset:3072 lds
    s_add_u32 s48, s48, s39
    s_cmp_lt_u32 s35, s34
    s_cselect_b32 s47, s48, 0x70000000
    s_add_u32 m0, s55, 98304
    s_add_u32 s35, s35, 1
    buffer_load_dwordx4 v12, s[16:19], s47 offen offset:0 lds
    buffer_load_dwordx4 v13, s[16:19], s47 offen offset:1024 lds
    buffer_load_dwordx4 v14, s[16:19], s47 offen offset:2048 lds
    buffer_load_dwordx4 v15, s[16:19], s47 offen offset:3072 lds
    s_add_u32 s48, s48, s39
    s_cmp_lt_u32 s35, s34
    s_cselect_b32 s47, s48, 0x70000000
    s_add_u32 m0, s55, 114688
    s_add_u32 s35, s35, 1
    buffer_load_dwordx4 v12, s[16:19], s47 offen offset:0 lds
    buffer_load_dwordx4 v13, s[16:19], s47 offen offset:1024 lds
    buffer_load_dwordx4 v14, s[16:19], s47 offen offset:2048 lds
    buffer_load_dwordx4 v15, s[16:19], s47 offen offset:3072 lds
    s_add_u32 s48, s48, s39
    s_waitcnt vmcnt(16)
    s_barrier
    ds_read_b64_tr_b16 a[128:129], v16 offset:0
    ds_read_b64_tr_b16 a[130:131], v16 offset:1024
    ds_read_b64_tr_b16 a[132:133], v17 offset:0
    ds_read_b64_tr_b16 a[134:135], v17 offset:1024
    ds_read_b64_tr_b16 a[136:137], v16 offset:8192
    ds_read_b64_tr_b16 a[138:139], v16 offset:9216
    ds_read_b64_tr_b16 a[140:141], v17 offset:8192
    ds_read_b64_tr_b16 a[142:143], v17 offset:9216
    s_waitcnt lgkmcnt(0)
    ds_read_b64_tr_b16 a[144:145], v16 offset:16384
    ds_read_b64_tr_b16 a[146:147], v16 offset:17408
    ds_read_b64_tr_b16 a[148:149], v17 offset:16384
    ds_read_b64_tr_b16 a[150:151], v17 offset:17408
    ds_read_b64_tr_b16 a[152:153], v16 offset:24576
    ds_read_b64_tr_b16 a[154:155], v16 offset:25600
    ds_read_b64_tr_b16 a[156:157], v17 offset:24576
    ds_read_b64_tr_b16 a[158:159], v17 offset:25600
    s_waitcnt lgkmcnt(0)
    ds_read_b64_tr_b16 a[160:161], v16 offset:32768
    ds_read_b64_tr_b16 a[162:163], v16 offset:33792
    ds_read_b64_tr_b16 a[164:165], v17 offset:32768
    ds_read_b64_tr_b16 a[166:167], v17 offset:33792
    ds_read_b64_tr_b16 a[168:169], v16 offset:40960
    ds_read_b64_tr_b16 a[170:171], v16 offset:41984
    ds_read_b64_tr_b16 a[172:173], v17 offset:40960
    ds_read_b64_tr_b16 a[174:175], v17 offset:41984
    s_waitcnt lgkmcnt(0)
    ds_read_b64_tr_b16 a[176:177], v16 offset:49152
    ds_read_b64_tr_b16 a[178:179], v16 offset:50176
    ds_read_b64_tr_b16 a[180:181], v17 offset:49152
    ds_read_b64_tr_b16 a[182:183], v17 offset:50176
    ds_read_b64_tr_b16 a[184:185], v16 offset:57344
    ds_read_b64_tr_b16 a[186:187], v16 offset:58368
    ds_read_b64_tr_b16 a[188:189], v17 offset:57344
    ds_read_b64_tr_b16 a[190:191], v17 offset:58368
    s_waitcnt lgkmcnt(0)
    s_barrier
    s_waitcnt vmcnt(0)
    s_barrier
    ds_read_b64_tr_b16 a[192:193], v18 offset:0
    ds_read_b64_tr_b16 a[194:195], v18 offset:1024
    ds_read_b64_tr_b16 a[196:197], v19 offset:0
    ds_read_b64_tr_b16 a[198:199], v19 offset:1024
    ds_read_b64_tr_b16 a[200:201], v18 offset:8192
    ds_read_b64_tr_b16 a[202:203], v18 offset:9216
    ds_read_b64_tr_b16 a[204:205], v19 offset:8192
    ds_read_b64_tr_b16 a[206:207], v19 offset:9216
    s_waitcnt lgkmcnt(0)
    ds_read_b64_tr_b16 a[208:209], v18 offset:16384
    ds_read_b64_tr_b16 a[210:211], v18 offset:17408
    ds_read_b64_tr_b16 a[212:213], v19 offset:16384
    ds_read_b64_tr_b16 a[214:215], v19 offset:17408
    ds_read_b64_tr_b16 a[216:217], v18 offset:24576
    ds_read_b64_tr_b16 a[218:219], v18 offset:25600
    ds_read_b64_tr_b16 a[220:221], v19 offset:24576
    ds_read_b64_tr_b16 a[222:223], v19 offset:25600
    s_waitcnt lgkmcnt(0)
    ds_read_b64_tr_b16 a[224:225], v18 offset:32768
    ds_read_b64_tr_b16 a[226:227], v18 offset:33792
    ds_read_b64_tr_b16 a[228:229], v19 offset:32768
    ds_read_b64_tr_b16 a[230:231], v19 offset:33792
    ds_read_b64_tr_b16 a[232:233], v18 offset:40960
    ds_read_b64_tr_b16 a[234:235], v18 offset:41984
    ds_read_b64_tr_b16 a[236:237], v19 offset:40960
    ds_read_b64_tr_b16 a[238:239], v19 offset:41984
    s_waitcnt lgkmcnt(0)
    ds_read_b64_tr_b16 a[240:241], v18 offset:49152
    ds_read_b64_tr_b16 a[242:243], v18 offset:50176
    ds_read_b64_tr_b16 a[244:245], v19 offset:49152
    ds_read_b64_tr_b16 a[246:247], v19 offset:50176
    ds_read_b64_tr_b16 a[248:249], v18 offset:57344
    ds_read_b64_tr_b16 a[250:251], v18 offset:58368
    ds_read_b64_tr_b16 a[252:253], v19 offset:57344
    ds_read_b64_tr_b16 a[254:255], v19 offset:58368
    s_waitcnt lgkmcnt(0)
    s_barrier
ms_top:
    s_cmp_eq_u32 s58, 0
    s_cbranch_scc1 ms_next
    s_bfe_u32 s44, s58, 0x60016
    s_lshr_b32 s49, s58, 28
    s_mov_b32 s89, 16
    s_lshl_b32 s46, s44, 7
    s_add_u32 s88, s46, 84088832
    s_add_u32 s47, s46, 84101888
    s_cmp_eq_u32 s49, 4
    s_cselect_b32 s88, s47, s88
    s_add_u32 s47, s46, 84108416
    s_cmp_eq_u32 s49, 7
    s_cselect_b32 s88, s47, s88
    s_add_u32 s47, s46, 84112768
    s_cmp_eq_u32 s49, 8
    s_cselect_b32 s88, s47, s88
    s_cselect_b32 s89, 28, s89
    s_cmp_lg_u32 s49, 5
    s_cbranch_scc1 m2_52
    s_sub_u32 s46, s44, 1
    s_cmp_eq_u32 s44, 0
    s_cselect_b32 s46, 0, s46
    s_add_u32 s47, s44, 1
    s_cmp_eq_u32 s44, 31
    s_cselect_b32 s47, s44, s47
    s_sub_u32 s47, s47, s46
    s_add_u32 s47, s47, 1
    s_lshl_b32 s89, s47, 3
    s_lshl_b32 s46, s46, 5
    s_add_u32 s88, s46, 84106240
m2_52:
    s_mov_b32 s84, s58
    s_add_u32 s58, s58, 4194304
    s_bfe_u32 s44, s58, 0x60016
    s_add_u32 s45, s58, 1
    s_and_b32 s45, s45, 7
    s_add_u32 s45, s45, 30
    s_cmp_eq_u32 s44, s45
    s_cselect_b32 s58, 0, s58
    s_bfe_u32 s94, s84, 0x60016
    s_bfe_u32 s95, s84, 0x50011
    s_bfe_u32 s96, s84, 0x3000e
    s_bfe_u32 s78, s84, 0x60008
    s_bfe_u32 s79, s84, 0x50003
    s_lshl_b32 s70, s94, 6
    s_mov_b32 s71, 0
    s_lshr_b32 s49, s84, 28
    s_mov_b32 s84, 0
    s_cmp_lg_u32 s49, 2
    s_cbranch_scc1 mr_53
    s_load_dwordx2 s[16:17], s[0:1], 40
    s_mov_b32 s18, 8388608
    s_mov_b32 s19, 0x00020000
    s_waitcnt lgkmcnt(0)
    s_mov_b32 s12, s8
    s_mov_b32 s13, s9
    s_mov_b32 s14, s10
    s_mov_b32 s15, s11
    s_mov_b32 s20, s8
    s_mov_b32 s21, s9
    s_mov_b32 s22, s10
    s_mov_b32 s23, s11
    s_mov_b32 s24, s8
    s_mov_b32 s25, s9
    s_mov_b32 s26, s10
    s_mov_b32 s27, s11
    s_lshl_b32 s44, s94, 6
    s_lshl_b32 s45, s96, 3
    s_add_u32 s44, s44, s45
    s_add_u32 s44, s44, s95
    s_lshl_b32 s44, s44, 2
    s_add_u32 s83, s44, 84093184
    s_mov_b32 s31, 8192
    s_mov_b32 s32, 2048
    s_mov_b32 s33, 2048
    s_mov_b32 s34, 0
    s_mov_b32 s51, 0
    s_mov_b32 s40, 0
    s_mov_b32 s34, s79
    s_mov_b32 s75, s95
    s_mov_b32 s76, 16
    s_mul_i32 s28, s70, 8192
    s_lshl_b32 s44, s78, 7
    s_add_u32 s28, s28, s44
    s_add_u32 s28, s28, 62914560
    s_mul_i32 s29, s78, 131072
    s_lshl_b32 s44, s95, 8
    s_add_u32 s29, s29, s44
    s_lshl_b32 s30, s70, 11
    s_add_u32 s30, s30, s44
    s_lshl_b32 s44, s96, 22
    s_add_u32 s30, s30, s44
    s_add_u32 s30, s30, 134217728
mr_53:
    s_cmp_lg_u32 s49, 8
    s_cbranch_scc1 mr_54
    s_load_dwordx2 s[16:17], s[0:1], 88
    s_mov_b32 s18, 7340032
    s_mov_b32 s19, 0x00020000
    s_waitcnt lgkmcnt(0)
    s_mov_b32 s12, s8
    s_mov_b32 s13, s9
    s_mov_b32 s14, s10
    s_mov_b32 s15, s11
    s_mov_b32 s20, s8
    s_mov_b32 s21, s9
    s_mov_b32 s22, s10
    s_mov_b32 s23, s11
    s_mov_b32 s24, s8
    s_mov_b32 s25, s9
    s_mov_b32 s26, s10
    s_mov_b32 s27, s11
    s_lshl_b32 s44, s94, 6
    s_lshl_b32 s45, s96, 3
    s_add_u32 s44, s44, s45
    s_add_u32 s44, s44, s95
    s_lshl_b32 s44, s44, 2
    s_add_u32 s83, s44, 84117120
    s_mov_b32 s31, 7168
    s_mov_b32 s32, 2048
    s_mov_b32 s33, 2048
    s_mov_b32 s34, 0
    s_mov_b32 s51, 0
    s_mov_b32 s40, 0
    s_mov_b32 s34, s79
    s_mov_b32 s75, s95
    s_mov_b32 s76, 16
    s_mul_i32 s28, s70, 7168
    s_lshl_b32 s44, s78, 7
    s_add_u32 s28, s28, s44
    s_add_u32 s28, s28, 115343360
    s_mul_i32 s29, s78, 131072
    s_lshl_b32 s44, s95, 8
    s_add_u32 s29, s29, s44
    s_lshl_b32 s30, s70, 11
    s_add_u32 s30, s30, s44
    s_lshl_b32 s44, s96, 22
    s_add_u32 s30, s30, s44
    s_add_u32 s30, s30, 167772160
mr_54:
    s_cmp_lg_u32 s49, 4
    s_cbranch_scc1 mr_55
    s_load_dwordx2 s[16:17], s[0:1], 64
    s_mov_b32 s18, 2097152
    s_mov_b32 s19, 0x00020000
    s_waitcnt lgkmcnt(0)
    s_mov_b32 s12, s8
    s_mov_b32 s13, s9
    s_mov_b32 s14, s10
    s_mov_b32 s15, s11
    s_mov_b32 s20, s8
    s_mov_b32 s21, s9
    s_mov_b32 s22, s10
    s_mov_b32 s23, s11
    s_mov_b32 s24, s8
    s_mov_b32 s25, s9
    s_mov_b32 s26, s10
    s_mov_b32 s27, s11
    s_mul_i32 s44, s94, 8
    s_add_u32 s44, s44, s95
    s_lshl_b32 s44, s44, 2
    s_add_u32 s83, s44, 84106240
    s_mov_b32 s31, 2048
    s_mov_b32 s32, 2048
    s_mov_b32 s33, 2048
    s_mov_b32 s34, 16
    s_mov_b32 s51, 0
    s_mov_b32 s40, 1
    s_mov_b32 s75, s78
    s_cmp_eq_u32 s79, 7
    s_cselect_b32 s76, 19, 16
    s_lshl_b32 s28, s70, 11
    s_add_u32 s28, s28, 96468992
    s_lshl_b32 s29, s95, 8
    s_mul_i32 s30, s70, 2048
    s_add_u32 s30, s30, s29
    s_add_u32 s30, s30, 100667392
mr_55:
    s_cmp_lg_u32 s49, 5
    s_cbranch_scc1 mr_56
    s_load_dwordx2 s[16:17], s[0:1], 72
    s_mov_b32 s18, 2097152
    s_mov_b32 s19, 0x00020000
    s_waitcnt lgkmcnt(0)
    s_mov_b32 s12, s8
    s_mov_b32 s13, s9
    s_mov_b32 s14, s10
    s_mov_b32 s15, s11
    s_mov_b32 s20, s8
    s_mov_b32 s21, s9
    s_mov_b32 s22, s10
    s_mov_b32 s23, s11
    s_mov_b32 s24, s8
    s_mov_b32 s25, s9
    s_mov_b32 s26, s10
    s_mov_b32 s27, s11
    s_mul_i32 s44, s94, 8
    s_add_u32 s44, s44, s95
    s_lshl_b32 s44, s44, 2
    s_add_u32 s83, s44, 84107328
    s_mov_b32 s31, 2048
    s_mov_b32 s32, 2048
    s_mov_b32 s33, 2048
    s_mov_b32 s34, 16
    s_mov_b32 s51, 2048
    s_mov_b32 s40, 2
    s_mov_b32 s75, s78
    s_cmp_eq_u32 s79, 7
    s_cselect_b32 s76, 19, 16
    s_lshl_b32 s28, s70, 11
    s_add_u32 s28, s28, 100665344
    s_lshl_b32 s29, s95, 8
    s_mul_i32 s30, s70, 2048
    s_add_u32 s30, s30, s29
    s_add_u32 s38, s30, 92274688
    s_add_u32 s30, s30, 106954752
mr_56:
    s_cmp_lg_u32 s49, 7
    s_cbranch_scc1 mr_57
    s_load_dwordx2 s[16:17], s[0:1], 80
    s_mov_b32 s18, 7340032
    s_mov_b32 s19, 0x00020000
    s_waitcnt lgkmcnt(0)
    s_mov_b32 s12, s8
    s_mov_b32 s13, s9
    s_mov_b32 s14, s10
    s_mov_b32 s15, s11
    s_mov_b32 s20, s8
    s_mov_b32 s21, s9
    s_mov_b32 s22, s10
    s_mov_b32 s23, s11
    s_mov_b32 s24, s8
    s_mov_b32 s25, s9
    s_mov_b32 s26, s10
    s_mov_b32 s27, s11
    s_mul_i32 s44, s94, 32
    s_add_u32 s44, s44, s95
    s_lshl_b32 s44, s44, 2
    s_add_u32 s83, s44, 84112768
    s_mov_b32 s31, 2048
    s_mov_b32 s32, 7168
    s_mov_b32 s33, 7168
    s_mov_b32 s34, 16
    s_mov_b32 s51, 0
    s_mov_b32 s40, 1
    s_mov_b32 s75, s78
    s_cmp_eq_u32 s79, 7
    s_cselect_b32 s76, 19, 16
    s_lshl_b32 s28, s70, 11
    s_add_u32 s28, s28, 111149056
    s_lshl_b32 s29, s95, 8
    s_mul_i32 s30, s70, 7168
    s_add_u32 s30, s30, s29
    s_add_u32 s30, s30, 115343360
mr_57:
    v_and_b32 v1, 63, v0
    v_lshrrev_b32 v24, 6, v0
    s_nop 0
    v_readfirstlane_b32 s41, v24
    v_lshrrev_b32 v2, 4, v1
    v_and_b32 v3, 15, v1
    s_nop 1
    v_lshrrev_b32 v24, 3, v1
    v_and_b32 v25, 7, v1
    v_xor_b32 v25, v25, v24
    v_lshlrev_b32 v25, 4, v25
    s_mul_i32 s44, s41, 16
    s_add_u32 s45, s44, 0
    v_add_u32 v26, s45, v24
    v_mul_lo_u32 v26, v26, s31
    v_add_u32 v26, v26, v25
    v_subrev_u32 v4, 0, v26
    s_add_u32 s45, s44, 8
    v_add_u32 v26, s45, v24
    v_mul_lo_u32 v26, v26, s31
    v_add_u32 v26, v26, v25
    v_subrev_u32 v5, 1024, v26
    s_mul_i32 s54, s41, 2048
    v_and_b32 v24, 7, v3
    v_xor_b32 v24, v24, v2
    v_lshlrev_b32 v24, 4, v24
    v_lshl_add_u32 v8, v3, 7, v24
    v_xor_b32 v9, 64, v8
    v_add_u32 v10, 65536, v8
    v_add_u32 v11, 65536, v9
    v_lshrrev_b32 v250, 6, v0
    s_nop 0
    v_readfirstlane_b32 s90, v250
    s_nop 3
    s_cmp_lg_u32 s90, 0
    s_cbranch_scc1 wf_58
    v_cmp_gt_u32 vcc, s89, v0
    s_mov_b64 s[92:93], vcc
    v_lshlrev_b32 v250, 2, v0
    s_mov_b32 s90, 0
    s_mov_b64 exec, s[92:93]
wl_59:
    buffer_load_dword v251, v250, s[8:11], s88 offen sc1
    s_add_u32 s90, s90, 1
    s_cmp_gt_u32 s90, 4194304
    s_cbranch_scc1 worker_abort
    s_waitcnt vmcnt(0)
    v_cmp_eq_u32 vcc, 0, v251
    s_cbranch_vccz wl_59_ok
    s_sleep 4
    s_branch wl_59
wl_59_ok:
    s_mov_b64 exec, -1
wf_58:
    s_barrier
    s_branch gemm_main_s
att_loop:
    s_bfe_u32 s97, s58, 0x50011
    s_bfe_u32 s73, s58, 0x60016
    s_bfe_u32 s74, s58, 0x60008
    s_cmp_eq_u32 s74, 0
    s_cselect_b32 s74, 64, s74
att_next:
    s_cmp_ge_u32 s73, s74
    s_cbranch_scc1 att_fin
    s_mov_b32 s94, s73
    s_and_b32 s95, s97, 7
    s_add_u32 s73, s73, 2
    v_lshrrev_b32 v250, 6, v0
    s_nop 0
    v_readfirstlane_b32 s90, v250
    s_nop 3
    s_cmp_lg_u32 s90, 0
    s_cbranch_scc1 ad_60
    s_lshr_b32 s49, s94, 2
    s_mul_i32 s44, s49, 384
    s_lshl_b32 s45, s95, 4
    s_add_u32 s44, s44, s45
    s_add_u32 s44, s44, 84082688
    v_lshrrev_b32 v248, 2, v0
    v_lshlrev_b32 v248, 7, v248
    v_and_b32 v249, 3, v0
    v_lshl_add_u32 v248, v249, 2, v248
    v_add_u32 v248, s44, v248
    s_lshl_b32 s44, s94, 10
    s_lshl_b32 s45, s95, 7
    s_add_u32 s44, s44, s45
    s_add_u32 s44, s44, 84017024
    v_lshlrev_b32 v249, 2, v0
    v_add_u32 v249, s44, v249
    v_cmp_gt_u32 vcc, 32, v0
    s_nop 1
    v_cndmask_b32 v250, v249, v248, vcc
    s_mov_b32 s92, 0xfff
    s_mov_b32 s93, -1
    s_mov_b64 exec, s[92:93]
    s_mov_b32 s90, 0
ap_61:
    buffer_load_dword v251, v250, s[8:11], 0 offen sc1
    s_add_u32 s90, s90, 1
    s_cmp_gt_u32 s90, 4194304
    s_cbranch_scc1 worker_abort
    s_waitcnt vmcnt(0)
    v_cmp_eq_u32 vcc, 0, v251
    s_cbranch_vccz ap_61_ok
    s_sleep 2
    s_branch ap_61
ap_61_ok:
    s_mov_b64 exec, -1
ad_60:
    s_barrier
    s_lshr_b32 s44, s94, 1
    s_lshl_b32 s44, s44, 5
    s_and_b32 s45, s94, 1
    s_lshl_b32 s45, s45, 3
    s_add_u32 s44, s44, s45
    s_add_u32 s44, s44, s95
    s_lshl_b32 s44, s44, 2
    s_add_u32 s83, s44, 84088832
    s_mov_b32 s56, s94
    s_lshl_b32 s57, s95, 2
    s_mov_b32 s84, 3
    v_and_b32 v1, 63, v0
    v_lshrrev_b32 v4, 6, v0
    s_nop 0
    v_readfirstlane_b32 s41, v4
    v_lshrrev_b32 v2, 4, v1
    v_and_b32 v3, 15, v1
    s_nop 1
    s_add_u32 s49, s57, s41
    s_mul_i32 s48, s41, 27648
    s_lshl_b32 s44, s56, 18
    s_lshl_b32 s45, s49, 8
    s_add_u32 s44, s44, s45
    v_add_u32 v4, 0, v2
    v_xor_b32 v5, v4, v3
    v_lshlrev_b32 v5, 4, v5
    v_lshl_add_u32 v5, v4, 13, v5
    v_subrev_u32 v8, 0, v5
    v_and_b32 v6, 7, v4
    v_lshrrev_b32 v7, 1, v3
    v_xor_b32 v6, v6, v7
    v_lshlrev_b32 v6, 5, v6
    v_and_b32 v7, 1, v3
    v_lshl_add_u32 v6, v7, 4, v6
    v_lshl_add_u32 v6, v4, 13, v6
    v_subrev_u32 v16, 0, v6
    v_add_u32 v4, 4, v2
    v_xor_b32 v5, v4, v3
    v_lshlrev_b32 v5, 4, v5
    v_lshl_add_u32 v5, v4, 13, v5
    v_subrev_u32 v9, 1024, v5
    v_and_b32 v6, 7, v4
    v_lshrrev_b32 v7, 1, v3
    v_xor_b32 v6, v6, v7
    v_lshlrev_b32 v6, 5, v6
    v_and_b32 v7, 1, v3
    v_lshl_add_u32 v6, v7, 4, v6
    v_lshl_add_u32 v6, v4, 13, v6
    v_subrev_u32 v17, 1024, v6
    v_add_u32 v4, 8, v2
    v_xor_b32 v5, v4, v3
    v_lshlrev_b32 v5, 4, v5
    v_lshl_add_u32 v5, v4, 13, v5
    v_subrev_u32 v10, 2048, v5
    v_and_b32 v6, 7, v4
    v_lshrrev_b32 v7, 1, v3
    v_xor_b32 v6, v6, v7
    v_lshlrev_b32 v6, 5, v6
    v_and_b32 v7, 1, v3
    v_lshl_add_u32 v6, v7, 4, v6
    v_lshl_add_u32 v6, v4, 13, v6
    v_subrev_u32 v18, 2048, v6
    v_add_u32 v4, 12, v2
    v_xor_b32 v5, v4, v3
    v_lshlrev_b32 v5, 4, v5
    v_lshl_add_u32 v5, v4, 13, v5
    v_subrev_u32 v11, 3072, v5
    v_and_b32 v6, 7, v4
    v_lshrrev_b32 v7, 1, v3
    v_xor_b32 v6, v6, v7
    v_lshlrev_b32 v6, 5, v6
    v_and_b32 v7, 1, v3
    v_lshl_add_u32 v6, v7, 4, v6
    v_lshl_add_u32 v6, v4, 13, v6
    v_subrev_u32 v19, 3072, v6
    s_add_u32 m0, s48, 0
    s_add_u32 s46, s44, 4194304
    buffer_load_dwordx4 v8, s[8:11], s46 offen offset:0 sc1 lds
    buffer_load_dwordx4 v9, s[8:11], s46 offen offset:1024 sc1 lds
    buffer_load_dwordx4 v10, s[8:11], s46 offen offset:2048 sc1 lds
    buffer_load_dwordx4 v11, s[8:11], s46 offen offset:3072 sc1 lds
    s_add_u32 m0, s48, 4096
    s_add_u32 s46, s44, 4325376
    buffer_load_dwordx4 v8, s[8:11], s46 offen offset:0 sc1 lds
    buffer_load_dwordx4 v9, s[8:11], s46 offen offset:1024 sc1 lds
    buffer_load_dwordx4 v10, s[8:11], s46 offen offset:2048 sc1 lds
    buffer_load_dwordx4 v11, s[8:11], s46 offen offset:3072 sc1 lds
    s_add_u32 m0, s48, 8192
    s_add_u32 s46, s44, 20971520
    buffer_load_dwordx4 v8, s[8:11], s46 offen offset:0 sc1 lds
    buffer_load_dwordx4 v9, s[8:11], s46 offen offset:1024 sc1 lds
    buffer_load_dwordx4 v10, s[8:11], s46 offen offset:2048 sc1 lds
    buffer_load_dwordx4 v11, s[8:11], s46 offen offset:3072 sc1 lds
    s_add_u32 m0, s48, 12288
    s_add_u32 s46, s44, 21102592
    buffer_load_dwordx4 v8, s[8:11], s46 offen offset:0 sc1 lds
    buffer_load_dwordx4 v9, s[8:11], s46 offen offset:1024 sc1 lds
    buffer_load_dwordx4 v10, s[8:11], s46 offen offset:2048 sc1 lds
    buffer_load_dwordx4 v11, s[8:11], s46 offen offset:3072 sc1 lds
    s_add_u32 m0, s48, 16384
    s_add_u32 s46, s44, 37748736
    buffer_load_dwordx4 v16, s[8:11], s46 offen offset:0 sc1 lds
    buffer_load_dwordx4 v17, s[8:11], s46 offen offset:1024 sc1 lds
    buffer_load_dwordx4 v18, s[8:11], s46 offen offset:2048 sc1 lds
    buffer_load_dwordx4 v19, s[8:11], s46 offen offset:3072 sc1 lds
    s_add_u32 m0, s48, 20480
    s_add_u32 s46, s44, 37879808
    buffer_load_dwordx4 v16, s[8:11], s46 offen offset:0 sc1 lds
    buffer_load_dwordx4 v17, s[8:11], s46 offen offset:1024 sc1 lds
    buffer_load_dwordx4 v18, s[8:11], s46 offen offset:2048 sc1 lds
    buffer_load_dwordx4 v19, s[8:11], s46 offen offset:3072 sc1 lds
    s_lshl_b32 s46, s56, 16
    s_add_u32 s46, s46, s45
    s_add_u32 s46, s46, 54525952
    s_add_u32 m0, s48, 24576
    s_nop 0
    buffer_load_dwordx4 v8, s[8:11], s46 offen offset:0 sc1 lds
    buffer_load_dwordx4 v9, s[8:11], s46 offen offset:1024 sc1 lds
    s_lshl_b32 s46, s56, 5
    s_add_u32 s46, s46, s49
    s_lshl_b32 s46, s46, 11
    s_add_u32 s46, s46, 58720256
    v_lshlrev_b32 v4, 2, v1
    buffer_load_dword v96, v4, s[8:11], s46 offen offset:0 sc1
    v_mov_b32 v97, 0
    buffer_load_dword v98, v4, s[8:11], s46 offen offset:256 sc1
    v_mov_b32 v99, 0
    buffer_load_dword v100, v4, s[8:11], s46 offen offset:512 sc1
    v_mov_b32 v101, 0
    buffer_load_dword v102, v4, s[8:11], s46 offen offset:768 sc1
    v_mov_b32 v103, 0
    buffer_load_dword v104, v4, s[8:11], s46 offen offset:1024 sc1
    v_mov_b32 v105, 0
    buffer_load_dword v106, v4, s[8:11], s46 offen offset:1280 sc1
    v_mov_b32 v107, 0
    buffer_load_dword v108, v4, s[8:11], s46 offen offset:1536 sc1
    v_mov_b32 v109, 0
    buffer_load_dword v110, v4, s[8:11], s46 offen offset:1792 sc1
    v_mov_b32 v111, 0
    v_xor_b32 v4, v2, v3
    v_lshlrev_b32 v4, 4, v4
    v_lshl_add_u32 v4, v3, 8, v4
    v_add_u32 v20, s48, v4
    v_xor_b32 v21, 64, v20
    v_xor_b32 v22, 128, v20
    v_xor_b32 v23, 192, v20
    v_lshrrev_b32 v5, 2, v3
    v_lshlrev_b32 v5, 1, v5
    v_and_b32 v4, 1, v3
    v_add_u32 v5, v5, v4
    v_xor_b32 v4, v2, v5
    v_lshlrev_b32 v4, 4, v4
    v_lshl_add_u32 v4, v5, 8, v4
    v_add_u32 v24, s48, v4
    v_add_u32 v24, 24576, v24
    v_xor_b32 v25, 64, v24
    v_xor_b32 v26, 128, v24
    v_xor_b32 v27, 192, v24
    v_lshrrev_b32 v4, 2, v3
    v_lshl_add_u32 v4, v2, 2, v4
    v_and_b32 v5, 7, v4
    v_lshlrev_b32 v5, 5, v5
    v_lshl_add_u32 v5, v4, 8, v5
    v_and_b32 v6, 3, v3
    v_lshl_add_u32 v5, v6, 3, v5
    v_add_u32 v28, s48, v5
    v_add_u32 v28, 16384, v28
    s_waitcnt vmcnt(0)
    ds_read_b128 v[32:35], v20 offset:0
    ds_read_b128 v[36:39], v21 offset:0
    ds_read_b128 v[40:43], v22 offset:0
    ds_read_b128 v[44:47], v23 offset:0
    ds_read_b128 v[48:51], v20 offset:4096
    ds_read_b128 v[52:55], v21 offset:4096
    ds_read_b128 v[56:59], v22 offset:4096
    ds_read_b128 v[60:63], v23 offset:4096
    ds_read_b128 v[64:67], v20 offset:8192
    ds_read_b128 v[68:71], v21 offset:8192
    ds_read_b128 v[72:75], v22 offset:8192
    ds_read_b128 v[76:79], v23 offset:8192
    s_waitcnt lgkmcnt(8)
    ds_read_b128 v[80:83], v20 offset:12288
    ds_read_b128 v[84:87], v21 offset:12288
    ds_read_b128 v[88:91], v22 offset:12288
    ds_read_b128 v[92:95], v23 offset:12288
    s_waitcnt lgkmcnt(8)
    ds_read_b128 v[112:115], v24
    ds_read_b128 v[116:119], v25
    ds_read_b128 v[120:123], v26
    ds_read_b128 v[124:127], v27
    s_waitcnt lgkmcnt(0)
    v_mfma_f32_16x16x32_bf16 v[128:131], v[112:115], v[32:35], 0
    v_mfma_f32_16x16x32_bf16 v[132:135], v[64:67], v[32:35], 0
    v_mfma_f32_16x16x32_bf16 v[136:139], v[112:115], v[48:51], 0
    v_mfma_f32_16x16x32_bf16 v[140:143], v[64:67], v[48:51], 0
    v_mfma_f32_16x16x32_bf16 v[144:147], v[80:83], v[48:51], 0
    v_mfma_f32_16x16x32_bf16 v[128:131], v[116:119], v[36:39], v[128:131]
    v_mfma_f32_16x16x32_bf16 v[132:135], v[68:71], v[36:39], v[132:135]
    v_mfma_f32_16x16x32_bf16 v[136:139], v[116:119], v[52:55], v[136:139]
    v_mfma_f32_16x16x32_bf16 v[140:143], v[68:71], v[52:55], v[140:143]
    v_mfma_f32_16x16x32_bf16 v[144:147], v[84:87], v[52:55], v[144:147]
    v_mfma_f32_16x16x32_bf16 v[128:131], v[120:123], v[40:43], v[128:131]
    v_mfma_f32_16x16x32_bf16 v[132:135], v[72:75], v[40:43], v[132:135]
    v_mfma_f32_16x16x32_bf16 v[136:139], v[120:123], v[56:59], v[136:139]
    v_mfma_f32_16x16x32_bf16 v[140:143], v[72:75], v[56:59], v[140:143]
    v_mfma_f32_16x16x32_bf16 v[144:147], v[88:91], v[56:59], v[144:147]
    v_mfma_f32_16x16x32_bf16 v[128:131], v[124:127], v[44:47], v[128:131]
    v_mfma_f32_16x16x32_bf16 v[132:135], v[76:79], v[44:47], v[132:135]
    v_mfma_f32_16x16x32_bf16 v[136:139], v[124:127], v[60:63], v[136:139]
    v_mfma_f32_16x16x32_bf16 v[140:143], v[76:79], v[60:63], v[140:143]
    v_mfma_f32_16x16x32_bf16 v[144:147], v[92:95], v[60:63], v[144:147]
    v_xor_b32 v4, 0, v28
    ds_read_b64_tr_b16 v[148:149], v4 offset:0
    ds_read_b64_tr_b16 v[150:151], v4 offset:4096
    v_xor_b32 v5, 32, v28
    ds_read_b64_tr_b16 v[152:153], v5 offset:0
    ds_read_b64_tr_b16 v[154:155], v5 offset:4096
    v_xor_b32 v4, 64, v28
    ds_read_b64_tr_b16 v[156:157], v4 offset:0
    ds_read_b64_tr_b16 v[158:159], v4 offset:4096
    v_xor_b32 v5, 96, v28
    ds_read_b64_tr_b16 v[160:161], v5 offset:0
    ds_read_b64_tr_b16 v[162:163], v5 offset:4096
    v_xor_b32 v4, 128, v28
    ds_read_b64_tr_b16 v[164:165], v4 offset:0
    ds_read_b64_tr_b16 v[166:167], v4 offset:4096
    v_xor_b32 v5, 160, v28
    ds_read_b64_tr_b16 v[168:169], v5 offset:0
    ds_read_b64_tr_b16 v[170:171], v5 offset:4096
    v_xor_b32 v4, 192, v28
    ds_read_b64_tr_b16 v[172:173], v4 offset:0
    ds_read_b64_tr_b16 v[174:175], v4 offset:4096
    v_xor_b32 v5, 224, v28
    ds_read_b64_tr_b16 v[176:177], v5 offset:0
    ds_read_b64_tr_b16 v[178:179], v5 offset:4096
    v_lshlrev_b32 v6, 2, v2
    v_mov_b32 v30, 0xf149f2ca
    v_add_u32 v7, 0, v6
    v_cmp_gt_u32 vcc, v7, v3
    s_nop 1
    v_cndmask_b32 v132, v132, v30, vcc
    v_cndmask_b32 v144, v144, v30, vcc
    v_add_u32 v7, 1, v6
    v_cmp_gt_u32 vcc, v7, v3
    s_nop 1
    v_cndmask_b32 v133, v133, v30, vcc
    v_cndmask_b32 v145, v145, v30, vcc
    v_add_u32 v7, 2, v6
    v_cmp_gt_u32 vcc, v7, v3
    s_nop 1
    v_cndmask_b32 v134, v134, v30, vcc
    v_cndmask_b32 v146, v146, v30, vcc
    v_add_u32 v7, 3, v6
    v_cmp_gt_u32 vcc, v7, v3
    s_nop 1
    v_cndmask_b32 v135, v135, v30, vcc
    v_cndmask_b32 v147, v147, v30, vcc
    v_mov_b32 v130, v30
    v_mov_b32 v131, v30
    v_mov_b32 v138, v30
    v_mov_b32 v139, v30
    s_mov_b32 s47, 0x3fb8aa3b
    s_mov_b32 s46, 0x3db504f3
    v_cvt_pk_bf16_f32 v193, v128, v129
    v_lshlrev_b32 v128, 16, v193
    v_and_b32 v129, 0xffff0000, v193
    v_cvt_pk_bf16_f32 v193, v130, v131
    v_lshlrev_b32 v130, 16, v193
    v_and_b32 v131, 0xffff0000, v193
    v_cvt_pk_bf16_f32 v193, v132, v133
    v_lshlrev_b32 v132, 16, v193
    v_and_b32 v133, 0xffff0000, v193
    v_cvt_pk_bf16_f32 v193, v134, v135
    v_lshlrev_b32 v134, 16, v193
    v_and_b32 v135, 0xffff0000, v193
    v_mul_f32 v128, s46, v128
    v_mul_f32 v129, s46, v129
    v_mul_f32 v130, s46, v130
    v_mul_f32 v131, s46, v131
    v_mul_f32 v132, s46, v132
    v_mul_f32 v133, s46, v133
    v_mul_f32 v134, s46, v134
    v_mul_f32 v135, s46, v135
    v_cvt_pk_bf16_f32 v193, v128, v129
    v_lshlrev_b32 v128, 16, v193
    v_and_b32 v129, 0xffff0000, v193
    v_cvt_pk_bf16_f32 v193, v130, v131
    v_lshlrev_b32 v130, 16, v193
    v_and_b32 v131, 0xffff0000, v193
    v_cvt_pk_bf16_f32 v193, v132, v133
    v_lshlrev_b32 v132, 16, v193
    v_and_b32 v133, 0xffff0000, v193
    v_cvt_pk_bf16_f32 v193, v134, v135
    v_lshlrev_b32 v134, 16, v193
    v_and_b32 v135, 0xffff0000, v193
    v_max3_f32 v192, v128, v129, v130
    v_max3_f32 v192, v192, v131, v132
    v_max3_f32 v192, v192, v133, v134
    v_max_f32 v192, v192, v135
    v_mov_b32 v193, v192
    s_nop 1
    v_permlane32_swap_b32 v192, v193
    s_nop 0
    v_max_f32 v192, v192, v193
    v_mov_b32 v193, v192
    s_nop 1
    v_permlane16_swap_b32 v192, v193
    s_nop 0
    v_max_f32 v192, v192, v193
    v_sub_f32 v128, v128, v192
    v_sub_f32 v129, v129, v192
    v_sub_f32 v130, v130, v192
    v_sub_f32 v131, v131, v192
    v_sub_f32 v132, v132, v192
    v_sub_f32 v133, v133, v192
    v_sub_f32 v134, v134, v192
    v_sub_f32 v135, v135, v192
    v_mul_f32 v128, s47, v128
    v_mul_f32 v129, s47, v129
    v_mul_f32 v130, s47, v130
    v_mul_f32 v131, s47, v131
    v_mul_f32 v132, s47, v132
    v_mul_f32 v133, s47, v133
    v_mul_f32 v134, s47, v134
    v_mul_f32 v135, s47, v135
    v_exp_f32 v128, v128
    v_exp_f32 v129, v129
    v_exp_f32 v130, v130
    v_exp_f32 v131, v131
    v_exp_f32 v132, v132
    v_exp_f32 v133, v133
    v_exp_f32 v134, v134
    v_exp_f32 v135, v135
    s_nop 0
    v_add_f32 v192, v128, v129
    v_add_f32 v192, v192, v130
    v_add_f32 v192, v192, v131
    v_add_f32 v192, v192, v132
    v_add_f32 v192, v192, v133
    v_add_f32 v192, v192, v134
    v_add_f32 v192, v192, v135
    v_mov_b32 v193, v192
    s_nop 1
    v_permlane32_swap_b32 v192, v193
    s_nop 0
    v_add_f32 v192, v192, v193
    v_mov_b32 v193, v192
    s_nop 1
    v_permlane16_swap_b32 v192, v193
    s_nop 0
    v_add_f32 v192, v192, v193
    v_rcp_f32 v192, v192
    s_nop 0
    v_mul_f32 v128, v128, v192
    v_mul_f32 v129, v129, v192
    v_mul_f32 v130, v130, v192
    v_mul_f32 v131, v131, v192
    v_mul_f32 v132, v132, v192
    v_mul_f32 v133, v133, v192
    v_mul_f32 v134, v134, v192
    v_mul_f32 v135, v135, v192
    v_cvt_pk_bf16_f32 v180, v128, v129
    v_cvt_pk_bf16_f32 v181, v130, v131
    v_cvt_pk_bf16_f32 v182, v132, v133
    v_cvt_pk_bf16_f32 v183, v134, v135
    v_cvt_pk_bf16_f32 v193, v136, v137
    v_lshlrev_b32 v136, 16, v193
    v_and_b32 v137, 0xffff0000, v193
    v_cvt_pk_bf16_f32 v193, v138, v139
    v_lshlrev_b32 v138, 16, v193
    v_and_b32 v139, 0xffff0000, v193
    v_cvt_pk_bf16_f32 v193, v140, v141
    v_lshlrev_b32 v140, 16, v193
    v_and_b32 v141, 0xffff0000, v193
    v_cvt_pk_bf16_f32 v193, v142, v143
    v_lshlrev_b32 v142, 16, v193
    v_and_b32 v143, 0xffff0000, v193
    v_cvt_pk_bf16_f32 v193, v144, v145
    v_lshlrev_b32 v144, 16, v193
    v_and_b32 v145, 0xffff0000, v193
    v_cvt_pk_bf16_f32 v193, v146, v147
    v_lshlrev_b32 v146, 16, v193
    v_and_b32 v147, 0xffff0000, v193
    v_mul_f32 v136, s46, v136
    v_mul_f32 v137, s46, v137
    v_mul_f32 v138, s46, v138
    v_mul_f32 v139, s46, v139
    v_mul_f32 v140, s46, v140
    v_mul_f32 v141, s46, v141
    v_mul_f32 v142, s46, v142
    v_mul_f32 v143, s46, v143
    v_mul_f32 v144, s46, v144
    v_mul_f32 v145, s46, v145
    v_mul_f32 v146, s46, v146
    v_mul_f32 v147, s46, v147
    v_cvt_pk_bf16_f32 v193, v136, v137
    v_lshlrev_b32 v136, 16, v193
    v_and_b32 v137, 0xffff0000, v193
    v_cvt_pk_bf16_f32 v193, v138, v139
    v_lshlrev_b32 v138, 16, v193
    v_and_b32 v139, 0xffff0000, v193
    v_cvt_pk_bf16_f32 v193, v140, v141
    v_lshlrev_b32 v140, 16, v193
    v_and_b32 v141, 0xffff0000, v193
    v_cvt_pk_bf16_f32 v193, v142, v143
    v_lshlrev_b32 v142, 16, v193
    v_and_b32 v143, 0xffff0000, v193
    v_cvt_pk_bf16_f32 v193, v144, v145
    v_lshlrev_b32 v144, 16, v193
    v_and_b32 v145, 0xffff0000, v193
    v_cvt_pk_bf16_f32 v193, v146, v147
    v_lshlrev_b32 v146, 16, v193
    v_and_b32 v147, 0xffff0000, v193
    v_max3_f32 v192, v136, v137, v138
    v_max3_f32 v192, v192, v139, v140
    v_max3_f32 v192, v192, v141, v142
    v_max3_f32 v192, v192, v143, v144
    v_max3_f32 v192, v192, v145, v146
    v_max_f32 v192, v192, v147
    v_mov_b32 v193, v192
    s_nop 1
    v_permlane32_swap_b32 v192, v193
    s_nop 0
    v_max_f32 v192, v192, v193
    v_mov_b32 v193, v192
    s_nop 1
    v_permlane16_swap_b32 v192, v193
    s_nop 0
    v_max_f32 v192, v192, v193
    v_sub_f32 v136, v136, v192
    v_sub_f32 v137, v137, v192
    v_sub_f32 v138, v138, v192
    v_sub_f32 v139, v139, v192
    v_sub_f32 v140, v140, v192
    v_sub_f32 v141, v141, v192
    v_sub_f32 v142, v142, v192
    v_sub_f32 v143, v143, v192
    v_sub_f32 v144, v144, v192
    v_sub_f32 v145, v145, v192
    v_sub_f32 v146, v146, v192
    v_sub_f32 v147, v147, v192
    v_mul_f32 v136, s47, v136
    v_mul_f32 v137, s47, v137
    v_mul_f32 v138, s47, v138
    v_mul_f32 v139, s47, v139
    v_mul_f32 v140, s47, v140
    v_mul_f32 v141, s47, v141
    v_mul_f32 v142, s47, v142
    v_mul_f32 v143, s47, v143
    v_mul_f32 v144, s47, v144
    v_mul_f32 v145, s47, v145
    v_mul_f32 v146, s47, v146
    v_mul_f32 v147, s47, v147
    v_exp_f32 v136, v136
    v_exp_f32 v137, v137
    v_exp_f32 v138, v138
    v_exp_f32 v139, v139
    v_exp_f32 v140, v140
    v_exp_f32 v141, v141
    v_exp_f32 v142, v142
    v_exp_f32 v143, v143
    v_exp_f32 v144, v144
    v_exp_f32 v145, v145
    v_exp_f32 v146, v146
    v_exp_f32 v147, v147
    s_nop 0
    v_add_f32 v192, v136, v137
    v_add_f32 v192, v192, v138
    v_add_f32 v192, v192, v139
    v_add_f32 v192, v192, v140
    v_add_f32 v192, v192, v141
    v_add_f32 v192, v192, v142
    v_add_f32 v192, v192, v143
    v_add_f32 v192, v192, v144
    v_add_f32 v192, v192, v145
    v_add_f32 v192, v192, v146
    v_add_f32 v192, v192, v147
    v_mov_b32 v193, v192
    s_nop 1
    v_permlane32_swap_b32 v192, v193
    s_nop 0
    v_add_f32 v192, v192, v193
    v_mov_b32 v193, v192
    s_nop 1
    v_permlane16_swap_b32 v192, v193
    s_nop 0
    v_add_f32 v192, v192, v193
    v_rcp_f32 v192, v192
    s_nop 0
    v_mul_f32 v136, v136, v192
    v_mul_f32 v137, v137, v192
    v_mul_f32 v138, v138, v192
    v_mul_f32 v139, v139, v192
    v_mul_f32 v140, v140, v192
    v_mul_f32 v141, v141, v192
    v_mul_f32 v142, v142, v192
    v_mul_f32 v143, v143, v192
    v_mul_f32 v144, v144, v192
    v_mul_f32 v145, v145, v192
    v_mul_f32 v146, v146, v192
    v_mul_f32 v147, v147, v192
    v_cvt_pk_bf16_f32 v184, v136, v137
    v_cvt_pk_bf16_f32 v185, v138, v139
    v_cvt_pk_bf16_f32 v186, v140, v141
    v_cvt_pk_bf16_f32 v187, v142, v143
    v_cvt_pk_bf16_f32 v188, v144, v145
    v_cvt_pk_bf16_f32 v189, v146, v147
    s_waitcnt lgkmcnt(0)
    v_mfma_f32_16x16x16_bf16 v[32:35], v[96:97], v[180:181], 0
    v_mfma_f32_16x16x16_bf16 v[36:39], v[98:99], v[180:181], 0
    v_mfma_f32_16x16x16_bf16 v[40:43], v[100:101], v[180:181], 0
    v_mfma_f32_16x16x16_bf16 v[44:47], v[102:103], v[180:181], 0
    v_mfma_f32_16x16x16_bf16 v[48:51], v[104:105], v[180:181], 0
    v_mfma_f32_16x16x16_bf16 v[52:55], v[106:107], v[180:181], 0
    v_mfma_f32_16x16x16_bf16 v[56:59], v[108:109], v[180:181], 0
    v_mfma_f32_16x16x16_bf16 v[60:63], v[110:111], v[180:181], 0
    v_mfma_f32_16x16x16_bf16 v[64:67], v[96:97], v[184:185], 0
    v_mfma_f32_16x16x16_bf16 v[68:71], v[98:99], v[184:185], 0
    v_mfma_f32_16x16x16_bf16 v[72:75], v[100:101], v[184:185], 0
    v_mfma_f32_16x16x16_bf16 v[76:79], v[102:103], v[184:185], 0
    v_mfma_f32_16x16x16_bf16 v[80:83], v[104:105], v[184:185], 0
    v_mfma_f32_16x16x16_bf16 v[84:87], v[106:107], v[184:185], 0
    v_mfma_f32_16x16x16_bf16 v[88:91], v[108:109], v[184:185], 0
    v_mfma_f32_16x16x16_bf16 v[92:95], v[110:111], v[184:185], 0
    v_mfma_f32_16x16x16_bf16 v[32:35], v[148:149], v[182:183], v[32:35]
    v_mfma_f32_16x16x16_bf16 v[36:39], v[152:153], v[182:183], v[36:39]
    v_mfma_f32_16x16x16_bf16 v[40:43], v[156:157], v[182:183], v[40:43]
    v_mfma_f32_16x16x16_bf16 v[44:47], v[160:161], v[182:183], v[44:47]
    v_mfma_f32_16x16x16_bf16 v[48:51], v[164:165], v[182:183], v[48:51]
    v_mfma_f32_16x16x16_bf16 v[52:55], v[168:169], v[182:183], v[52:55]
    v_mfma_f32_16x16x16_bf16 v[56:59], v[172:173], v[182:183], v[56:59]
    v_mfma_f32_16x16x16_bf16 v[60:63], v[176:177], v[182:183], v[60:63]
    v_mfma_f32_16x16x16_bf16 v[64:67], v[148:149], v[186:187], v[64:67]
    v_mfma_f32_16x16x16_bf16 v[68:71], v[152:153], v[186:187], v[68:71]
    v_mfma_f32_16x16x16_bf16 v[72:75], v[156:157], v[186:187], v[72:75]
    v_mfma_f32_16x16x16_bf16 v[76:79], v[160:161], v[186:187], v[76:79]
    v_mfma_f32_16x16x16_bf16 v[80:83], v[164:165], v[186:187], v[80:83]
    v_mfma_f32_16x16x16_bf16 v[84:87], v[168:169], v[186:187], v[84:87]
    v_mfma_f32_16x16x16_bf16 v[88:91], v[172:173], v[186:187], v[88:91]
    v_mfma_f32_16x16x16_bf16 v[92:95], v[176:177], v[186:187], v[92:95]
    v_mfma_f32_16x16x16_bf16 v[64:67], v[150:151], v[188:189], v[64:67]
    v_mfma_f32_16x16x16_bf16 v[68:71], v[154:155], v[188:189], v[68:71]
    v_mfma_f32_16x16x16_bf16 v[72:75], v[158:159], v[188:189], v[72:75]
    v_mfma_f32_16x16x16_bf16 v[76:79], v[162:163], v[188:189], v[76:79]
    v_mfma_f32_16x16x16_bf16 v[80:83], v[166:167], v[188:189], v[80:83]
    v_mfma_f32_16x16x16_bf16 v[84:87], v[170:171], v[188:189], v[84:87]
    v_mfma_f32_16x16x16_bf16 v[88:91], v[174:175], v[188:189], v[88:91]
    v_mfma_f32_16x16x16_bf16 v[92:95], v[178:179], v[188:189], v[92:95]
    s_nop 9
    v_mul_u32_u24 v4, 272, v3
    v_lshl_add_u32 v4, v2, 3, v4
    v_add_u32 v4, s48, v4
    v_cvt_pk_bf16_f32 v32, v32, v33
    v_cvt_pk_bf16_f32 v33, v34, v35
    ds_write_b64 v4, v[32:33] offset:0
    v_cvt_pk_bf16_f32 v36, v36, v37
    v_cvt_pk_bf16_f32 v37, v38, v39
    ds_write_b64 v4, v[36:37] offset:32
    v_cvt_pk_bf16_f32 v40, v40, v41
    v_cvt_pk_bf16_f32 v41, v42, v43
    ds_write_b64 v4, v[40:41] offset:64
    v_cvt_pk_bf16_f32 v44, v44, v45
    v_cvt_pk_bf16_f32 v45, v46, v47
    ds_write_b64 v4, v[44:45] offset:96
    v_cvt_pk_bf16_f32 v48, v48, v49
    v_cvt_pk_bf16_f32 v49, v50, v51
    ds_write_b64 v4, v[48:49] offset:128
    v_cvt_pk_bf16_f32 v52, v52, v53
    v_cvt_pk_bf16_f32 v53, v54, v55
    ds_write_b64 v4, v[52:53] offset:160
    v_cvt_pk_bf16_f32 v56, v56, v57
    v_cvt_pk_bf16_f32 v57, v58, v59
    ds_write_b64 v4, v[56:57] offset:192
    v_cvt_pk_bf16_f32 v60, v60, v61
    v_cvt_pk_bf16_f32 v61, v62, v63
    ds_write_b64 v4, v[60:61] offset:224
    v_cvt_pk_bf16_f32 v64, v64, v65
    v_cvt_pk_bf16_f32 v65, v66, v67
    ds_write_b64 v4, v[64:65] offset:4352
    v_cvt_pk_bf16_f32 v68, v68, v69
    v_cvt_pk_bf16_f32 v69, v70, v71
    ds_write_b64 v4, v[68:69] offset:4384
    v_cvt_pk_bf16_f32 v72, v72, v73
    v_cvt_pk_bf16_f32 v73, v74, v75
    ds_write_b64 v4, v[72:73] offset:4416
    v_cvt_pk_bf16_f32 v76, v76, v77
    v_cvt_pk_bf16_f32 v77, v78, v79
    ds_write_b64 v4, v[76:77] offset:4448
    v_cvt_pk_bf16_f32 v80, v80, v81
    v_cvt_pk_bf16_f32 v81, v82, v83
    ds_write_b64 v4, v[80:81] offset:4480
    v_cvt_pk_bf16_f32 v84, v84, v85
    v_cvt_pk_bf16_f32 v85, v86, v87
    ds_write_b64 v4, v[84:85] offset:4512
    v_cvt_pk_bf16_f32 v88, v88, v89
    v_cvt_pk_bf16_f32 v89, v90, v91
    ds_write_b64 v4, v[88:89] offset:4544
    v_cvt_pk_bf16_f32 v92, v92, v93
    v_cvt_pk_bf16_f32 v93, v94, v95
    ds_write_b64 v4, v[92:93] offset:4576
    v_mul_u32_u24 v5, 272, v2
    v_lshl_add_u32 v5, v3, 4, v5
    v_add_u32 v5, s48, v5
    v_lshlrev_b32 v6, 13, v2
    v_lshl_add_u32 v6, v3, 4, v6
    s_waitcnt lgkmcnt(0)
    ds_read_b128 v[96:99], v5 offset:0
    ds_read_b128 v[100:103], v5 offset:1088
    ds_read_b128 v[104:107], v5 offset:2176
    ds_read_b128 v[108:111], v5 offset:3264
    ds_read_b128 v[112:115], v5 offset:4352
    ds_read_b128 v[116:119], v5 offset:5440
    ds_read_b128 v[120:123], v5 offset:6528
    ds_read_b128 v[124:127], v5 offset:7616
    s_waitcnt lgkmcnt(0)
    s_add_u32 s46, s44, 62914560
    buffer_store_dwordx4 v[96:99], v6, s[8:11], s46 offen sc1
    s_add_u32 s46, s44, 62947328
    buffer_store_dwordx4 v[100:103], v6, s[8:11], s46 offen sc1
    s_add_u32 s46, s44, 62980096
    buffer_store_dwordx4 v[104:107], v6, s[8:11], s46 offen sc1
    s_add_u32 s46, s44, 63012864
    buffer_store_dwordx4 v[108:111], v6, s[8:11], s46 offen sc1
    s_add_u32 s46, s44, 63045632
    buffer_store_dwordx4 v[112:115], v6, s[8:11], s46 offen sc1
    s_add_u32 s46, s44, 63078400
    buffer_store_dwordx4 v[116:119], v6, s[8:11], s46 offen sc1
    s_add_u32 s46, s44, 63111168
    buffer_store_dwordx4 v[120:123], v6, s[8:11], s46 offen sc1
    s_add_u32 s46, s44, 63143936
    buffer_store_dwordx4 v[124:127], v6, s[8:11], s46 offen sc1
    s_branch unit_done
att_fin:
    s_mov_b32 s58, 0
    s_branch ms_next
u_rowloop:
    s_bfe_u32 s97, s58, 0x50011
    s_mov_b32 s58, 0
    s_mov_b32 s59, 0
    s_mov_b32 s91, 0
rl_top:
    s_cmp_ge_u32 s91, 16
    s_cbranch_scc1 L_exit_main
    v_lshrrev_b32 v250, 6, v0
    s_nop 0
    v_readfirstlane_b32 s90, v250
    s_nop 3
    s_cmp_lg_u32 s90, 0
    s_cbranch_scc1 rl_wait
    v_lshlrev_b32 v250, 2, v0
    s_mov_b32 s90, 0
rl_poll:
    s_lshr_b32 s45, s97, 4
    s_min_u32 s44, s58, 15
    s_lshl_b32 s44, s44, 1
    s_add_u32 s44, s44, s45
    s_lshl_b32 s44, s44, 8
    s_add_u32 s44, s44, 84093184
    buffer_load_dword v247, v250, s[8:11], s44 offen sc1
    s_min_u32 s44, s59, 15
    s_lshl_b32 s44, s44, 1
    s_add_u32 s44, s44, s45
    s_lshl_b32 s44, s44, 5
    s_add_u32 s44, s44, 84107328
    buffer_load_dword v248, v250, s[8:11], s44 offen sc1
    s_min_u32 s44, s91, 15
    s_lshl_b32 s44, s44, 1
    s_add_u32 s44, s44, s45
    s_lshl_b32 s44, s44, 8
    s_add_u32 s44, s44, 84117120
    buffer_load_dword v249, v250, s[8:11], s44 offen sc1
    s_add_u32 s90, s90, 1
    s_cmp_gt_u32 s90, 4194304
    s_cbranch_scc1 worker_abort
    s_waitcnt vmcnt(0)
    s_mov_b32 s49, 0
    s_cmp_lg_u32 s49, 0
    s_cbranch_scc1 rn_62
    s_cmp_ge_u32 s58, 16
    s_cbranch_scc1 rn_62
    v_cmp_eq_u32 vcc, 0, v247
    s_and_b32 vcc_hi, vcc_hi, 0xffff
    s_cmp_lg_u64 vcc, 0
    s_cbranch_scc1 rn_62
    s_mov_b32 s49, 1
rn_62:
    s_cmp_lg_u32 s49, 0
    s_cbranch_scc1 rn_63
    s_cmp_ge_u32 s59, 16
    s_cbranch_scc1 rn_63
    v_cmp_eq_u32 vcc, 0, v248
    s_and_b32 vcc_lo, vcc_lo, 0xff
    s_mov_b32 vcc_hi, 0
    s_cmp_lg_u64 vcc, 0
    s_cbranch_scc1 rn_63
    s_mov_b32 s49, 2
rn_63:
    s_cmp_lg_u32 s49, 0
    s_cbranch_scc1 rn_64
    s_cmp_ge_u32 s91, 16
    s_cbranch_scc1 rn_64
    v_cmp_eq_u32 vcc, 0, v249
    s_and_b32 vcc_hi, vcc_hi, 0xffff
    s_cmp_lg_u64 vcc, 0
    s_cbranch_scc1 rn_64
    s_mov_b32 s49, 3
rn_64:
    s_cmp_lg_u32 s49, 0
    s_cbranch_scc1 rl_got
    s_sleep 2
    s_branch rl_poll
rl_got:
    v_mov_b32 v250, 163832
    v_mov_b32 v251, s49
    s_mov_b64 exec, 1
    ds_write_b32 v250, v251
    s_mov_b64 exec, -1
    s_waitcnt lgkmcnt(0)
rl_wait:
    s_barrier
    v_mov_b32 v250, 163832
    ds_read_b32 v251, v250
    s_waitcnt lgkmcnt(0)
    v_readfirstlane_b32 s49, v251
    s_barrier
    s_mov_b32 s84, 2
    s_cmp_eq_u32 s49, 2
    s_cbranch_scc1 rl_2
    s_cmp_eq_u32 s49, 3
    s_cbranch_scc1 rl_3
    s_lshl_b32 s94, s58, 1
    s_lshr_b32 s45, s97, 4
    s_add_u32 s94, s94, s45
    s_and_b32 s95, s97, 15
    s_add_u32 s58, s58, 1
    s_lshl_b32 s70, s94, 6
    s_mov_b32 s71, 0
    s_branch u_r1
rl_2:
    s_lshl_b32 s94, s59, 1
    s_lshr_b32 s45, s97, 4
    s_add_u32 s94, s94, s45
    s_and_b32 s95, s97, 15
    s_add_u32 s59, s59, 1
    s_lshl_b32 s70, s94, 6
    s_mov_b32 s71, 0
    s_branch u_r2
rl_3:
    s_lshl_b32 s94, s91, 1
    s_lshr_b32 s45, s97, 4
    s_add_u32 s94, s94, s45
    s_and_b32 s95, s97, 15
    s_add_u32 s91, s91, 1
    s_lshl_b32 s70, s94, 6
    s_mov_b32 s71, 0
    s_branch u_r3
u_r1:
    s_lshl_b32 s44, s94, 5
    s_add_u32 s44, s44, s95
    s_lshl_b32 s44, s44, 2
    s_add_u32 s83, s44, 84101888
    s_load_dwordx2 s[24:25], s[0:1], 0
    s_mov_b32 s26, 4194304
    s_mov_b32 s27, 0x00020000
    s_waitcnt lgkmcnt(0)
    s_lshl_b32 s44, s95, 2
    s_add_u32 s55, s70, s44
    v_and_b32 v1, 63, v0
    v_lshrrev_b32 v2, 6, v0
    s_nop 0
    v_readfirstlane_b32 s41, v2
    v_lshlrev_b32 v3, 4, v1
    v_lshlrev_b32 v4, 5, v1
    s_nop 1
    s_add_u32 s44, s41, s55
    s_lshl_b32 s45, s44, 11
    s_lshl_b32 s47, s44, 12
    s_add_u32 s46, s45, 134217728
    buffer_load_dwordx4 v[16:19], v3, s[8:11], s46 offen sc1
    buffer_load_dwordx4 v[20:23], v3, s[8:11], s46 offen offset:1024 sc1
    s_add_u32 s46, s45, 138412032
    buffer_load_dwordx4 v[24:27], v3, s[8:11], s46 offen sc1
    buffer_load_dwordx4 v[28:31], v3, s[8:11], s46 offen offset:1024 sc1
    s_add_u32 s46, s45, 142606336
    buffer_load_dwordx4 v[32:35], v3, s[8:11], s46 offen sc1
    buffer_load_dwordx4 v[36:39], v3, s[8:11], s46 offen offset:1024 sc1
    s_add_u32 s46, s45, 146800640
    buffer_load_dwordx4 v[40:43], v3, s[8:11], s46 offen sc1
    buffer_load_dwordx4 v[44:47], v3, s[8:11], s46 offen offset:1024 sc1
    s_add_u32 s46, s45, 150994944
    buffer_load_dwordx4 v[48:51], v3, s[8:11], s46 offen sc1
    buffer_load_dwordx4 v[52:55], v3, s[8:11], s46 offen offset:1024 sc1
    s_add_u32 s46, s45, 155189248
    buffer_load_dwordx4 v[56:59], v3, s[8:11], s46 offen sc1
    buffer_load_dwordx4 v[60:63], v3, s[8:11], s46 offen offset:1024 sc1
    buffer_load_dwordx4 v[112:115], v3, s[24:27], s45 offen
    buffer_load_dwordx4 v[116:119], v3, s[24:27], s45 offen offset:1024
    s_waitcnt vmcnt(0)
    v_lshlrev_b32 v160, 16, v16
    v_and_b32 v161, 0xffff0000, v16
    v_lshlrev_b32 v162, 16, v17
    v_and_b32 v163, 0xffff0000, v17
    v_lshlrev_b32 v164, 16, v18
    v_and_b32 v165, 0xffff0000, v18
    v_lshlrev_b32 v166, 16, v19
    v_and_b32 v167, 0xffff0000, v19
    v_lshlrev_b32 v168, 16, v20
    v_and_b32 v169, 0xffff0000, v20
    v_lshlrev_b32 v170, 16, v21
    v_and_b32 v171, 0xffff0000, v21
    v_lshlrev_b32 v172, 16, v22
    v_and_b32 v173, 0xffff0000, v22
    v_lshlrev_b32 v174, 16, v23
    v_and_b32 v175, 0xffff0000, v23
    v_lshlrev_b32 v176, 16, v24
    v_and_b32 v177, 0xffff0000, v24
    v_lshlrev_b32 v178, 16, v25
    v_and_b32 v179, 0xffff0000, v25
    v_lshlrev_b32 v180, 16, v26
    v_and_b32 v181, 0xffff0000, v26
    v_lshlrev_b32 v182, 16, v27
    v_and_b32 v183, 0xffff0000, v27
    v_lshlrev_b32 v184, 16, v28
    v_and_b32 v185, 0xffff0000, v28
    v_lshlrev_b32 v186, 16, v29
    v_and_b32 v187, 0xffff0000, v29
    v_lshlrev_b32 v188, 16, v30
    v_and_b32 v189, 0xffff0000, v30
    v_lshlrev_b32 v190, 16, v31
    v_and_b32 v191, 0xffff0000, v31
    v_pk_add_f32 v[160:161], v[160:161], v[176:177]
    v_pk_add_f32 v[162:163], v[162:163], v[178:179]
    v_pk_add_f32 v[164:165], v[164:165], v[180:181]
    v_pk_add_f32 v[166:167], v[166:167], v[182:183]
    v_pk_add_f32 v[168:169], v[168:169], v[184:185]
    v_pk_add_f32 v[170:171], v[170:171], v[186:187]
    v_pk_add_f32 v[172:173], v[172:173], v[188:189]
    v_pk_add_f32 v[174:175], v[174:175], v[190:191]
    v_lshlrev_b32 v176, 16, v32
    v_and_b32 v177, 0xffff0000, v32
    v_lshlrev_b32 v178, 16, v33
    v_and_b32 v179, 0xffff0000, v33
    v_lshlrev_b32 v180, 16, v34
    v_and_b32 v181, 0xffff0000, v34
    v_lshlrev_b32 v182, 16, v35
    v_and_b32 v183, 0xffff0000, v35
    v_lshlrev_b32 v184, 16, v36
    v_and_b32 v185, 0xffff0000, v36
    v_lshlrev_b32 v186, 16, v37
    v_and_b32 v187, 0xffff0000, v37
    v_lshlrev_b32 v188, 16, v38
    v_and_b32 v189, 0xffff0000, v38
    v_lshlrev_b32 v190, 16, v39
    v_and_b32 v191, 0xffff0000, v39
    v_pk_add_f32 v[160:161], v[160:161], v[176:177]
    v_pk_add_f32 v[162:163], v[162:163], v[178:179]
    v_pk_add_f32 v[164:165], v[164:165], v[180:181]
    v_pk_add_f32 v[166:167], v[166:167], v[182:183]
    v_pk_add_f32 v[168:169], v[168:169], v[184:185]
    v_pk_add_f32 v[170:171], v[170:171], v[186:187]
    v_pk_add_f32 v[172:173], v[172:173], v[188:189]
    v_pk_add_f32 v[174:175], v[174:175], v[190:191]
    v_lshlrev_b32 v176, 16, v40
    v_and_b32 v177, 0xffff0000, v40
    v_lshlrev_b32 v178, 16, v41
    v_and_b32 v179, 0xffff0000, v41
    v_lshlrev_b32 v180, 16, v42
    v_and_b32 v181, 0xffff0000, v42
    v_lshlrev_b32 v182, 16, v43
    v_and_b32 v183, 0xffff0000, v43
    v_lshlrev_b32 v184, 16, v44
    v_and_b32 v185, 0xffff0000, v44
    v_lshlrev_b32 v186, 16, v45
    v_and_b32 v187, 0xffff0000, v45
    v_lshlrev_b32 v188, 16, v46
    v_and_b32 v189, 0xffff0000, v46
    v_lshlrev_b32 v190, 16, v47
    v_and_b32 v191, 0xffff0000, v47
    v_pk_add_f32 v[160:161], v[160:161], v[176:177]
    v_pk_add_f32 v[162:163], v[162:163], v[178:179]
    v_pk_add_f32 v[164:165], v[164:165], v[180:181]
    v_pk_add_f32 v[166:167], v[166:167], v[182:183]
    v_pk_add_f32 v[168:169], v[168:169], v[184:185]
    v_pk_add_f32 v[170:171], v[170:171], v[186:187]
    v_pk_add_f32 v[172:173], v[172:173], v[188:189]
    v_pk_add_f32 v[174:175], v[174:175], v[190:191]
    v_lshlrev_b32 v176, 16, v48
    v_and_b32 v177, 0xffff0000, v48
    v_lshlrev_b32 v178, 16, v49
    v_and_b32 v179, 0xffff0000, v49
    v_lshlrev_b32 v180, 16, v50
    v_and_b32 v181, 0xffff0000, v50
    v_lshlrev_b32 v182, 16, v51
    v_and_b32 v183, 0xffff0000, v51
    v_lshlrev_b32 v184, 16, v52
    v_and_b32 v185, 0xffff0000, v52
    v_lshlrev_b32 v186, 16, v53
    v_and_b32 v187, 0xffff0000, v53
    v_lshlrev_b32 v188, 16, v54
    v_and_b32 v189, 0xffff0000, v54
    v_lshlrev_b32 v190, 16, v55
    v_and_b32 v191, 0xffff0000, v55
    v_pk_add_f32 v[160:161], v[160:161], v[176:177]
    v_pk_add_f32 v[162:163], v[162:163], v[178:179]
    v_pk_add_f32 v[164:165], v[164:165], v[180:181]
    v_pk_add_f32 v[166:167], v[166:167], v[182:183]
    v_pk_add_f32 v[168:169], v[168:169], v[184:185]
    v_pk_add_f32 v[170:171], v[170:171], v[186:187]
    v_pk_add_f32 v[172:173], v[172:173], v[188:189]
    v_pk_add_f32 v[174:175], v[174:175], v[190:191]
    v_lshlrev_b32 v176, 16, v56
    v_and_b32 v177, 0xffff0000, v56
    v_lshlrev_b32 v178, 16, v57
    v_and_b32 v179, 0xffff0000, v57
    v_lshlrev_b32 v180, 16, v58
    v_and_b32 v181, 0xffff0000, v58
    v_lshlrev_b32 v182, 16, v59
    v_and_b32 v183, 0xffff0000, v59
    v_lshlrev_b32 v184, 16, v60
    v_and_b32 v185, 0xffff0000, v60
    v_lshlrev_b32 v186, 16, v61
    v_and_b32 v187, 0xffff0000, v61
    v_lshlrev_b32 v188, 16, v62
    v_and_b32 v189, 0xffff0000, v62
    v_lshlrev_b32 v190, 16, v63
    v_and_b32 v191, 0xffff0000, v63
    v_pk_add_f32 v[160:161], v[160:161], v[176:177]
    v_pk_add_f32 v[162:163], v[162:163], v[178:179]
    v_pk_add_f32 v[164:165], v[164:165], v[180:181]
    v_pk_add_f32 v[166:167], v[166:167], v[182:183]
    v_pk_add_f32 v[168:169], v[168:169], v[184:185]
    v_pk_add_f32 v[170:171], v[170:171], v[186:187]
    v_pk_add_f32 v[172:173], v[172:173], v[188:189]
    v_pk_add_f32 v[174:175], v[174:175], v[190:191]
    v_cvt_pk_bf16_f32 v8, v160, v161
    v_lshlrev_b32 v160, 16, v8
    v_and_b32 v161, 0xffff0000, v8
    v_cvt_pk_bf16_f32 v8, v162, v163
    v_lshlrev_b32 v162, 16, v8
    v_and_b32 v163, 0xffff0000, v8
    v_cvt_pk_bf16_f32 v8, v164, v165
    v_lshlrev_b32 v164, 16, v8
    v_and_b32 v165, 0xffff0000, v8
    v_cvt_pk_bf16_f32 v8, v166, v167
    v_lshlrev_b32 v166, 16, v8
    v_and_b32 v167, 0xffff0000, v8
    v_cvt_pk_bf16_f32 v8, v168, v169
    v_lshlrev_b32 v168, 16, v8
    v_and_b32 v169, 0xffff0000, v8
    v_cvt_pk_bf16_f32 v8, v170, v171
    v_lshlrev_b32 v170, 16, v8
    v_and_b32 v171, 0xffff0000, v8
    v_cvt_pk_bf16_f32 v8, v172, v173
    v_lshlrev_b32 v172, 16, v8
    v_and_b32 v173, 0xffff0000, v8
    v_cvt_pk_bf16_f32 v8, v174, v175
    v_lshlrev_b32 v174, 16, v8
    v_and_b32 v175, 0xffff0000, v8
    v_lshlrev_b32 v176, 16, v112
    v_and_b32 v177, 0xffff0000, v112
    v_lshlrev_b32 v178, 16, v113
    v_and_b32 v179, 0xffff0000, v113
    v_lshlrev_b32 v180, 16, v114
    v_and_b32 v181, 0xffff0000, v114
    v_lshlrev_b32 v182, 16, v115
    v_and_b32 v183, 0xffff0000, v115
    v_lshlrev_b32 v184, 16, v116
    v_and_b32 v185, 0xffff0000, v116
    v_lshlrev_b32 v186, 16, v117
    v_and_b32 v187, 0xffff0000, v117
    v_lshlrev_b32 v188, 16, v118
    v_and_b32 v189, 0xffff0000, v118
    v_lshlrev_b32 v190, 16, v119
    v_and_b32 v191, 0xffff0000, v119
    v_add_f32 v160, v160, v176
    v_add_f32 v161, v161, v177
    v_add_f32 v162, v162, v178
    v_add_f32 v163, v163, v179
    v_add_f32 v164, v164, v180
    v_add_f32 v165, v165, v181
    v_add_f32 v166, v166, v182
    v_add_f32 v167, v167, v183
    v_add_f32 v168, v168, v184
    v_add_f32 v169, v169, v185
    v_add_f32 v170, v170, v186
    v_add_f32 v171, v171, v187
    v_add_f32 v172, v172, v188
    v_add_f32 v173, v173, v189
    v_add_f32 v174, v174, v190
    v_add_f32 v175, v175, v191
    v_cvt_pk_bf16_f32 v192, v160, v161
    v_cvt_pk_bf16_f32 v193, v162, v163
    v_cvt_pk_bf16_f32 v194, v164, v165
    v_cvt_pk_bf16_f32 v195, v166, v167
    v_cvt_pk_bf16_f32 v196, v168, v169
    v_cvt_pk_bf16_f32 v197, v170, v171
    v_cvt_pk_bf16_f32 v198, v172, v173
    v_cvt_pk_bf16_f32 v199, v174, v175
    s_add_u32 s46, s45, 88080384
    buffer_store_dwordx4 v[192:195], v3, s[8:11], s46 offen sc1
    buffer_store_dwordx4 v[196:199], v3, s[8:11], s46 offen offset:1024 sc1
    v_lshlrev_b32 v160, 16, v192
    v_and_b32 v161, 0xffff0000, v192
    v_lshlrev_b32 v162, 16, v193
    v_and_b32 v163, 0xffff0000, v193
    v_lshlrev_b32 v164, 16, v194
    v_and_b32 v165, 0xffff0000, v194
    v_lshlrev_b32 v166, 16, v195
    v_and_b32 v167, 0xffff0000, v195
    v_lshlrev_b32 v168, 16, v196
    v_and_b32 v169, 0xffff0000, v196
    v_lshlrev_b32 v170, 16, v197
    v_and_b32 v171, 0xffff0000, v197
    v_lshlrev_b32 v172, 16, v198
    v_and_b32 v173, 0xffff0000, v198
    v_lshlrev_b32 v174, 16, v199
    v_and_b32 v175, 0xffff0000, v199
    v_add_f32 v8, v160, v161
    v_add_f32 v8, v8, v162
    v_add_f32 v8, v8, v163
    v_add_f32 v8, v8, v164
    v_add_f32 v8, v8, v165
    v_add_f32 v8, v8, v166
    v_add_f32 v8, v8, v167
    v_add_f32 v8, v8, v168
    v_add_f32 v8, v8, v169
    v_add_f32 v8, v8, v170
    v_add_f32 v8, v8, v171
    v_add_f32 v8, v8, v172
    v_add_f32 v8, v8, v173
    v_add_f32 v8, v8, v174
    v_add_f32 v8, v8, v175
    s_nop 1
    v_add_f32_dpp v8, v8, v8 row_ror:8 row_mask:0xf bank_mask:0xf
    s_nop 1
    v_add_f32_dpp v8, v8, v8 row_ror:4 row_mask:0xf bank_mask:0xf
    s_nop 1
    v_add_f32_dpp v8, v8, v8 row_ror:2 row_mask:0xf bank_mask:0xf
    s_nop 1
    v_add_f32_dpp v8, v8, v8 row_ror:1 row_mask:0xf bank_mask:0xf
    v_mov_b32 v9, v8
    s_nop 1
    v_permlane16_swap_b32 v8, v9
    s_nop 0
    v_add_f32 v8, v8, v9
    v_mov_b32 v9, v8
    s_nop 1
    v_permlane32_swap_b32 v8, v9
    s_nop 0
    v_add_f32 v8, v8, v9
    v_mul_f32 v8, 0x3a800000, v8
    v_sub_f32 v11, v160, v8
    v_mul_f32 v10, v11, v11
    v_sub_f32 v11, v161, v8
    v_fmac_f32 v10, v11, v11
    v_sub_f32 v11, v162, v8
    v_fmac_f32 v10, v11, v11
    v_sub_f32 v11, v163, v8
    v_fmac_f32 v10, v11, v11
    v_sub_f32 v11, v164, v8
    v_fmac_f32 v10, v11, v11
    v_sub_f32 v11, v165, v8
    v_fmac_f32 v10, v11, v11
    v_sub_f32 v11, v166, v8
    v_fmac_f32 v10, v11, v11
    v_sub_f32 v11, v167, v8
    v_fmac_f32 v10, v11, v11
    v_sub_f32 v11, v168, v8
    v_fmac_f32 v10, v11, v11
    v_sub_f32 v11, v169, v8
    v_fmac_f32 v10, v11, v11
    v_sub_f32 v11, v170, v8
    v_fmac_f32 v10, v11, v11
    v_sub_f32 v11, v171, v8
    v_fmac_f32 v10, v11, v11
    v_sub_f32 v11, v172, v8
    v_fmac_f32 v10, v11, v11
    v_sub_f32 v11, v173, v8
    v_fmac_f32 v10, v11, v11
    v_sub_f32 v11, v174, v8
    v_fmac_f32 v10, v11, v11
    v_sub_f32 v11, v175, v8
    v_fmac_f32 v10, v11, v11
    s_nop 1
    v_add_f32_dpp v10, v10, v10 row_ror:8 row_mask:0xf bank_mask:0xf
    s_nop 1
    v_add_f32_dpp v10, v10, v10 row_ror:4 row_mask:0xf bank_mask:0xf
    s_nop 1
    v_add_f32_dpp v10, v10, v10 row_ror:2 row_mask:0xf bank_mask:0xf
    s_nop 1
    v_add_f32_dpp v10, v10, v10 row_ror:1 row_mask:0xf bank_mask:0xf
    v_mov_b32 v9, v10
    s_nop 1
    v_permlane16_swap_b32 v10, v9
    s_nop 0
    v_add_f32 v10, v10, v9
    v_mov_b32 v9, v10
    s_nop 1
    v_permlane32_swap_b32 v10, v9
    s_nop 0
    v_add_f32 v10, v10, v9
    v_mul_f32 v10, 0x3a800000, v10
    v_cvt_pk_bf16_f32 v9, v10, v10
    v_lshlrev_b32 v10, 16, v9
    v_cvt_pk_bf16_f32 v9, v8, v8
    v_lshlrev_b32 v8, 16, v9
    v_add_f32 v10, 0x3727c5ac, v10
    v_cvt_pk_bf16_f32 v9, v10, v10
    v_lshlrev_b32 v10, 16, v9
    v_sqrt_f32 v10, v10
    s_nop 0
    v_cvt_pk_bf16_f32 v9, v10, v10
    v_lshlrev_b32 v10, 16, v9
    v_rcp_f32 v10, v10
    v_sub_f32 v160, v160, v8
    v_sub_f32 v161, v161, v8
    v_sub_f32 v162, v162, v8
    v_sub_f32 v163, v163, v8
    v_sub_f32 v164, v164, v8
    v_sub_f32 v165, v165, v8
    v_sub_f32 v166, v166, v8
    v_sub_f32 v167, v167, v8
    v_sub_f32 v168, v168, v8
    v_sub_f32 v169, v169, v8
    v_sub_f32 v170, v170, v8
    v_sub_f32 v171, v171, v8
    v_sub_f32 v172, v172, v8
    v_sub_f32 v173, v173, v8
    v_sub_f32 v174, v174, v8
    v_sub_f32 v175, v175, v8
    v_cvt_pk_bf16_f32 v9, v160, v161
    v_lshlrev_b32 v160, 16, v9
    v_and_b32 v161, 0xffff0000, v9
    v_cvt_pk_bf16_f32 v9, v162, v163
    v_lshlrev_b32 v162, 16, v9
    v_and_b32 v163, 0xffff0000, v9
    v_cvt_pk_bf16_f32 v9, v164, v165
    v_lshlrev_b32 v164, 16, v9
    v_and_b32 v165, 0xffff0000, v9
    v_cvt_pk_bf16_f32 v9, v166, v167
    v_lshlrev_b32 v166, 16, v9
    v_and_b32 v167, 0xffff0000, v9
    v_cvt_pk_bf16_f32 v9, v168, v169
    v_lshlrev_b32 v168, 16, v9
    v_and_b32 v169, 0xffff0000, v9
    v_cvt_pk_bf16_f32 v9, v170, v171
    v_lshlrev_b32 v170, 16, v9
    v_and_b32 v171, 0xffff0000, v9
    v_cvt_pk_bf16_f32 v9, v172, v173
    v_lshlrev_b32 v172, 16, v9
    v_and_b32 v173, 0xffff0000, v9
    v_cvt_pk_bf16_f32 v9, v174, v175
    v_lshlrev_b32 v174, 16, v9
    v_and_b32 v175, 0xffff0000, v9
    v_mul_f32 v160, v160, v10
    v_mul_f32 v161, v161, v10
    v_mul_f32 v162, v162, v10
    v_mul_f32 v163, v163, v10
    v_mul_f32 v164, v164, v10
    v_mul_f32 v165, v165, v10
    v_mul_f32 v166, v166, v10
    v_mul_f32 v167, v167, v10
    v_mul_f32 v168, v168, v10
    v_mul_f32 v169, v169, v10
    v_mul_f32 v170, v170, v10
    v_mul_f32 v171, v171, v10
    v_mul_f32 v172, v172, v10
    v_mul_f32 v173, v173, v10
    v_mul_f32 v174, v174, v10
    v_mul_f32 v175, v175, v10
    v_cvt_pk_bf16_f32 v200, v160, v161
    v_cvt_pk_bf16_f32 v201, v162, v163
    v_cvt_pk_bf16_f32 v202, v164, v165
    v_cvt_pk_bf16_f32 v203, v166, v167
    v_cvt_pk_bf16_f32 v204, v168, v169
    v_cvt_pk_bf16_f32 v205, v170, v171
    v_cvt_pk_bf16_f32 v206, v172, v173
    v_cvt_pk_bf16_f32 v207, v174, v175
    s_add_u32 s46, s45, 92274688
    buffer_store_dwordx4 v[200:203], v3, s[8:11], s46 offen sc1
    buffer_store_dwordx4 v[204:207], v3, s[8:11], s46 offen offset:1024 sc1
    v_lshlrev_b32 v160, 16, v200
    v_and_b32 v161, 0xffff0000, v200
    v_lshlrev_b32 v162, 16, v201
    v_and_b32 v163, 0xffff0000, v201
    v_lshlrev_b32 v164, 16, v202
    v_and_b32 v165, 0xffff0000, v202
    v_lshlrev_b32 v166, 16, v203
    v_and_b32 v167, 0xffff0000, v203
    v_lshlrev_b32 v168, 16, v204
    v_and_b32 v169, 0xffff0000, v204
    v_lshlrev_b32 v170, 16, v205
    v_and_b32 v171, 0xffff0000, v205
    v_lshlrev_b32 v172, 16, v206
    v_and_b32 v173, 0xffff0000, v206
    v_lshlrev_b32 v174, 16, v207
    v_and_b32 v175, 0xffff0000, v207
    v_add_f32 v8, v160, v161
    v_add_f32 v8, v8, v162
    v_add_f32 v8, v8, v163
    v_add_f32 v8, v8, v164
    v_add_f32 v8, v8, v165
    v_add_f32 v8, v8, v166
    v_add_f32 v8, v8, v167
    v_add_f32 v8, v8, v168
    v_add_f32 v8, v8, v169
    v_add_f32 v8, v8, v170
    v_add_f32 v8, v8, v171
    v_add_f32 v8, v8, v172
    v_add_f32 v8, v8, v173
    v_add_f32 v8, v8, v174
    v_add_f32 v8, v8, v175
    s_nop 1
    v_add_f32_dpp v8, v8, v8 row_ror:8 row_mask:0xf bank_mask:0xf
    s_nop 1
    v_add_f32_dpp v8, v8, v8 row_ror:4 row_mask:0xf bank_mask:0xf
    s_nop 1
    v_add_f32_dpp v8, v8, v8 row_ror:2 row_mask:0xf bank_mask:0xf
    s_nop 1
    v_add_f32_dpp v8, v8, v8 row_ror:1 row_mask:0xf bank_mask:0xf
    v_mov_b32 v9, v8
    s_nop 1
    v_permlane16_swap_b32 v8, v9
    s_nop 0
    v_add_f32 v8, v8, v9
    v_mov_b32 v9, v8
    s_nop 1
    v_permlane32_swap_b32 v8, v9
    s_nop 0
    v_add_f32 v8, v8, v9
    v_mul_f32 v8, 0x3a800000, v8
    v_sub_f32 v11, v160, v8
    v_mul_f32 v10, v11, v11
    v_sub_f32 v11, v161, v8
    v_fmac_f32 v10, v11, v11
    v_sub_f32 v11, v162, v8
    v_fmac_f32 v10, v11, v11
    v_sub_f32 v11, v163, v8
    v_fmac_f32 v10, v11, v11
    v_sub_f32 v11, v164, v8
    v_fmac_f32 v10, v11, v11
    v_sub_f32 v11, v165, v8
    v_fmac_f32 v10, v11, v11
    v_sub_f32 v11, v166, v8
    v_fmac_f32 v10, v11, v11
    v_sub_f32 v11, v167, v8
    v_fmac_f32 v10, v11, v11
    v_sub_f32 v11, v168, v8
    v_fmac_f32 v10, v11, v11
    v_sub_f32 v11, v169, v8
    v_fmac_f32 v10, v11, v11
    v_sub_f32 v11, v170, v8
    v_fmac_f32 v10, v11, v11
    v_sub_f32 v11, v171, v8
    v_fmac_f32 v10, v11, v11
    v_sub_f32 v11, v172, v8
    v_fmac_f32 v10, v11, v11
    v_sub_f32 v11, v173, v8
    v_fmac_f32 v10, v11, v11
    v_sub_f32 v11, v174, v8
    v_fmac_f32 v10, v11, v11
    v_sub_f32 v11, v175, v8
    v_fmac_f32 v10, v11, v11
    s_nop 1
    v_add_f32_dpp v10, v10, v10 row_ror:8 row_mask:0xf bank_mask:0xf
    s_nop 1
    v_add_f32_dpp v10, v10, v10 row_ror:4 row_mask:0xf bank_mask:0xf
    s_nop 1
    v_add_f32_dpp v10, v10, v10 row_ror:2 row_mask:0xf bank_mask:0xf
    s_nop 1
    v_add_f32_dpp v10, v10, v10 row_ror:1 row_mask:0xf bank_mask:0xf
    v_mov_b32 v9, v10
    s_nop 1
    v_permlane16_swap_b32 v10, v9
    s_nop 0
    v_add_f32 v10, v10, v9
    v_mov_b32 v9, v10
    s_nop 1
    v_permlane32_swap_b32 v10, v9
    s_nop 0
    v_add_f32 v10, v10, v9
    v_mul_f32 v10, 0x3a800000, v10
    v_cvt_pk_bf16_f32 v9, v10, v10
    v_lshlrev_b32 v10, 16, v9
    v_cvt_pk_bf16_f32 v9, v8, v8
    v_lshlrev_b32 v8, 16, v9
    v_add_f32 v10, 0x3727c5ac, v10
    v_cvt_pk_bf16_f32 v9, v10, v10
    v_lshlrev_b32 v10, 16, v9
    v_sqrt_f32 v10, v10
    s_nop 0
    v_cvt_pk_bf16_f32 v9, v10, v10
    v_lshlrev_b32 v10, 16, v9
    v_rcp_f32 v10, v10
    v_sub_f32 v160, v160, v8
    v_sub_f32 v161, v161, v8
    v_sub_f32 v162, v162, v8
    v_sub_f32 v163, v163, v8
    v_sub_f32 v164, v164, v8
    v_sub_f32 v165, v165, v8
    v_sub_f32 v166, v166, v8
    v_sub_f32 v167, v167, v8
    v_sub_f32 v168, v168, v8
    v_sub_f32 v169, v169, v8
    v_sub_f32 v170, v170, v8
    v_sub_f32 v171, v171, v8
    v_sub_f32 v172, v172, v8
    v_sub_f32 v173, v173, v8
    v_sub_f32 v174, v174, v8
    v_sub_f32 v175, v175, v8
    v_cvt_pk_bf16_f32 v9, v160, v161
    v_lshlrev_b32 v160, 16, v9
    v_and_b32 v161, 0xffff0000, v9
    v_cvt_pk_bf16_f32 v9, v162, v163
    v_lshlrev_b32 v162, 16, v9
    v_and_b32 v163, 0xffff0000, v9
    v_cvt_pk_bf16_f32 v9, v164, v165
    v_lshlrev_b32 v164, 16, v9
    v_and_b32 v165, 0xffff0000, v9
    v_cvt_pk_bf16_f32 v9, v166, v167
    v_lshlrev_b32 v166, 16, v9
    v_and_b32 v167, 0xffff0000, v9
    v_cvt_pk_bf16_f32 v9, v168, v169
    v_lshlrev_b32 v168, 16, v9
    v_and_b32 v169, 0xffff0000, v9
    v_cvt_pk_bf16_f32 v9, v170, v171
    v_lshlrev_b32 v170, 16, v9
    v_and_b32 v171, 0xffff0000, v9
    v_cvt_pk_bf16_f32 v9, v172, v173
    v_lshlrev_b32 v172, 16, v9
    v_and_b32 v173, 0xffff0000, v9
    v_cvt_pk_bf16_f32 v9, v174, v175
    v_lshlrev_b32 v174, 16, v9
    v_and_b32 v175, 0xffff0000, v9
    v_mul_f32 v160, v160, v10
    v_mul_f32 v161, v161, v10
    v_mul_f32 v162, v162, v10
    v_mul_f32 v163, v163, v10
    v_mul_f32 v164, v164, v10
    v_mul_f32 v165, v165, v10
    v_mul_f32 v166, v166, v10
    v_mul_f32 v167, v167, v10
    v_mul_f32 v168, v168, v10
    v_mul_f32 v169, v169, v10
    v_mul_f32 v170, v170, v10
    v_mul_f32 v171, v171, v10
    v_mul_f32 v172, v172, v10
    v_mul_f32 v173, v173, v10
    v_mul_f32 v174, v174, v10
    v_mul_f32 v175, v175, v10
    v_cvt_pk_bf16_f32 v208, v160, v161
    v_cvt_pk_bf16_f32 v209, v162, v163
    v_cvt_pk_bf16_f32 v210, v164, v165
    v_cvt_pk_bf16_f32 v211, v166, v167
    v_cvt_pk_bf16_f32 v212, v168, v169
    v_cvt_pk_bf16_f32 v213, v170, v171
    v_cvt_pk_bf16_f32 v214, v172, v173
    v_cvt_pk_bf16_f32 v215, v174, v175
    s_add_u32 s46, s45, 96468992
    buffer_store_dwordx4 v[208:211], v3, s[8:11], s46 offen sc1
    buffer_store_dwordx4 v[212:215], v3, s[8:11], s46 offen offset:1024 sc1
    s_branch unit_done
u_r2:
    s_lshl_b32 s44, s94, 5
    s_add_u32 s44, s44, s95
    s_lshl_b32 s44, s44, 2
    s_add_u32 s83, s44, 84108416
    s_lshl_b32 s44, s95, 2
    s_add_u32 s55, s70, s44
    v_and_b32 v1, 63, v0
    v_lshrrev_b32 v2, 6, v0
    s_nop 0
    v_readfirstlane_b32 s41, v2
    v_lshlrev_b32 v3, 4, v1
    v_lshlrev_b32 v4, 5, v1
    s_nop 1
    s_add_u32 s44, s41, s55
    s_lshl_b32 s45, s44, 11
    s_lshl_b32 s47, s44, 12
    s_add_u32 s46, s45, 106954752
    buffer_load_dwordx4 v[16:19], v3, s[8:11], s46 offen sc1
    buffer_load_dwordx4 v[20:23], v3, s[8:11], s46 offen offset:1024 sc1
    s_waitcnt vmcnt(0)
    v_lshlrev_b32 v64, 16, v16
    v_and_b32 v65, 0xffff0000, v16
    v_lshlrev_b32 v66, 16, v17
    v_and_b32 v67, 0xffff0000, v17
    v_lshlrev_b32 v68, 16, v18
    v_and_b32 v69, 0xffff0000, v18
    v_lshlrev_b32 v70, 16, v19
    v_and_b32 v71, 0xffff0000, v19
    v_lshlrev_b32 v72, 16, v20
    v_and_b32 v73, 0xffff0000, v20
    v_lshlrev_b32 v74, 16, v21
    v_and_b32 v75, 0xffff0000, v21
    v_lshlrev_b32 v76, 16, v22
    v_and_b32 v77, 0xffff0000, v22
    v_lshlrev_b32 v78, 16, v23
    v_and_b32 v79, 0xffff0000, v23
    v_add_f32 v8, v64, v65
    v_add_f32 v8, v8, v66
    v_add_f32 v8, v8, v67
    v_add_f32 v8, v8, v68
    v_add_f32 v8, v8, v69
    v_add_f32 v8, v8, v70
    v_add_f32 v8, v8, v71
    v_add_f32 v8, v8, v72
    v_add_f32 v8, v8, v73
    v_add_f32 v8, v8, v74
    v_add_f32 v8, v8, v75
    v_add_f32 v8, v8, v76
    v_add_f32 v8, v8, v77
    v_add_f32 v8, v8, v78
    v_add_f32 v8, v8, v79
    s_nop 1
    v_add_f32_dpp v8, v8, v8 row_ror:8 row_mask:0xf bank_mask:0xf
    s_nop 1
    v_add_f32_dpp v8, v8, v8 row_ror:4 row_mask:0xf bank_mask:0xf
    s_nop 1
    v_add_f32_dpp v8, v8, v8 row_ror:2 row_mask:0xf bank_mask:0xf
    s_nop 1
    v_add_f32_dpp v8, v8, v8 row_ror:1 row_mask:0xf bank_mask:0xf
    v_mov_b32 v9, v8
    s_nop 1
    v_permlane16_swap_b32 v8, v9
    s_nop 0
    v_add_f32 v8, v8, v9
    v_mov_b32 v9, v8
    s_nop 1
    v_permlane32_swap_b32 v8, v9
    s_nop 0
    v_add_f32 v8, v8, v9
    v_mul_f32 v8, 0x3a800000, v8
    v_sub_f32 v11, v64, v8
    v_mul_f32 v10, v11, v11
    v_sub_f32 v11, v65, v8
    v_fmac_f32 v10, v11, v11
    v_sub_f32 v11, v66, v8
    v_fmac_f32 v10, v11, v11
    v_sub_f32 v11, v67, v8
    v_fmac_f32 v10, v11, v11
    v_sub_f32 v11, v68, v8
    v_fmac_f32 v10, v11, v11
    v_sub_f32 v11, v69, v8
    v_fmac_f32 v10, v11, v11
    v_sub_f32 v11, v70, v8
    v_fmac_f32 v10, v11, v11
    v_sub_f32 v11, v71, v8
    v_fmac_f32 v10, v11, v11
    v_sub_f32 v11, v72, v8
    v_fmac_f32 v10, v11, v11
    v_sub_f32 v11, v73, v8
    v_fmac_f32 v10, v11, v11
    v_sub_f32 v11, v74, v8
    v_fmac_f32 v10, v11, v11
    v_sub_f32 v11, v75, v8
    v_fmac_f32 v10, v11, v11
    v_sub_f32 v11, v76, v8
    v_fmac_f32 v10, v11, v11
    v_sub_f32 v11, v77, v8
    v_fmac_f32 v10, v11, v11
    v_sub_f32 v11, v78, v8
    v_fmac_f32 v10, v11, v11
    v_sub_f32 v11, v79, v8
    v_fmac_f32 v10, v11, v11
    s_nop 1
    v_add_f32_dpp v10, v10, v10 row_ror:8 row_mask:0xf bank_mask:0xf
    s_nop 1
    v_add_f32_dpp v10, v10, v10 row_ror:4 row_mask:0xf bank_mask:0xf
    s_nop 1
    v_add_f32_dpp v10, v10, v10 row_ror:2 row_mask:0xf bank_mask:0xf
    s_nop 1
    v_add_f32_dpp v10, v10, v10 row_ror:1 row_mask:0xf bank_mask:0xf
    v_mov_b32 v9, v10
    s_nop 1
    v_permlane16_swap_b32 v10, v9
    s_nop 0
    v_add_f32 v10, v10, v9
    v_mov_b32 v9, v10
    s_nop 1
    v_permlane32_swap_b32 v10, v9
    s_nop 0
    v_add_f32 v10, v10, v9
    v_mul_f32 v10, 0x3a800000, v10
    v_cvt_pk_bf16_f32 v9, v10, v10
    v_lshlrev_b32 v10, 16, v9
    v_cvt_pk_bf16_f32 v9, v8, v8
    v_lshlrev_b32 v8, 16, v9
    v_add_f32 v10, 0x3727c5ac, v10
    v_cvt_pk_bf16_f32 v9, v10, v10
    v_lshlrev_b32 v10, 16, v9
    v_sqrt_f32 v10, v10
    s_nop 0
    v_cvt_pk_bf16_f32 v9, v10, v10
    v_lshlrev_b32 v10, 16, v9
    v_rcp_f32 v10, v10
    v_sub_f32 v64, v64, v8
    v_sub_f32 v65, v65, v8
    v_sub_f32 v66, v66, v8
    v_sub_f32 v67, v67, v8
    v_sub_f32 v68, v68, v8
    v_sub_f32 v69, v69, v8
    v_sub_f32 v70, v70, v8
    v_sub_f32 v71, v71, v8
    v_sub_f32 v72, v72, v8
    v_sub_f32 v73, v73, v8
    v_sub_f32 v74, v74, v8
    v_sub_f32 v75, v75, v8
    v_sub_f32 v76, v76, v8
    v_sub_f32 v77, v77, v8
    v_sub_f32 v78, v78, v8
    v_sub_f32 v79, v79, v8
    v_cvt_pk_bf16_f32 v9, v64, v65
    v_lshlrev_b32 v64, 16, v9
    v_and_b32 v65, 0xffff0000, v9
    v_cvt_pk_bf16_f32 v9, v66, v67
    v_lshlrev_b32 v66, 16, v9
    v_and_b32 v67, 0xffff0000, v9
    v_cvt_pk_bf16_f32 v9, v68, v69
    v_lshlrev_b32 v68, 16, v9
    v_and_b32 v69, 0xffff0000, v9
    v_cvt_pk_bf16_f32 v9, v70, v71
    v_lshlrev_b32 v70, 16, v9
    v_and_b32 v71, 0xffff0000, v9
    v_cvt_pk_bf16_f32 v9, v72, v73
    v_lshlrev_b32 v72, 16, v9
    v_and_b32 v73, 0xffff0000, v9
    v_cvt_pk_bf16_f32 v9, v74, v75
    v_lshlrev_b32 v74, 16, v9
    v_and_b32 v75, 0xffff0000, v9
    v_cvt_pk_bf16_f32 v9, v76, v77
    v_lshlrev_b32 v76, 16, v9
    v_and_b32 v77, 0xffff0000, v9
    v_cvt_pk_bf16_f32 v9, v78, v79
    v_lshlrev_b32 v78, 16, v9
    v_and_b32 v79, 0xffff0000, v9
    v_mul_f32 v64, v64, v10
    v_mul_f32 v65, v65, v10
    v_mul_f32 v66, v66, v10
    v_mul_f32 v67, v67, v10
    v_mul_f32 v68, v68, v10
    v_mul_f32 v69, v69, v10
    v_mul_f32 v70, v70, v10
    v_mul_f32 v71, v71, v10
    v_mul_f32 v72, v72, v10
    v_mul_f32 v73, v73, v10
    v_mul_f32 v74, v74, v10
    v_mul_f32 v75, v75, v10
    v_mul_f32 v76, v76, v10
    v_mul_f32 v77, v77, v10
    v_mul_f32 v78, v78, v10
    v_mul_f32 v79, v79, v10
    v_cvt_pk_bf16_f32 v48, v64, v65
    v_cvt_pk_bf16_f32 v49, v66, v67
    v_cvt_pk_bf16_f32 v50, v68, v69
    v_cvt_pk_bf16_f32 v51, v70, v71
    v_cvt_pk_bf16_f32 v52, v72, v73
    v_cvt_pk_bf16_f32 v53, v74, v75
    v_cvt_pk_bf16_f32 v54, v76, v77
    v_cvt_pk_bf16_f32 v55, v78, v79
    s_add_u32 s46, s45, 111149056
    buffer_store_dwordx4 v[48:51], v3, s[8:11], s46 offen sc1
    buffer_store_dwordx4 v[52:55], v3, s[8:11], s46 offen offset:1024 sc1
    s_branch unit_done
u_r3:
    s_load_dwordx2 s[20:21], s[0:1], 96
    s_mov_b32 s22, 4194304
    s_mov_b32 s23, 0x00020000
    s_waitcnt lgkmcnt(0)
    s_lshl_b32 s44, s95, 2
    s_add_u32 s55, s70, s44
    v_and_b32 v1, 63, v0
    v_lshrrev_b32 v2, 6, v0
    s_nop 0
    v_readfirstlane_b32 s41, v2
    v_lshlrev_b32 v3, 4, v1
    v_lshlrev_b32 v4, 5, v1
    s_nop 1
    s_add_u32 s44, s41, s55
    s_lshl_b32 s45, s44, 11
    s_lshl_b32 s47, s44, 12
    s_add_u32 s46, s45, 167772160
    buffer_load_dwordx4 v[16:19], v3, s[8:11], s46 offen sc1
    buffer_load_dwordx4 v[20:23], v3, s[8:11], s46 offen offset:1024 sc1
    s_add_u32 s46, s45, 171966464
    buffer_load_dwordx4 v[24:27], v3, s[8:11], s46 offen sc1
    buffer_load_dwordx4 v[28:31], v3, s[8:11], s46 offen offset:1024 sc1
    s_add_u32 s46, s45, 176160768
    buffer_load_dwordx4 v[32:35], v3, s[8:11], s46 offen sc1
    buffer_load_dwordx4 v[36:39], v3, s[8:11], s46 offen offset:1024 sc1
    s_add_u32 s46, s45, 180355072
    buffer_load_dwordx4 v[40:43], v3, s[8:11], s46 offen sc1
    buffer_load_dwordx4 v[44:47], v3, s[8:11], s46 offen offset:1024 sc1
    s_add_u32 s46, s45, 184549376
    buffer_load_dwordx4 v[48:51], v3, s[8:11], s46 offen sc1
    buffer_load_dwordx4 v[52:55], v3, s[8:11], s46 offen offset:1024 sc1
    s_add_u32 s46, s45, 188743680
    buffer_load_dwordx4 v[56:59], v3, s[8:11], s46 offen sc1
    buffer_load_dwordx4 v[60:63], v3, s[8:11], s46 offen offset:1024 sc1
    s_add_u32 s46, s45, 106954752
    buffer_load_dwordx4 v[112:115], v3, s[8:11], s46 offen sc1
    buffer_load_dwordx4 v[116:119], v3, s[8:11], s46 offen offset:1024 sc1
    s_add_u32 s46, s45, 88080384
    buffer_load_dwordx4 v[120:123], v3, s[8:11], s46 offen sc1
    buffer_load_dwordx4 v[124:127], v3, s[8:11], s46 offen offset:1024 sc1
    s_waitcnt vmcnt(0)
    v_lshlrev_b32 v160, 16, v16
    v_and_b32 v161, 0xffff0000, v16
    v_lshlrev_b32 v162, 16, v17
    v_and_b32 v163, 0xffff0000, v17
    v_lshlrev_b32 v164, 16, v18
    v_and_b32 v165, 0xffff0000, v18
    v_lshlrev_b32 v166, 16, v19
    v_and_b32 v167, 0xffff0000, v19
    v_lshlrev_b32 v168, 16, v20
    v_and_b32 v169, 0xffff0000, v20
    v_lshlrev_b32 v170, 16, v21
    v_and_b32 v171, 0xffff0000, v21
    v_lshlrev_b32 v172, 16, v22
    v_and_b32 v173, 0xffff0000, v22
    v_lshlrev_b32 v174, 16, v23
    v_and_b32 v175, 0xffff0000, v23
    v_lshlrev_b32 v176, 16, v24
    v_and_b32 v177, 0xffff0000, v24
    v_lshlrev_b32 v178, 16, v25
    v_and_b32 v179, 0xffff0000, v25
    v_lshlrev_b32 v180, 16, v26
    v_and_b32 v181, 0xffff0000, v26
    v_lshlrev_b32 v182, 16, v27
    v_and_b32 v183, 0xffff0000, v27
    v_lshlrev_b32 v184, 16, v28
    v_and_b32 v185, 0xffff0000, v28
    v_lshlrev_b32 v186, 16, v29
    v_and_b32 v187, 0xffff0000, v29
    v_lshlrev_b32 v188, 16, v30
    v_and_b32 v189, 0xffff0000, v30
    v_lshlrev_b32 v190, 16, v31
    v_and_b32 v191, 0xffff0000, v31
    v_pk_add_f32 v[160:161], v[160:161], v[176:177]
    v_pk_add_f32 v[162:163], v[162:163], v[178:179]
    v_pk_add_f32 v[164:165], v[164:165], v[180:181]
    v_pk_add_f32 v[166:167], v[166:167], v[182:183]
    v_pk_add_f32 v[168:169], v[168:169], v[184:185]
    v_pk_add_f32 v[170:171], v[170:171], v[186:187]
    v_pk_add_f32 v[172:173], v[172:173], v[188:189]
    v_pk_add_f32 v[174:175], v[174:175], v[190:191]
    v_lshlrev_b32 v176, 16, v32
    v_and_b32 v177, 0xffff0000, v32
    v_lshlrev_b32 v178, 16, v33
    v_and_b32 v179, 0xffff0000, v33
    v_lshlrev_b32 v180, 16, v34
    v_and_b32 v181, 0xffff0000, v34
    v_lshlrev_b32 v182, 16, v35
    v_and_b32 v183, 0xffff0000, v35
    v_lshlrev_b32 v184, 16, v36
    v_and_b32 v185, 0xffff0000, v36
    v_lshlrev_b32 v186, 16, v37
    v_and_b32 v187, 0xffff0000, v37
    v_lshlrev_b32 v188, 16, v38
    v_and_b32 v189, 0xffff0000, v38
    v_lshlrev_b32 v190, 16, v39
    v_and_b32 v191, 0xffff0000, v39
    v_pk_add_f32 v[160:161], v[160:161], v[176:177]
    v_pk_add_f32 v[162:163], v[162:163], v[178:179]
    v_pk_add_f32 v[164:165], v[164:165], v[180:181]
    v_pk_add_f32 v[166:167], v[166:167], v[182:183]
    v_pk_add_f32 v[168:169], v[168:169], v[184:185]
    v_pk_add_f32 v[170:171], v[170:171], v[186:187]
    v_pk_add_f32 v[172:173], v[172:173], v[188:189]
    v_pk_add_f32 v[174:175], v[174:175], v[190:191]
    v_lshlrev_b32 v176, 16, v40
    v_and_b32 v177, 0xffff0000, v40
    v_lshlrev_b32 v178, 16, v41
    v_and_b32 v179, 0xffff0000, v41
    v_lshlrev_b32 v180, 16, v42
    v_and_b32 v181, 0xffff0000, v42
    v_lshlrev_b32 v182, 16, v43
    v_and_b32 v183, 0xffff0000, v43
    v_lshlrev_b32 v184, 16, v44
    v_and_b32 v185, 0xffff0000, v44
    v_lshlrev_b32 v186, 16, v45
    v_and_b32 v187, 0xffff0000, v45
    v_lshlrev_b32 v188, 16, v46
    v_and_b32 v189, 0xffff0000, v46
    v_lshlrev_b32 v190, 16, v47
    v_and_b32 v191, 0xffff0000, v47
    v_pk_add_f32 v[160:161], v[160:161], v[176:177]
    v_pk_add_f32 v[162:163], v[162:163], v[178:179]
    v_pk_add_f32 v[164:165], v[164:165], v[180:181]
    v_pk_add_f32 v[166:167], v[166:167], v[182:183]
    v_pk_add_f32 v[168:169], v[168:169], v[184:185]
    v_pk_add_f32 v[170:171], v[170:171], v[186:187]
    v_pk_add_f32 v[172:173], v[172:173], v[188:189]
    v_pk_add_f32 v[174:175], v[174:175], v[190:191]
    v_lshlrev_b32 v176, 16, v48
    v_and_b32 v177, 0xffff0000, v48
    v_lshlrev_b32 v178, 16, v49
    v_and_b32 v179, 0xffff0000, v49
    v_lshlrev_b32 v180, 16, v50
    v_and_b32 v181, 0xffff0000, v50
    v_lshlrev_b32 v182, 16, v51
    v_and_b32 v183, 0xffff0000, v51
    v_lshlrev_b32 v184, 16, v52
    v_and_b32 v185, 0xffff0000, v52
    v_lshlrev_b32 v186, 16, v53
    v_and_b32 v187, 0xffff0000, v53
    v_lshlrev_b32 v188, 16, v54
    v_and_b32 v189, 0xffff0000, v54
    v_lshlrev_b32 v190, 16, v55
    v_and_b32 v191, 0xffff0000, v55
    v_pk_add_f32 v[160:161], v[160:161], v[176:177]
    v_pk_add_f32 v[162:163], v[162:163], v[178:179]
    v_pk_add_f32 v[164:165], v[164:165], v[180:181]
    v_pk_add_f32 v[166:167], v[166:167], v[182:183]
    v_pk_add_f32 v[168:169], v[168:169], v[184:185]
    v_pk_add_f32 v[170:171], v[170:171], v[186:187]
    v_pk_add_f32 v[172:173], v[172:173], v[188:189]
    v_pk_add_f32 v[174:175], v[174:175], v[190:191]
    v_lshlrev_b32 v176, 16, v56
    v_and_b32 v177, 0xffff0000, v56
    v_lshlrev_b32 v178, 16, v57
    v_and_b32 v179, 0xffff0000, v57
    v_lshlrev_b32 v180, 16, v58
    v_and_b32 v181, 0xffff0000, v58
    v_lshlrev_b32 v182, 16, v59
    v_and_b32 v183, 0xffff0000, v59
    v_lshlrev_b32 v184, 16, v60
    v_and_b32 v185, 0xffff0000, v60
    v_lshlrev_b32 v186, 16, v61
    v_and_b32 v187, 0xffff0000, v61
    v_lshlrev_b32 v188, 16, v62
    v_and_b32 v189, 0xffff0000, v62
    v_lshlrev_b32 v190, 16, v63
    v_and_b32 v191, 0xffff0000, v63
    v_pk_add_f32 v[160:161], v[160:161], v[176:177]
    v_pk_add_f32 v[162:163], v[162:163], v[178:179]
    v_pk_add_f32 v[164:165], v[164:165], v[180:181]
    v_pk_add_f32 v[166:167], v[166:167], v[182:183]
    v_pk_add_f32 v[168:169], v[168:169], v[184:185]
    v_pk_add_f32 v[170:171], v[170:171], v[186:187]
    v_pk_add_f32 v[172:173], v[172:173], v[188:189]
    v_pk_add_f32 v[174:175], v[174:175], v[190:191]
    v_cvt_pk_bf16_f32 v8, v160, v161
    v_lshlrev_b32 v160, 16, v8
    v_and_b32 v161, 0xffff0000, v8
    v_cvt_pk_bf16_f32 v8, v162, v163
    v_lshlrev_b32 v162, 16, v8
    v_and_b32 v163, 0xffff0000, v8
    v_cvt_pk_bf16_f32 v8, v164, v165
    v_lshlrev_b32 v164, 16, v8
    v_and_b32 v165, 0xffff0000, v8
    v_cvt_pk_bf16_f32 v8, v166, v167
    v_lshlrev_b32 v166, 16, v8
    v_and_b32 v167, 0xffff0000, v8
    v_cvt_pk_bf16_f32 v8, v168, v169
    v_lshlrev_b32 v168, 16, v8
    v_and_b32 v169, 0xffff0000, v8
    v_cvt_pk_bf16_f32 v8, v170, v171
    v_lshlrev_b32 v170, 16, v8
    v_and_b32 v171, 0xffff0000, v8
    v_cvt_pk_bf16_f32 v8, v172, v173
    v_lshlrev_b32 v172, 16, v8
    v_and_b32 v173, 0xffff0000, v8
    v_cvt_pk_bf16_f32 v8, v174, v175
    v_lshlrev_b32 v174, 16, v8
    v_and_b32 v175, 0xffff0000, v8
    v_lshlrev_b32 v176, 16, v112
    v_and_b32 v177, 0xffff0000, v112
    v_lshlrev_b32 v178, 16, v113
    v_and_b32 v179, 0xffff0000, v113
    v_lshlrev_b32 v180, 16, v114
    v_and_b32 v181, 0xffff0000, v114
    v_lshlrev_b32 v182, 16, v115
    v_and_b32 v183, 0xffff0000, v115
    v_lshlrev_b32 v184, 16, v116
    v_and_b32 v185, 0xffff0000, v116
    v_lshlrev_b32 v186, 16, v117
    v_and_b32 v187, 0xffff0000, v117
    v_lshlrev_b32 v188, 16, v118
    v_and_b32 v189, 0xffff0000, v118
    v_lshlrev_b32 v190, 16, v119
    v_and_b32 v191, 0xffff0000, v119
    v_add_f32 v160, v160, v176
    v_add_f32 v161, v161, v177
    v_add_f32 v162, v162, v178
    v_add_f32 v163, v163, v179
    v_add_f32 v164, v164, v180
    v_add_f32 v165, v165, v181
    v_add_f32 v166, v166, v182
    v_add_f32 v167, v167, v183
    v_add_f32 v168, v168, v184
    v_add_f32 v169, v169, v185
    v_add_f32 v170, v170, v186
    v_add_f32 v171, v171, v187
    v_add_f32 v172, v172, v188
    v_add_f32 v173, v173, v189
    v_add_f32 v174, v174, v190
    v_add_f32 v175, v175, v191
    v_cvt_pk_bf16_f32 v8, v160, v161
    v_lshlrev_b32 v160, 16, v8
    v_and_b32 v161, 0xffff0000, v8
    v_cvt_pk_bf16_f32 v8, v162, v163
    v_lshlrev_b32 v162, 16, v8
    v_and_b32 v163, 0xffff0000, v8
    v_cvt_pk_bf16_f32 v8, v164, v165
    v_lshlrev_b32 v164, 16, v8
    v_and_b32 v165, 0xffff0000, v8
    v_cvt_pk_bf16_f32 v8, v166, v167
    v_lshlrev_b32 v166, 16, v8
    v_and_b32 v167, 0xffff0000, v8
    v_cvt_pk_bf16_f32 v8, v168, v169
    v_lshlrev_b32 v168, 16, v8
    v_and_b32 v169, 0xffff0000, v8
    v_cvt_pk_bf16_f32 v8, v170, v171
    v_lshlrev_b32 v170, 16, v8
    v_and_b32 v171, 0xffff0000, v8
    v_cvt_pk_bf16_f32 v8, v172, v173
    v_lshlrev_b32 v172, 16, v8
    v_and_b32 v173, 0xffff0000, v8
    v_cvt_pk_bf16_f32 v8, v174, v175
    v_lshlrev_b32 v174, 16, v8
    v_and_b32 v175, 0xffff0000, v8
    v_lshlrev_b32 v176, 16, v120
    v_and_b32 v177, 0xffff0000, v120
    v_lshlrev_b32 v178, 16, v121
    v_and_b32 v179, 0xffff0000, v121
    v_lshlrev_b32 v180, 16, v122
    v_and_b32 v181, 0xffff0000, v122
    v_lshlrev_b32 v182, 16, v123
    v_and_b32 v183, 0xffff0000, v123
    v_lshlrev_b32 v184, 16, v124
    v_and_b32 v185, 0xffff0000, v124
    v_lshlrev_b32 v186, 16, v125
    v_and_b32 v187, 0xffff0000, v125
    v_lshlrev_b32 v188, 16, v126
    v_and_b32 v189, 0xffff0000, v126
    v_lshlrev_b32 v190, 16, v127
    v_and_b32 v191, 0xffff0000, v127
    v_add_f32 v160, v160, v176
    v_add_f32 v161, v161, v177
    v_add_f32 v162, v162, v178
    v_add_f32 v163, v163, v179
    v_add_f32 v164, v164, v180
    v_add_f32 v165, v165, v181
    v_add_f32 v166, v166, v182
    v_add_f32 v167, v167, v183
    v_add_f32 v168, v168, v184
    v_add_f32 v169, v169, v185
    v_add_f32 v170, v170, v186
    v_add_f32 v171, v171, v187
    v_add_f32 v172, v172, v188
    v_add_f32 v173, v173, v189
    v_add_f32 v174, v174, v190
    v_add_f32 v175, v175, v191
    v_cvt_pk_bf16_f32 v192, v160, v161
    v_cvt_pk_bf16_f32 v193, v162, v163
    v_cvt_pk_bf16_f32 v194, v164, v165
    v_cvt_pk_bf16_f32 v195, v166, v167
    v_cvt_pk_bf16_f32 v196, v168, v169
    v_cvt_pk_bf16_f32 v197, v170, v171
    v_cvt_pk_bf16_f32 v198, v172, v173
    v_cvt_pk_bf16_f32 v199, v174, v175
    buffer_store_dwordx4 v[192:195], v3, s[20:23], s45 offen
    buffer_store_dwordx4 v[196:199], v3, s[20:23], s45 offen offset:1024
    s_branch unit_nosig
gemm_main:
    s_mov_b32 s35, 0
    s_cmp_lt_u32 s35, s34
    s_cselect_b32 s50, s28, 0x70000000
    s_add_u32 m0, s54, 0
    s_add_u32 s35, s35, 1
    buffer_load_dwordx4 v4, s[12:15], s50 offen offset:0 sc1 lds
    buffer_load_dwordx4 v5, s[12:15], s50 offen offset:1024 sc1 lds
    buffer_load_dwordx4 v6, s[12:15], s50 offen offset:2048 sc1 lds
    buffer_load_dwordx4 v7, s[12:15], s50 offen offset:3072 sc1 lds
    s_add_u32 s28, s28, 128
    s_cmp_lt_u32 s35, s34
    s_cselect_b32 s50, s28, 0x70000000
    s_add_u32 m0, s54, 16384
    s_add_u32 s35, s35, 1
    buffer_load_dwordx4 v4, s[12:15], s50 offen offset:0 sc1 lds
    buffer_load_dwordx4 v5, s[12:15], s50 offen offset:1024 sc1 lds
    buffer_load_dwordx4 v6, s[12:15], s50 offen offset:2048 sc1 lds
    buffer_load_dwordx4 v7, s[12:15], s50 offen offset:3072 sc1 lds
    s_add_u32 s28, s28, 128
    s_cmp_lt_u32 s35, s34
    s_cselect_b32 s50, s28, 0x70000000
    s_add_u32 m0, s54, 32768
    s_add_u32 s35, s35, 1
    buffer_load_dwordx4 v4, s[12:15], s50 offen offset:0 sc1 lds
    buffer_load_dwordx4 v5, s[12:15], s50 offen offset:1024 sc1 lds
    buffer_load_dwordx4 v6, s[12:15], s50 offen offset:2048 sc1 lds
    buffer_load_dwordx4 v7, s[12:15], s50 offen offset:3072 sc1 lds
    s_add_u32 s28, s28, 128
    s_waitcnt vmcnt(8)
    s_barrier
    ds_read_b128 v[32:35], v8 offset:0
    ds_read_b128 v[36:39], v8 offset:2048
    ds_read_b128 v[40:43], v8 offset:4096
    ds_read_b128 v[44:47], v8 offset:6144
    ds_read_b128 v[48:51], v8 offset:8192
    ds_read_b128 v[52:55], v8 offset:10240
    ds_read_b128 v[56:59], v8 offset:12288
    ds_read_b128 v[60:63], v8 offset:14336
    s_waitcnt lgkmcnt(0)
    v_mfma_f32_16x16x32_bf16 v[128:131], a[0:3], v[32:35], 0
    ds_read_b128 v[64:67], v9 offset:0
    v_mfma_f32_16x16x32_bf16 v[132:135], a[4:7], v[32:35], 0
    ds_read_b128 v[68:71], v9 offset:2048
    v_mfma_f32_16x16x32_bf16 v[136:139], a[0:3], v[36:39], 0
    ds_read_b128 v[72:75], v9 offset:4096
    s_cmp_lt_u32 s35, s34
    s_cselect_b32 s50, s28, 0x70000000
    s_add_u32 m0, s54, 49152
    s_add_u32 s35, s35, 1
    buffer_load_dwordx4 v4, s[12:15], s50 offen offset:0 sc1 lds
    v_mfma_f32_16x16x32_bf16 v[140:143], a[4:7], v[36:39], 0
    ds_read_b128 v[76:79], v9 offset:6144
    v_mfma_f32_16x16x32_bf16 v[144:147], a[0:3], v[40:43], 0
    ds_read_b128 v[80:83], v9 offset:8192
    v_mfma_f32_16x16x32_bf16 v[148:151], a[4:7], v[40:43], 0
    ds_read_b128 v[84:87], v9 offset:10240
    v_mfma_f32_16x16x32_bf16 v[152:155], a[0:3], v[44:47], 0
    ds_read_b128 v[88:91], v9 offset:12288
    buffer_load_dwordx4 v5, s[12:15], s50 offen offset:1024 sc1 lds
    v_mfma_f32_16x16x32_bf16 v[156:159], a[4:7], v[44:47], 0
    ds_read_b128 v[92:95], v9 offset:14336
    v_mfma_f32_16x16x32_bf16 v[160:163], a[0:3], v[48:51], 0
    v_mfma_f32_16x16x32_bf16 v[164:167], a[4:7], v[48:51], 0
    v_mfma_f32_16x16x32_bf16 v[168:171], a[0:3], v[52:55], 0
    buffer_load_dwordx4 v6, s[12:15], s50 offen offset:2048 sc1 lds
    v_mfma_f32_16x16x32_bf16 v[172:175], a[4:7], v[52:55], 0
    v_mfma_f32_16x16x32_bf16 v[176:179], a[0:3], v[56:59], 0
    v_mfma_f32_16x16x32_bf16 v[180:183], a[4:7], v[56:59], 0
    s_waitcnt vmcnt(7) lgkmcnt(0)
    s_barrier
    v_mfma_f32_16x16x32_bf16 v[184:187], a[0:3], v[60:63], 0
    buffer_load_dwordx4 v7, s[12:15], s50 offen offset:3072 sc1 lds
    s_add_u32 s28, s28, 128
    s_mul_i32 s44, s51, 2
    s_add_u32 s28, s28, s44
    v_mfma_f32_16x16x32_bf16 v[188:191], a[4:7], v[60:63], 0
    v_mfma_f32_16x16x32_bf16 v[128:131], a[8:11], v[64:67], v[128:131]
    ds_read_b128 v[32:35], v8 offset:16384
    v_mfma_f32_16x16x32_bf16 v[132:135], a[12:15], v[64:67], v[132:135]
    ds_read_b128 v[36:39], v8 offset:18432
    v_mfma_f32_16x16x32_bf16 v[136:139], a[8:11], v[68:71], v[136:139]
    ds_read_b128 v[40:43], v8 offset:20480
    s_cmp_lt_u32 s35, s34
    s_cselect_b32 s50, s28, 0x70000000
    s_add_u32 m0, s54, 65536
    s_add_u32 s35, s35, 1
    buffer_load_dwordx4 v4, s[12:15], s50 offen offset:0 sc1 lds
    v_mfma_f32_16x16x32_bf16 v[140:143], a[12:15], v[68:71], v[140:143]
    ds_read_b128 v[44:47], v8 offset:22528
    v_mfma_f32_16x16x32_bf16 v[144:147], a[8:11], v[72:75], v[144:147]
    ds_read_b128 v[48:51], v8 offset:24576
    v_mfma_f32_16x16x32_bf16 v[148:151], a[12:15], v[72:75], v[148:151]
    ds_read_b128 v[52:55], v8 offset:26624
    v_mfma_f32_16x16x32_bf16 v[152:155], a[8:11], v[76:79], v[152:155]
    ds_read_b128 v[56:59], v8 offset:28672
    buffer_load_dwordx4 v5, s[12:15], s50 offen offset:1024 sc1 lds
    v_mfma_f32_16x16x32_bf16 v[156:159], a[12:15], v[76:79], v[156:159]
    ds_read_b128 v[60:63], v8 offset:30720
    v_mfma_f32_16x16x32_bf16 v[160:163], a[8:11], v[80:83], v[160:163]
    v_mfma_f32_16x16x32_bf16 v[164:167], a[12:15], v[80:83], v[164:167]
    v_mfma_f32_16x16x32_bf16 v[168:171], a[8:11], v[84:87], v[168:171]
    buffer_load_dwordx4 v6, s[12:15], s50 offen offset:2048 sc1 lds
    v_mfma_f32_16x16x32_bf16 v[172:175], a[12:15], v[84:87], v[172:175]
    v_mfma_f32_16x16x32_bf16 v[176:179], a[8:11], v[88:91], v[176:179]
    v_mfma_f32_16x16x32_bf16 v[180:183], a[12:15], v[88:91], v[180:183]
    v_mfma_f32_16x16x32_bf16 v[184:187], a[8:11], v[92:95], v[184:187]
    buffer_load_dwordx4 v7, s[12:15], s50 offen offset:3072 sc1 lds
    s_add_u32 s28, s28, 128
    v_mfma_f32_16x16x32_bf16 v[188:191], a[12:15], v[92:95], v[188:191]
    s_cmp_le_u32 s34, 1
    s_cbranch_scc1 be_65
    s_waitcnt lgkmcnt(0)
    v_mfma_f32_16x16x32_bf16 v[128:131], a[16:19], v[32:35], v[128:131]
    ds_read_b128 v[64:67], v9 offset:16384
    v_mfma_f32_16x16x32_bf16 v[132:135], a[20:23], v[32:35], v[132:135]
    ds_read_b128 v[68:71], v9 offset:18432
    v_mfma_f32_16x16x32_bf16 v[136:139], a[16:19], v[36:39], v[136:139]
    ds_read_b128 v[72:75], v9 offset:20480
    s_cmp_lt_u32 s35, s34
    s_cselect_b32 s50, s28, 0x70000000
    s_add_u32 m0, s54, 81920
    s_add_u32 s35, s35, 1
    buffer_load_dwordx4 v4, s[12:15], s50 offen offset:0 sc1 lds
    v_mfma_f32_16x16x32_bf16 v[140:143], a[20:23], v[36:39], v[140:143]
    ds_read_b128 v[76:79], v9 offset:22528
    v_mfma_f32_16x16x32_bf16 v[144:147], a[16:19], v[40:43], v[144:147]
    ds_read_b128 v[80:83], v9 offset:24576
    v_mfma_f32_16x16x32_bf16 v[148:151], a[20:23], v[40:43], v[148:151]
    ds_read_b128 v[84:87], v9 offset:26624
    v_mfma_f32_16x16x32_bf16 v[152:155], a[16:19], v[44:47], v[152:155]
    ds_read_b128 v[88:91], v9 offset:28672
    buffer_load_dwordx4 v5, s[12:15], s50 offen offset:1024 sc1 lds
    v_mfma_f32_16x16x32_bf16 v[156:159], a[20:23], v[44:47], v[156:159]
    ds_read_b128 v[92:95], v9 offset:30720
    v_mfma_f32_16x16x32_bf16 v[160:163], a[16:19], v[48:51], v[160:163]
    v_mfma_f32_16x16x32_bf16 v[164:167], a[20:23], v[48:51], v[164:167]
    v_mfma_f32_16x16x32_bf16 v[168:171], a[16:19], v[52:55], v[168:171]
    buffer_load_dwordx4 v6, s[12:15], s50 offen offset:2048 sc1 lds
    v_mfma_f32_16x16x32_bf16 v[172:175], a[20:23], v[52:55], v[172:175]
    v_mfma_f32_16x16x32_bf16 v[176:179], a[16:19], v[56:59], v[176:179]
    v_mfma_f32_16x16x32_bf16 v[180:183], a[20:23], v[56:59], v[180:183]
    s_waitcnt vmcnt(11) lgkmcnt(0)
    s_barrier
    v_mfma_f32_16x16x32_bf16 v[184:187], a[16:19], v[60:63], v[184:187]
    buffer_load_dwordx4 v7, s[12:15], s50 offen offset:3072 sc1 lds
    s_add_u32 s28, s28, 128
    v_mfma_f32_16x16x32_bf16 v[188:191], a[20:23], v[60:63], v[188:191]
    v_mfma_f32_16x16x32_bf16 v[128:131], a[24:27], v[64:67], v[128:131]
    ds_read_b128 v[32:35], v8 offset:32768
    v_mfma_f32_16x16x32_bf16 v[132:135], a[28:31], v[64:67], v[132:135]
    ds_read_b128 v[36:39], v8 offset:34816
    v_mfma_f32_16x16x32_bf16 v[136:139], a[24:27], v[68:71], v[136:139]
    ds_read_b128 v[40:43], v8 offset:36864
    s_cmp_lt_u32 s35, s34
    s_cselect_b32 s50, s28, 0x70000000
    s_add_u32 m0, s54, 98304
    s_add_u32 s35, s35, 1
    buffer_load_dwordx4 v4, s[12:15], s50 offen offset:0 sc1 lds
    v_mfma_f32_16x16x32_bf16 v[140:143], a[28:31], v[68:71], v[140:143]
    ds_read_b128 v[44:47], v8 offset:38912
    v_mfma_f32_16x16x32_bf16 v[144:147], a[24:27], v[72:75], v[144:147]
    ds_read_b128 v[48:51], v8 offset:40960
    v_mfma_f32_16x16x32_bf16 v[148:151], a[28:31], v[72:75], v[148:151]
    ds_read_b128 v[52:55], v8 offset:43008
    v_mfma_f32_16x16x32_bf16 v[152:155], a[24:27], v[76:79], v[152:155]
    ds_read_b128 v[56:59], v8 offset:45056
    buffer_load_dwordx4 v5, s[12:15], s50 offen offset:1024 sc1 lds
    v_mfma_f32_16x16x32_bf16 v[156:159], a[28:31], v[76:79], v[156:159]
    ds_read_b128 v[60:63], v8 offset:47104
    v_mfma_f32_16x16x32_bf16 v[160:163], a[24:27], v[80:83], v[160:163]
    v_mfma_f32_16x16x32_bf16 v[164:167], a[28:31], v[80:83], v[164:167]
    v_mfma_f32_16x16x32_bf16 v[168:171], a[24:27], v[84:87], v[168:171]
    buffer_load_dwordx4 v6, s[12:15], s50 offen offset:2048 sc1 lds
    v_mfma_f32_16x16x32_bf16 v[172:175], a[28:31], v[84:87], v[172:175]
    v_mfma_f32_16x16x32_bf16 v[176:179], a[24:27], v[88:91], v[176:179]
    v_mfma_f32_16x16x32_bf16 v[180:183], a[28:31], v[88:91], v[180:183]
    v_mfma_f32_16x16x32_bf16 v[184:187], a[24:27], v[92:95], v[184:187]
    buffer_load_dwordx4 v7, s[12:15], s50 offen offset:3072 sc1 lds
    s_add_u32 s28, s28, 128
    v_mfma_f32_16x16x32_bf16 v[188:191], a[28:31], v[92:95], v[188:191]
    s_cmp_le_u32 s34, 2
    s_cbranch_scc1 be_65
    s_waitcnt lgkmcnt(0)
    v_mfma_f32_16x16x32_bf16 v[128:131], a[32:35], v[32:35], v[128:131]
    ds_read_b128 v[64:67], v9 offset:32768
    v_mfma_f32_16x16x32_bf16 v[132:135], a[36:39], v[32:35], v[132:135]
    ds_read_b128 v[68:71], v9 offset:34816
    v_mfma_f32_16x16x32_bf16 v[136:139], a[32:35], v[36:39], v[136:139]
    ds_read_b128 v[72:75], v9 offset:36864
    s_cmp_lt_u32 s35, s34
    s_cselect_b32 s50, s28, 0x70000000
    s_add_u32 m0, s54, 114688
    s_add_u32 s35, s35, 1
    buffer_load_dwordx4 v4, s[12:15], s50 offen offset:0 sc1 lds
    v_mfma_f32_16x16x32_bf16 v[140:143], a[36:39], v[36:39], v[140:143]
    ds_read_b128 v[76:79], v9 offset:38912
    v_mfma_f32_16x16x32_bf16 v[144:147], a[32:35], v[40:43], v[144:147]
    ds_read_b128 v[80:83], v9 offset:40960
    v_mfma_f32_16x16x32_bf16 v[148:151], a[36:39], v[40:43], v[148:151]
    ds_read_b128 v[84:87], v9 offset:43008
    v_mfma_f32_16x16x32_bf16 v[152:155], a[32:35], v[44:47], v[152:155]
    ds_read_b128 v[88:91], v9 offset:45056
    buffer_load_dwordx4 v5, s[12:15], s50 offen offset:1024 sc1 lds
    v_mfma_f32_16x16x32_bf16 v[156:159], a[36:39], v[44:47], v[156:159]
    ds_read_b128 v[92:95], v9 offset:47104
    v_mfma_f32_16x16x32_bf16 v[160:163], a[32:35], v[48:51], v[160:163]
    v_mfma_f32_16x16x32_bf16 v[164:167], a[36:39], v[48:51], v[164:167]
    v_mfma_f32_16x16x32_bf16 v[168:171], a[32:35], v[52:55], v[168:171]
    buffer_load_dwordx4 v6, s[12:15], s50 offen offset:2048 sc1 lds
    v_mfma_f32_16x16x32_bf16 v[172:175], a[36:39], v[52:55], v[172:175]
    v_mfma_f32_16x16x32_bf16 v[176:179], a[32:35], v[56:59], v[176:179]
    v_mfma_f32_16x16x32_bf16 v[180:183], a[36:39], v[56:59], v[180:183]
    s_waitcnt vmcnt(15) lgkmcnt(0)
    s_barrier
    v_mfma_f32_16x16x32_bf16 v[184:187], a[32:35], v[60:63], v[184:187]
    buffer_load_dwordx4 v7, s[12:15], s50 offen offset:3072 sc1 lds
    s_add_u32 s28, s28, 128
    s_mul_i32 s44, s51, -3
    s_add_u32 s28, s28, s44
    v_mfma_f32_16x16x32_bf16 v[188:191], a[36:39], v[60:63], v[188:191]
    v_mfma_f32_16x16x32_bf16 v[128:131], a[40:43], v[64:67], v[128:131]
    ds_read_b128 v[32:35], v8 offset:49152
    v_mfma_f32_16x16x32_bf16 v[132:135], a[44:47], v[64:67], v[132:135]
    ds_read_b128 v[36:39], v8 offset:51200
    v_mfma_f32_16x16x32_bf16 v[136:139], a[40:43], v[68:71], v[136:139]
    ds_read_b128 v[40:43], v8 offset:53248
    s_cmp_lt_u32 s35, s34
    s_cselect_b32 s50, s28, 0x70000000
    s_add_u32 m0, s54, 0
    s_add_u32 s35, s35, 1
    buffer_load_dwordx4 v4, s[12:15], s50 offen offset:0 sc1 lds
    v_mfma_f32_16x16x32_bf16 v[140:143], a[44:47], v[68:71], v[140:143]
    ds_read_b128 v[44:47], v8 offset:55296
    v_mfma_f32_16x16x32_bf16 v[144:147], a[40:43], v[72:75], v[144:147]
    ds_read_b128 v[48:51], v8 offset:57344
    v_mfma_f32_16x16x32_bf16 v[148:151], a[44:47], v[72:75], v[148:151]
    ds_read_b128 v[52:55], v8 offset:59392
    v_mfma_f32_16x16x32_bf16 v[152:155], a[40:43], v[76:79], v[152:155]
    ds_read_b128 v[56:59], v8 offset:61440
    buffer_load_dwordx4 v5, s[12:15], s50 offen offset:1024 sc1 lds
    v_mfma_f32_16x16x32_bf16 v[156:159], a[44:47], v[76:79], v[156:159]
    ds_read_b128 v[60:63], v8 offset:63488
    v_mfma_f32_16x16x32_bf16 v[160:163], a[40:43], v[80:83], v[160:163]
    v_mfma_f32_16x16x32_bf16 v[164:167], a[44:47], v[80:83], v[164:167]
    v_mfma_f32_16x16x32_bf16 v[168:171], a[40:43], v[84:87], v[168:171]
    buffer_load_dwordx4 v6, s[12:15], s50 offen offset:2048 sc1 lds
    v_mfma_f32_16x16x32_bf16 v[172:175], a[44:47], v[84:87], v[172:175]
    v_mfma_f32_16x16x32_bf16 v[176:179], a[40:43], v[88:91], v[176:179]
    v_mfma_f32_16x16x32_bf16 v[180:183], a[44:47], v[88:91], v[180:183]
    v_mfma_f32_16x16x32_bf16 v[184:187], a[40:43], v[92:95], v[184:187]
    buffer_load_dwordx4 v7, s[12:15], s50 offen offset:3072 sc1 lds
    s_add_u32 s28, s28, 128
    v_mfma_f32_16x16x32_bf16 v[188:191], a[44:47], v[92:95], v[188:191]
    s_cmp_le_u32 s34, 3
    s_cbranch_scc1 be_65
    s_waitcnt lgkmcnt(0)
    v_mfma_f32_16x16x32_bf16 v[128:131], a[48:51], v[32:35], v[128:131]
    ds_read_b128 v[64:67], v9 offset:49152
    v_mfma_f32_16x16x32_bf16 v[132:135], a[52:55], v[32:35], v[132:135]
    ds_read_b128 v[68:71], v9 offset:51200
    v_mfma_f32_16x16x32_bf16 v[136:139], a[48:51], v[36:39], v[136:139]
    ds_read_b128 v[72:75], v9 offset:53248
    s_cmp_lt_u32 s35, s34
    s_cselect_b32 s50, s28, 0x70000000
    s_add_u32 m0, s54, 16384
    s_add_u32 s35, s35, 1
    buffer_load_dwordx4 v4, s[12:15], s50 offen offset:0 sc1 lds
    v_mfma_f32_16x16x32_bf16 v[140:143], a[52:55], v[36:39], v[140:143]
    ds_read_b128 v[76:79], v9 offset:55296
    v_mfma_f32_16x16x32_bf16 v[144:147], a[48:51], v[40:43], v[144:147]
    ds_read_b128 v[80:83], v9 offset:57344
    v_mfma_f32_16x16x32_bf16 v[148:151], a[52:55], v[40:43], v[148:151]
    ds_read_b128 v[84:87], v9 offset:59392
    v_mfma_f32_16x16x32_bf16 v[152:155], a[48:51], v[44:47], v[152:155]
    ds_read_b128 v[88:91], v9 offset:61440
    buffer_load_dwordx4 v5, s[12:15], s50 offen offset:1024 sc1 lds
    v_mfma_f32_16x16x32_bf16 v[156:159], a[52:55], v[44:47], v[156:159]
    ds_read_b128 v[92:95], v9 offset:63488
    v_mfma_f32_16x16x32_bf16 v[160:163], a[48:51], v[48:51], v[160:163]
    v_mfma_f32_16x16x32_bf16 v[164:167], a[52:55], v[48:51], v[164:167]
    v_mfma_f32_16x16x32_bf16 v[168:171], a[48:51], v[52:55], v[168:171]
    buffer_load_dwordx4 v6, s[12:15], s50 offen offset:2048 sc1 lds
    v_mfma_f32_16x16x32_bf16 v[172:175], a[52:55], v[52:55], v[172:175]
    v_mfma_f32_16x16x32_bf16 v[176:179], a[48:51], v[56:59], v[176:179]
    v_mfma_f32_16x16x32_bf16 v[180:183], a[52:55], v[56:59], v[180:183]
    s_waitcnt vmcnt(19) lgkmcnt(0)
    s_barrier
    v_mfma_f32_16x16x32_bf16 v[184:187], a[48:51], v[60:63], v[184:187]
    buffer_load_dwordx4 v7, s[12:15], s50 offen offset:3072 sc1 lds
    s_add_u32 s28, s28, 128
    v_mfma_f32_16x16x32_bf16 v[188:191], a[52:55], v[60:63], v[188:191]
    v_mfma_f32_16x16x32_bf16 v[128:131], a[56:59], v[64:67], v[128:131]
    ds_read_b128 v[32:35], v10 offset:0
    v_mfma_f32_16x16x32_bf16 v[132:135], a[60:63], v[64:67], v[132:135]
    ds_read_b128 v[36:39], v10 offset:2048
    v_mfma_f32_16x16x32_bf16 v[136:139], a[56:59], v[68:71], v[136:139]
    ds_read_b128 v[40:43], v10 offset:4096
    s_cmp_lt_u32 s35, s34
    s_cselect_b32 s50, s28, 0x70000000
    s_add_u32 m0, s54, 32768
    s_add_u32 s35, s35, 1
    buffer_load_dwordx4 v4, s[12:15], s50 offen offset:0 sc1 lds
    v_mfma_f32_16x16x32_bf16 v[140:143], a[60:63], v[68:71], v[140:143]
    ds_read_b128 v[44:47], v10 offset:6144
    v_mfma_f32_16x16x32_bf16 v[144:147], a[56:59], v[72:75], v[144:147]
    ds_read_b128 v[48:51], v10 offset:8192
    v_mfma_f32_16x16x32_bf16 v[148:151], a[60:63], v[72:75], v[148:151]
    ds_read_b128 v[52:55], v10 offset:10240
    v_mfma_f32_16x16x32_bf16 v[152:155], a[56:59], v[76:79], v[152:155]
    ds_read_b128 v[56:59], v10 offset:12288
    buffer_load_dwordx4 v5, s[12:15], s50 offen offset:1024 sc1 lds
    v_mfma_f32_16x16x32_bf16 v[156:159], a[60:63], v[76:79], v[156:159]
    ds_read_b128 v[60:63], v10 offset:14336
    v_mfma_f32_16x16x32_bf16 v[160:163], a[56:59], v[80:83], v[160:163]
    v_mfma_f32_16x16x32_bf16 v[164:167], a[60:63], v[80:83], v[164:167]
    v_mfma_f32_16x16x32_bf16 v[168:171], a[56:59], v[84:87], v[168:171]
    buffer_load_dwordx4 v6, s[12:15], s50 offen offset:2048 sc1 lds
    v_mfma_f32_16x16x32_bf16 v[172:175], a[60:63], v[84:87], v[172:175]
    v_mfma_f32_16x16x32_bf16 v[176:179], a[56:59], v[88:91], v[176:179]
    v_mfma_f32_16x16x32_bf16 v[180:183], a[60:63], v[88:91], v[180:183]
    v_mfma_f32_16x16x32_bf16 v[184:187], a[56:59], v[92:95], v[184:187]
    buffer_load_dwordx4 v7, s[12:15], s50 offen offset:3072 sc1 lds
    s_add_u32 s28, s28, 128
    v_mfma_f32_16x16x32_bf16 v[188:191], a[60:63], v[92:95], v[188:191]
    s_cmp_le_u32 s34, 4
    s_cbranch_scc1 be_65
    s_waitcnt lgkmcnt(0)
    v_mfma_f32_16x16x32_bf16 v[128:131], a[64:67], v[32:35], v[128:131]
    ds_read_b128 v[64:67], v11 offset:0
    v_mfma_f32_16x16x32_bf16 v[132:135], a[68:71], v[32:35], v[132:135]
    ds_read_b128 v[68:71], v11 offset:2048
    v_mfma_f32_16x16x32_bf16 v[136:139], a[64:67], v[36:39], v[136:139]
    ds_read_b128 v[72:75], v11 offset:4096
    v_mfma_f32_16x16x32_bf16 v[140:143], a[68:71], v[36:39], v[140:143]
    ds_read_b128 v[76:79], v11 offset:6144
    v_mfma_f32_16x16x32_bf16 v[144:147], a[64:67], v[40:43], v[144:147]
    ds_read_b128 v[80:83], v11 offset:8192
    s_cmp_lt_u32 s35, s34
    s_cselect_b32 s50, s28, 0x70000000
    s_add_u32 m0, s54, 49152
    s_add_u32 s35, s35, 1
    buffer_load_dwordx4 v4, s[12:15], s50 offen offset:0 sc1 lds
    v_mfma_f32_16x16x32_bf16 v[148:151], a[68:71], v[40:43], v[148:151]
    ds_read_b128 v[84:87], v11 offset:10240
    v_mfma_f32_16x16x32_bf16 v[152:155], a[64:67], v[44:47], v[152:155]
    ds_read_b128 v[88:91], v11 offset:12288
    v_mfma_f32_16x16x32_bf16 v[156:159], a[68:71], v[44:47], v[156:159]
    ds_read_b128 v[92:95], v11 offset:14336
    v_mfma_f32_16x16x32_bf16 v[160:163], a[64:67], v[48:51], v[160:163]
    v_mfma_f32_16x16x32_bf16 v[164:167], a[68:71], v[48:51], v[164:167]
    v_mfma_f32_16x16x32_bf16 v[168:171], a[64:67], v[52:55], v[168:171]
    v_mfma_f32_16x16x32_bf16 v[172:175], a[68:71], v[52:55], v[172:175]
    v_mfma_f32_16x16x32_bf16 v[176:179], a[64:67], v[56:59], v[176:179]
    buffer_load_dwordx4 v5, s[12:15], s50 offen offset:1024 sc1 lds
    v_mfma_f32_16x16x32_bf16 v[180:183], a[68:71], v[56:59], v[180:183]
    s_waitcnt vmcnt(22) lgkmcnt(0)
    s_barrier
    v_mfma_f32_16x16x32_bf16 v[184:187], a[64:67], v[60:63], v[184:187]
    v_mfma_f32_16x16x32_bf16 v[188:191], a[68:71], v[60:63], v[188:191]
    v_mfma_f32_16x16x32_bf16 v[128:131], a[72:75], v[64:67], v[128:131]
    ds_read_b128 v[32:35], v10 offset:16384
    v_mfma_f32_16x16x32_bf16 v[132:135], a[76:79], v[64:67], v[132:135]
    ds_read_b128 v[36:39], v10 offset:18432
    v_mfma_f32_16x16x32_bf16 v[136:139], a[72:75], v[68:71], v[136:139]
    ds_read_b128 v[40:43], v10 offset:20480
    v_mfma_f32_16x16x32_bf16 v[140:143], a[76:79], v[68:71], v[140:143]
    ds_read_b128 v[44:47], v10 offset:22528
    v_mfma_f32_16x16x32_bf16 v[144:147], a[72:75], v[72:75], v[144:147]
    ds_read_b128 v[48:51], v10 offset:24576
    buffer_load_dwordx4 v6, s[12:15], s50 offen offset:2048 sc1 lds
    v_mfma_f32_16x16x32_bf16 v[148:151], a[76:79], v[72:75], v[148:151]
    ds_read_b128 v[52:55], v10 offset:26624
    v_mfma_f32_16x16x32_bf16 v[152:155], a[72:75], v[76:79], v[152:155]
    ds_read_b128 v[56:59], v10 offset:28672
    v_mfma_f32_16x16x32_bf16 v[156:159], a[76:79], v[76:79], v[156:159]
    ds_read_b128 v[60:63], v10 offset:30720
    v_mfma_f32_16x16x32_bf16 v[160:163], a[72:75], v[80:83], v[160:163]
    v_mfma_f32_16x16x32_bf16 v[164:167], a[76:79], v[80:83], v[164:167]
    v_mfma_f32_16x16x32_bf16 v[168:171], a[72:75], v[84:87], v[168:171]
    v_mfma_f32_16x16x32_bf16 v[172:175], a[76:79], v[84:87], v[172:175]
    v_mfma_f32_16x16x32_bf16 v[176:179], a[72:75], v[88:91], v[176:179]
    buffer_load_dwordx4 v7, s[12:15], s50 offen offset:3072 sc1 lds
    s_add_u32 s28, s28, 128
    s_mul_i32 s44, s51, 4
    s_add_u32 s28, s28, s44
    v_mfma_f32_16x16x32_bf16 v[180:183], a[76:79], v[88:91], v[180:183]
    v_mfma_f32_16x16x32_bf16 v[184:187], a[72:75], v[92:95], v[184:187]
    v_mfma_f32_16x16x32_bf16 v[188:191], a[76:79], v[92:95], v[188:191]
    s_cmp_le_u32 s34, 5
    s_cbranch_scc1 be_65
    s_waitcnt lgkmcnt(0)
    v_mfma_f32_16x16x32_bf16 v[128:131], a[80:83], v[32:35], v[128:131]
    ds_read_b128 v[64:67], v11 offset:16384
    v_mfma_f32_16x16x32_bf16 v[132:135], a[84:87], v[32:35], v[132:135]
    ds_read_b128 v[68:71], v11 offset:18432
    v_mfma_f32_16x16x32_bf16 v[136:139], a[80:83], v[36:39], v[136:139]
    ds_read_b128 v[72:75], v11 offset:20480
    v_mfma_f32_16x16x32_bf16 v[140:143], a[84:87], v[36:39], v[140:143]
    ds_read_b128 v[76:79], v11 offset:22528
    v_mfma_f32_16x16x32_bf16 v[144:147], a[80:83], v[40:43], v[144:147]
    ds_read_b128 v[80:83], v11 offset:24576
    s_cmp_lt_u32 s35, s34
    s_cselect_b32 s50, s28, 0x70000000
    s_add_u32 m0, s54, 65536
    s_add_u32 s35, s35, 1
    buffer_load_dwordx4 v4, s[12:15], s50 offen offset:0 sc1 lds
    v_mfma_f32_16x16x32_bf16 v[148:151], a[84:87], v[40:43], v[148:151]
    ds_read_b128 v[84:87], v11 offset:26624
    v_mfma_f32_16x16x32_bf16 v[152:155], a[80:83], v[44:47], v[152:155]
    ds_read_b128 v[88:91], v11 offset:28672
    v_mfma_f32_16x16x32_bf16 v[156:159], a[84:87], v[44:47], v[156:159]
    ds_read_b128 v[92:95], v11 offset:30720
    v_mfma_f32_16x16x32_bf16 v[160:163], a[80:83], v[48:51], v[160:163]
    v_mfma_f32_16x16x32_bf16 v[164:167], a[84:87], v[48:51], v[164:167]
    v_mfma_f32_16x16x32_bf16 v[168:171], a[80:83], v[52:55], v[168:171]
    v_mfma_f32_16x16x32_bf16 v[172:175], a[84:87], v[52:55], v[172:175]
    v_mfma_f32_16x16x32_bf16 v[176:179], a[80:83], v[56:59], v[176:179]
    buffer_load_dwordx4 v5, s[12:15], s50 offen offset:1024 sc1 lds
    v_mfma_f32_16x16x32_bf16 v[180:183], a[84:87], v[56:59], v[180:183]
    s_waitcnt vmcnt(22) lgkmcnt(0)
    s_barrier
    v_mfma_f32_16x16x32_bf16 v[184:187], a[80:83], v[60:63], v[184:187]
    v_mfma_f32_16x16x32_bf16 v[188:191], a[84:87], v[60:63], v[188:191]
    v_mfma_f32_16x16x32_bf16 v[128:131], a[88:91], v[64:67], v[128:131]
    ds_read_b128 v[32:35], v10 offset:32768
    v_mfma_f32_16x16x32_bf16 v[132:135], a[92:95], v[64:67], v[132:135]
    ds_read_b128 v[36:39], v10 offset:34816
    v_mfma_f32_16x16x32_bf16 v[136:139], a[88:91], v[68:71], v[136:139]
    ds_read_b128 v[40:43], v10 offset:36864
    v_mfma_f32_16x16x32_bf16 v[140:143], a[92:95], v[68:71], v[140:143]
    ds_read_b128 v[44:47], v10 offset:38912
    v_mfma_f32_16x16x32_bf16 v[144:147], a[88:91], v[72:75], v[144:147]
    ds_read_b128 v[48:51], v10 offset:40960
    buffer_load_dwordx4 v6, s[12:15], s50 offen offset:2048 sc1 lds
    v_mfma_f32_16x16x32_bf16 v[148:151], a[92:95], v[72:75], v[148:151]
    ds_read_b128 v[52:55], v10 offset:43008
    v_mfma_f32_16x16x32_bf16 v[152:155], a[88:91], v[76:79], v[152:155]
    ds_read_b128 v[56:59], v10 offset:45056
    v_mfma_f32_16x16x32_bf16 v[156:159], a[92:95], v[76:79], v[156:159]
    ds_read_b128 v[60:63], v10 offset:47104
    v_mfma_f32_16x16x32_bf16 v[160:163], a[88:91], v[80:83], v[160:163]
    v_mfma_f32_16x16x32_bf16 v[164:167], a[92:95], v[80:83], v[164:167]
    v_mfma_f32_16x16x32_bf16 v[168:171], a[88:91], v[84:87], v[168:171]
    v_mfma_f32_16x16x32_bf16 v[172:175], a[92:95], v[84:87], v[172:175]
    v_mfma_f32_16x16x32_bf16 v[176:179], a[88:91], v[88:91], v[176:179]
    buffer_load_dwordx4 v7, s[12:15], s50 offen offset:3072 sc1 lds
    s_add_u32 s28, s28, 128
    v_mfma_f32_16x16x32_bf16 v[180:183], a[92:95], v[88:91], v[180:183]
    v_mfma_f32_16x16x32_bf16 v[184:187], a[88:91], v[92:95], v[184:187]
    v_mfma_f32_16x16x32_bf16 v[188:191], a[92:95], v[92:95], v[188:191]
    s_cmp_le_u32 s34, 6
    s_cbranch_scc1 be_65
    s_waitcnt lgkmcnt(0)
    v_mfma_f32_16x16x32_bf16 v[128:131], a[96:99], v[32:35], v[128:131]
    ds_read_b128 v[64:67], v11 offset:32768
    v_mfma_f32_16x16x32_bf16 v[132:135], a[100:103], v[32:35], v[132:135]
    ds_read_b128 v[68:71], v11 offset:34816
    v_mfma_f32_16x16x32_bf16 v[136:139], a[96:99], v[36:39], v[136:139]
    ds_read_b128 v[72:75], v11 offset:36864
    v_mfma_f32_16x16x32_bf16 v[140:143], a[100:103], v[36:39], v[140:143]
    ds_read_b128 v[76:79], v11 offset:38912
    v_mfma_f32_16x16x32_bf16 v[144:147], a[96:99], v[40:43], v[144:147]
    ds_read_b128 v[80:83], v11 offset:40960
    s_cmp_lt_u32 s35, s34
    s_cselect_b32 s50, s28, 0x70000000
    s_add_u32 m0, s54, 81920
    s_add_u32 s35, s35, 1
    buffer_load_dwordx4 v4, s[12:15], s50 offen offset:0 sc1 lds
    v_mfma_f32_16x16x32_bf16 v[148:151], a[100:103], v[40:43], v[148:151]
    ds_read_b128 v[84:87], v11 offset:43008
    v_mfma_f32_16x16x32_bf16 v[152:155], a[96:99], v[44:47], v[152:155]
    ds_read_b128 v[88:91], v11 offset:45056
    v_mfma_f32_16x16x32_bf16 v[156:159], a[100:103], v[44:47], v[156:159]
    ds_read_b128 v[92:95], v11 offset:47104
    v_mfma_f32_16x16x32_bf16 v[160:163], a[96:99], v[48:51], v[160:163]
    v_mfma_f32_16x16x32_bf16 v[164:167], a[100:103], v[48:51], v[164:167]
    v_mfma_f32_16x16x32_bf16 v[168:171], a[96:99], v[52:55], v[168:171]
    v_mfma_f32_16x16x32_bf16 v[172:175], a[100:103], v[52:55], v[172:175]
    v_mfma_f32_16x16x32_bf16 v[176:179], a[96:99], v[56:59], v[176:179]
    buffer_load_dwordx4 v5, s[12:15], s50 offen offset:1024 sc1 lds
    v_mfma_f32_16x16x32_bf16 v[180:183], a[100:103], v[56:59], v[180:183]
    s_waitcnt vmcnt(22) lgkmcnt(0)
    s_barrier
    v_mfma_f32_16x16x32_bf16 v[184:187], a[96:99], v[60:63], v[184:187]
    v_mfma_f32_16x16x32_bf16 v[188:191], a[100:103], v[60:63], v[188:191]
    v_mfma_f32_16x16x32_bf16 v[128:131], a[104:107], v[64:67], v[128:131]
    ds_read_b128 v[32:35], v10 offset:49152
    v_mfma_f32_16x16x32_bf16 v[132:135], a[108:111], v[64:67], v[132:135]
    ds_read_b128 v[36:39], v10 offset:51200
    v_mfma_f32_16x16x32_bf16 v[136:139], a[104:107], v[68:71], v[136:139]
    ds_read_b128 v[40:43], v10 offset:53248
    v_mfma_f32_16x16x32_bf16 v[140:143], a[108:111], v[68:71], v[140:143]
    ds_read_b128 v[44:47], v10 offset:55296
    v_mfma_f32_16x16x32_bf16 v[144:147], a[104:107], v[72:75], v[144:147]
    ds_read_b128 v[48:51], v10 offset:57344
    buffer_load_dwordx4 v6, s[12:15], s50 offen offset:2048 sc1 lds
    v_mfma_f32_16x16x32_bf16 v[148:151], a[108:111], v[72:75], v[148:151]
    ds_read_b128 v[52:55], v10 offset:59392
    v_mfma_f32_16x16x32_bf16 v[152:155], a[104:107], v[76:79], v[152:155]
    ds_read_b128 v[56:59], v10 offset:61440
    v_mfma_f32_16x16x32_bf16 v[156:159], a[108:111], v[76:79], v[156:159]
    ds_read_b128 v[60:63], v10 offset:63488
    v_mfma_f32_16x16x32_bf16 v[160:163], a[104:107], v[80:83], v[160:163]
    v_mfma_f32_16x16x32_bf16 v[164:167], a[108:111], v[80:83], v[164:167]
    v_mfma_f32_16x16x32_bf16 v[168:171], a[104:107], v[84:87], v[168:171]
    v_mfma_f32_16x16x32_bf16 v[172:175], a[108:111], v[84:87], v[172:175]
    v_mfma_f32_16x16x32_bf16 v[176:179], a[104:107], v[88:91], v[176:179]
    buffer_load_dwordx4 v7, s[12:15], s50 offen offset:3072 sc1 lds
    s_add_u32 s28, s28, 128
    v_mfma_f32_16x16x32_bf16 v[180:183], a[108:111], v[88:91], v[180:183]
    v_mfma_f32_16x16x32_bf16 v[184:187], a[104:107], v[92:95], v[184:187]
    v_mfma_f32_16x16x32_bf16 v[188:191], a[108:111], v[92:95], v[188:191]
    s_cmp_le_u32 s34, 7
    s_cbranch_scc1 be_65
    s_waitcnt lgkmcnt(0)
    v_mfma_f32_16x16x32_bf16 v[128:131], a[112:115], v[32:35], v[128:131]
    ds_read_b128 v[64:67], v11 offset:49152
    v_mfma_f32_16x16x32_bf16 v[132:135], a[116:119], v[32:35], v[132:135]
    ds_read_b128 v[68:71], v11 offset:51200
    v_mfma_f32_16x16x32_bf16 v[136:139], a[112:115], v[36:39], v[136:139]
    ds_read_b128 v[72:75], v11 offset:53248
    v_mfma_f32_16x16x32_bf16 v[140:143], a[116:119], v[36:39], v[140:143]
    ds_read_b128 v[76:79], v11 offset:55296
    v_mfma_f32_16x16x32_bf16 v[144:147], a[112:115], v[40:43], v[144:147]
    ds_read_b128 v[80:83], v11 offset:57344
    s_cmp_lt_u32 s35, s34
    s_cselect_b32 s50, s28, 0x70000000
    s_add_u32 m0, s54, 98304
    s_add_u32 s35, s35, 1
    buffer_load_dwordx4 v4, s[12:15], s50 offen offset:0 sc1 lds
    v_mfma_f32_16x16x32_bf16 v[148:151], a[116:119], v[40:43], v[148:151]
    ds_read_b128 v[84:87], v11 offset:59392
    v_mfma_f32_16x16x32_bf16 v[152:155], a[112:115], v[44:47], v[152:155]
    ds_read_b128 v[88:91], v11 offset:61440
    v_mfma_f32_16x16x32_bf16 v[156:159], a[116:119], v[44:47], v[156:159]
    ds_read_b128 v[92:95], v11 offset:63488
    v_mfma_f32_16x16x32_bf16 v[160:163], a[112:115], v[48:51], v[160:163]
    v_mfma_f32_16x16x32_bf16 v[164:167], a[116:119], v[48:51], v[164:167]
    v_mfma_f32_16x16x32_bf16 v[168:171], a[112:115], v[52:55], v[168:171]
    v_mfma_f32_16x16x32_bf16 v[172:175], a[116:119], v[52:55], v[172:175]
    v_mfma_f32_16x16x32_bf16 v[176:179], a[112:115], v[56:59], v[176:179]
    buffer_load_dwordx4 v5, s[12:15], s50 offen offset:1024 sc1 lds
    v_mfma_f32_16x16x32_bf16 v[180:183], a[116:119], v[56:59], v[180:183]
    s_waitcnt vmcnt(22) lgkmcnt(0)
    s_barrier
    v_mfma_f32_16x16x32_bf16 v[184:187], a[112:115], v[60:63], v[184:187]
    v_mfma_f32_16x16x32_bf16 v[188:191], a[116:119], v[60:63], v[188:191]
    v_mfma_f32_16x16x32_bf16 v[128:131], a[120:123], v[64:67], v[128:131]
    ds_read_b128 v[32:35], v8 offset:0
    v_mfma_f32_16x16x32_bf16 v[132:135], a[124:127], v[64:67], v[132:135]
    ds_read_b128 v[36:39], v8 offset:2048
    v_mfma_f32_16x16x32_bf16 v[136:139], a[120:123], v[68:71], v[136:139]
    ds_read_b128 v[40:43], v8 offset:4096
    v_mfma_f32_16x16x32_bf16 v[140:143], a[124:127], v[68:71], v[140:143]
    ds_read_b128 v[44:47], v8 offset:6144
    v_mfma_f32_16x16x32_bf16 v[144:147], a[120:123], v[72:75], v[144:147]
    ds_read_b128 v[48:51], v8 offset:8192
    buffer_load_dwordx4 v6, s[12:15], s50 offen offset:2048 sc1 lds
    v_mfma_f32_16x16x32_bf16 v[148:151], a[124:127], v[72:75], v[148:151]
    ds_read_b128 v[52:55], v8 offset:10240
    v_mfma_f32_16x16x32_bf16 v[152:155], a[120:123], v[76:79], v[152:155]
    ds_read_b128 v[56:59], v8 offset:12288
    v_mfma_f32_16x16x32_bf16 v[156:159], a[124:127], v[76:79], v[156:159]
    ds_read_b128 v[60:63], v8 offset:14336
    v_mfma_f32_16x16x32_bf16 v[160:163], a[120:123], v[80:83], v[160:163]
    v_mfma_f32_16x16x32_bf16 v[164:167], a[124:127], v[80:83], v[164:167]
    v_mfma_f32_16x16x32_bf16 v[168:171], a[120:123], v[84:87], v[168:171]
    v_mfma_f32_16x16x32_bf16 v[172:175], a[124:127], v[84:87], v[172:175]
    v_mfma_f32_16x16x32_bf16 v[176:179], a[120:123], v[88:91], v[176:179]
    buffer_load_dwordx4 v7, s[12:15], s50 offen offset:3072 sc1 lds
    s_add_u32 s28, s28, 128
    v_mfma_f32_16x16x32_bf16 v[180:183], a[124:127], v[88:91], v[180:183]
    v_mfma_f32_16x16x32_bf16 v[184:187], a[120:123], v[92:95], v[184:187]
    v_mfma_f32_16x16x32_bf16 v[188:191], a[124:127], v[92:95], v[188:191]
    s_cmp_le_u32 s34, 8
    s_cbranch_scc1 be_65
    s_waitcnt lgkmcnt(0)
    v_mfma_f32_16x16x32_bf16 v[128:131], a[128:131], v[32:35], v[128:131]
    ds_read_b128 v[64:67], v9 offset:0
    v_mfma_f32_16x16x32_bf16 v[132:135], a[132:135], v[32:35], v[132:135]
    ds_read_b128 v[68:71], v9 offset:2048
    v_mfma_f32_16x16x32_bf16 v[136:139], a[128:131], v[36:39], v[136:139]
    ds_read_b128 v[72:75], v9 offset:4096
    v_mfma_f32_16x16x32_bf16 v[140:143], a[132:135], v[36:39], v[140:143]
    ds_read_b128 v[76:79], v9 offset:6144
    v_mfma_f32_16x16x32_bf16 v[144:147], a[128:131], v[40:43], v[144:147]
    ds_read_b128 v[80:83], v9 offset:8192
    s_cmp_lt_u32 s35, s34
    s_cselect_b32 s50, s28, 0x70000000
    s_add_u32 m0, s54, 114688
    s_add_u32 s35, s35, 1
    buffer_load_dwordx4 v4, s[12:15], s50 offen offset:0 sc1 lds
    v_mfma_f32_16x16x32_bf16 v[148:151], a[132:135], v[40:43], v[148:151]
    ds_read_b128 v[84:87], v9 offset:10240
    v_mfma_f32_16x16x32_bf16 v[152:155], a[128:131], v[44:47], v[152:155]
    ds_read_b128 v[88:91], v9 offset:12288
    v_mfma_f32_16x16x32_bf16 v[156:159], a[132:135], v[44:47], v[156:159]
    ds_read_b128 v[92:95], v9 offset:14336
    v_mfma_f32_16x16x32_bf16 v[160:163], a[128:131], v[48:51], v[160:163]
    v_mfma_f32_16x16x32_bf16 v[164:167], a[132:135], v[48:51], v[164:167]
    v_mfma_f32_16x16x32_bf16 v[168:171], a[128:131], v[52:55], v[168:171]
    v_mfma_f32_16x16x32_bf16 v[172:175], a[132:135], v[52:55], v[172:175]
    v_mfma_f32_16x16x32_bf16 v[176:179], a[128:131], v[56:59], v[176:179]
    buffer_load_dwordx4 v5, s[12:15], s50 offen offset:1024 sc1 lds
    v_mfma_f32_16x16x32_bf16 v[180:183], a[132:135], v[56:59], v[180:183]
    s_waitcnt vmcnt(22) lgkmcnt(0)
    s_barrier
    v_mfma_f32_16x16x32_bf16 v[184:187], a[128:131], v[60:63], v[184:187]
    v_mfma_f32_16x16x32_bf16 v[188:191], a[132:135], v[60:63], v[188:191]
    v_mfma_f32_16x16x32_bf16 v[128:131], a[136:139], v[64:67], v[128:131]
    ds_read_b128 v[32:35], v8 offset:16384
    v_mfma_f32_16x16x32_bf16 v[132:135], a[140:143], v[64:67], v[132:135]
    ds_read_b128 v[36:39], v8 offset:18432
    v_mfma_f32_16x16x32_bf16 v[136:139], a[136:139], v[68:71], v[136:139]
    ds_read_b128 v[40:43], v8 offset:20480
    v_mfma_f32_16x16x32_bf16 v[140:143], a[140:143], v[68:71], v[140:143]
    ds_read_b128 v[44:47], v8 offset:22528
    v_mfma_f32_16x16x32_bf16 v[144:147], a[136:139], v[72:75], v[144:147]
    ds_read_b128 v[48:51], v8 offset:24576
    buffer_load_dwordx4 v6, s[12:15], s50 offen offset:2048 sc1 lds
    v_mfma_f32_16x16x32_bf16 v[148:151], a[140:143], v[72:75], v[148:151]
    ds_read_b128 v[52:55], v8 offset:26624
    v_mfma_f32_16x16x32_bf16 v[152:155], a[136:139], v[76:79], v[152:155]
    ds_read_b128 v[56:59], v8 offset:28672
    v_mfma_f32_16x16x32_bf16 v[156:159], a[140:143], v[76:79], v[156:159]
    ds_read_b128 v[60:63], v8 offset:30720
    v_mfma_f32_16x16x32_bf16 v[160:163], a[136:139], v[80:83], v[160:163]
    v_mfma_f32_16x16x32_bf16 v[164:167], a[140:143], v[80:83], v[164:167]
    v_mfma_f32_16x16x32_bf16 v[168:171], a[136:139], v[84:87], v[168:171]
    v_mfma_f32_16x16x32_bf16 v[172:175], a[140:143], v[84:87], v[172:175]
    v_mfma_f32_16x16x32_bf16 v[176:179], a[136:139], v[88:91], v[176:179]
    buffer_load_dwordx4 v7, s[12:15], s50 offen offset:3072 sc1 lds
    s_add_u32 s28, s28, 128
    v_mfma_f32_16x16x32_bf16 v[180:183], a[140:143], v[88:91], v[180:183]
    v_mfma_f32_16x16x32_bf16 v[184:187], a[136:139], v[92:95], v[184:187]
    v_mfma_f32_16x16x32_bf16 v[188:191], a[140:143], v[92:95], v[188:191]
    s_cmp_le_u32 s34, 9
    s_cbranch_scc1 be_65
    s_waitcnt lgkmcnt(0)
    v_mfma_f32_16x16x32_bf16 v[128:131], a[144:147], v[32:35], v[128:131]
    ds_read_b128 v[64:67], v9 offset:16384
    v_mfma_f32_16x16x32_bf16 v[132:135], a[148:151], v[32:35], v[132:135]
    ds_read_b128 v[68:71], v9 offset:18432
    v_mfma_f32_16x16x32_bf16 v[136:139], a[144:147], v[36:39], v[136:139]
    ds_read_b128 v[72:75], v9 offset:20480
    v_mfma_f32_16x16x32_bf16 v[140:143], a[148:151], v[36:39], v[140:143]
    ds_read_b128 v[76:79], v9 offset:22528
    v_mfma_f32_16x16x32_bf16 v[144:147], a[144:147], v[40:43], v[144:147]
    ds_read_b128 v[80:83], v9 offset:24576
    v_mfma_f32_16x16x32_bf16 v[148:151], a[148:151], v[40:43], v[148:151]
    ds_read_b128 v[84:87], v9 offset:26624
    v_mfma_f32_16x16x32_bf16 v[152:155], a[144:147], v[44:47], v[152:155]
    ds_read_b128 v[88:91], v9 offset:28672
    v_mfma_f32_16x16x32_bf16 v[156:159], a[148:151], v[44:47], v[156:159]
    ds_read_b128 v[92:95], v9 offset:30720
    v_mfma_f32_16x16x32_bf16 v[160:163], a[144:147], v[48:51], v[160:163]
    v_mfma_f32_16x16x32_bf16 v[164:167], a[148:151], v[48:51], v[164:167]
    v_mfma_f32_16x16x32_bf16 v[168:171], a[144:147], v[52:55], v[168:171]
    v_mfma_f32_16x16x32_bf16 v[172:175], a[148:151], v[52:55], v[172:175]
    v_mfma_f32_16x16x32_bf16 v[176:179], a[144:147], v[56:59], v[176:179]
    v_mfma_f32_16x16x32_bf16 v[180:183], a[148:151], v[56:59], v[180:183]
    s_waitcnt vmcnt(20) lgkmcnt(0)
    s_barrier
    v_mfma_f32_16x16x32_bf16 v[184:187], a[144:147], v[60:63], v[184:187]
    v_mfma_f32_16x16x32_bf16 v[188:191], a[148:151], v[60:63], v[188:191]
    v_mfma_f32_16x16x32_bf16 v[128:131], a[152:155], v[64:67], v[128:131]
    ds_read_b128 v[32:35], v8 offset:32768
    v_mfma_f32_16x16x32_bf16 v[132:135], a[156:159], v[64:67], v[132:135]
    ds_read_b128 v[36:39], v8 offset:34816
    v_mfma_f32_16x16x32_bf16 v[136:139], a[152:155], v[68:71], v[136:139]
    ds_read_b128 v[40:43], v8 offset:36864
    v_mfma_f32_16x16x32_bf16 v[140:143], a[156:159], v[68:71], v[140:143]
    ds_read_b128 v[44:47], v8 offset:38912
    v_mfma_f32_16x16x32_bf16 v[144:147], a[152:155], v[72:75], v[144:147]
    ds_read_b128 v[48:51], v8 offset:40960
    v_mfma_f32_16x16x32_bf16 v[148:151], a[156:159], v[72:75], v[148:151]
    ds_read_b128 v[52:55], v8 offset:43008
    v_mfma_f32_16x16x32_bf16 v[152:155], a[152:155], v[76:79], v[152:155]
    ds_read_b128 v[56:59], v8 offset:45056
    v_mfma_f32_16x16x32_bf16 v[156:159], a[156:159], v[76:79], v[156:159]
    ds_read_b128 v[60:63], v8 offset:47104
    v_mfma_f32_16x16x32_bf16 v[160:163], a[152:155], v[80:83], v[160:163]
    v_mfma_f32_16x16x32_bf16 v[164:167], a[156:159], v[80:83], v[164:167]
    v_mfma_f32_16x16x32_bf16 v[168:171], a[152:155], v[84:87], v[168:171]
    v_mfma_f32_16x16x32_bf16 v[172:175], a[156:159], v[84:87], v[172:175]
    v_mfma_f32_16x16x32_bf16 v[176:179], a[152:155], v[88:91], v[176:179]
    v_mfma_f32_16x16x32_bf16 v[180:183], a[156:159], v[88:91], v[180:183]
    v_mfma_f32_16x16x32_bf16 v[184:187], a[152:155], v[92:95], v[184:187]
    v_mfma_f32_16x16x32_bf16 v[188:191], a[156:159], v[92:95], v[188:191]
    s_cmp_le_u32 s34, 10
    s_cbranch_scc1 be_65
    s_waitcnt lgkmcnt(0)
    v_mfma_f32_16x16x32_bf16 v[128:131], a[160:163], v[32:35], v[128:131]
    ds_read_b128 v[64:67], v9 offset:32768
    v_mfma_f32_16x16x32_bf16 v[132:135], a[164:167], v[32:35], v[132:135]
    ds_read_b128 v[68:71], v9 offset:34816
    v_mfma_f32_16x16x32_bf16 v[136:139], a[160:163], v[36:39], v[136:139]
    ds_read_b128 v[72:75], v9 offset:36864
    v_mfma_f32_16x16x32_bf16 v[140:143], a[164:167], v[36:39], v[140:143]
    ds_read_b128 v[76:79], v9 offset:38912
    v_mfma_f32_16x16x32_bf16 v[144:147], a[160:163], v[40:43], v[144:147]
    ds_read_b128 v[80:83], v9 offset:40960
    v_mfma_f32_16x16x32_bf16 v[148:151], a[164:167], v[40:43], v[148:151]
    ds_read_b128 v[84:87], v9 offset:43008
    v_mfma_f32_16x16x32_bf16 v[152:155], a[160:163], v[44:47], v[152:155]
    ds_read_b128 v[88:91], v9 offset:45056
    v_mfma_f32_16x16x32_bf16 v[156:159], a[164:167], v[44:47], v[156:159]
    ds_read_b128 v[92:95], v9 offset:47104
    v_mfma_f32_16x16x32_bf16 v[160:163], a[160:163], v[48:51], v[160:163]
    v_mfma_f32_16x16x32_bf16 v[164:167], a[164:167], v[48:51], v[164:167]
    v_mfma_f32_16x16x32_bf16 v[168:171], a[160:163], v[52:55], v[168:171]
    v_mfma_f32_16x16x32_bf16 v[172:175], a[164:167], v[52:55], v[172:175]
    v_mfma_f32_16x16x32_bf16 v[176:179], a[160:163], v[56:59], v[176:179]
    v_mfma_f32_16x16x32_bf16 v[180:183], a[164:167], v[56:59], v[180:183]
    s_waitcnt vmcnt(16) lgkmcnt(0)
    s_barrier
    v_mfma_f32_16x16x32_bf16 v[184:187], a[160:163], v[60:63], v[184:187]
    v_mfma_f32_16x16x32_bf16 v[188:191], a[164:167], v[60:63], v[188:191]
    v_mfma_f32_16x16x32_bf16 v[128:131], a[168:171], v[64:67], v[128:131]
    ds_read_b128 v[32:35], v8 offset:49152
    v_mfma_f32_16x16x32_bf16 v[132:135], a[172:175], v[64:67], v[132:135]
    ds_read_b128 v[36:39], v8 offset:51200
    v_mfma_f32_16x16x32_bf16 v[136:139], a[168:171], v[68:71], v[136:139]
    ds_read_b128 v[40:43], v8 offset:53248
    v_mfma_f32_16x16x32_bf16 v[140:143], a[172:175], v[68:71], v[140:143]
    ds_read_b128 v[44:47], v8 offset:55296
    v_mfma_f32_16x16x32_bf16 v[144:147], a[168:171], v[72:75], v[144:147]
    ds_read_b128 v[48:51], v8 offset:57344
    v_mfma_f32_16x16x32_bf16 v[148:151], a[172:175], v[72:75], v[148:151]
    ds_read_b128 v[52:55], v8 offset:59392
    v_mfma_f32_16x16x32_bf16 v[152:155], a[168:171], v[76:79], v[152:155]
    ds_read_b128 v[56:59], v8 offset:61440
    v_mfma_f32_16x16x32_bf16 v[156:159], a[172:175], v[76:79], v[156:159]
    ds_read_b128 v[60:63], v8 offset:63488
    v_mfma_f32_16x16x32_bf16 v[160:163], a[168:171], v[80:83], v[160:163]
    v_mfma_f32_16x16x32_bf16 v[164:167], a[172:175], v[80:83], v[164:167]
    v_mfma_f32_16x16x32_bf16 v[168:171], a[168:171], v[84:87], v[168:171]
    v_mfma_f32_16x16x32_bf16 v[172:175], a[172:175], v[84:87], v[172:175]
    v_mfma_f32_16x16x32_bf16 v[176:179], a[168:171], v[88:91], v[176:179]
    v_mfma_f32_16x16x32_bf16 v[180:183], a[172:175], v[88:91], v[180:183]
    v_mfma_f32_16x16x32_bf16 v[184:187], a[168:171], v[92:95], v[184:187]
    v_mfma_f32_16x16x32_bf16 v[188:191], a[172:175], v[92:95], v[188:191]
    s_cmp_le_u32 s34, 11
    s_cbranch_scc1 be_65
    s_waitcnt lgkmcnt(0)
    v_mfma_f32_16x16x32_bf16 v[128:131], a[176:179], v[32:35], v[128:131]
    ds_read_b128 v[64:67], v9 offset:49152
    v_mfma_f32_16x16x32_bf16 v[132:135], a[180:183], v[32:35], v[132:135]
    ds_read_b128 v[68:71], v9 offset:51200
    v_mfma_f32_16x16x32_bf16 v[136:139], a[176:179], v[36:39], v[136:139]
    ds_read_b128 v[72:75], v9 offset:53248
    v_mfma_f32_16x16x32_bf16 v[140:143], a[180:183], v[36:39], v[140:143]
    ds_read_b128 v[76:79], v9 offset:55296
    v_mfma_f32_16x16x32_bf16 v[144:147], a[176:179], v[40:43], v[144:147]
    ds_read_b128 v[80:83], v9 offset:57344
    v_mfma_f32_16x16x32_bf16 v[148:151], a[180:183], v[40:43], v[148:151]
    ds_read_b128 v[84:87], v9 offset:59392
    v_mfma_f32_16x16x32_bf16 v[152:155], a[176:179], v[44:47], v[152:155]
    ds_read_b128 v[88:91], v9 offset:61440
    v_mfma_f32_16x16x32_bf16 v[156:159], a[180:183], v[44:47], v[156:159]
    ds_read_b128 v[92:95], v9 offset:63488
    v_mfma_f32_16x16x32_bf16 v[160:163], a[176:179], v[48:51], v[160:163]
    v_mfma_f32_16x16x32_bf16 v[164:167], a[180:183], v[48:51], v[164:167]
    v_mfma_f32_16x16x32_bf16 v[168:171], a[176:179], v[52:55], v[168:171]
    v_mfma_f32_16x16x32_bf16 v[172:175], a[180:183], v[52:55], v[172:175]
    v_mfma_f32_16x16x32_bf16 v[176:179], a[176:179], v[56:59], v[176:179]
    v_mfma_f32_16x16x32_bf16 v[180:183], a[180:183], v[56:59], v[180:183]
    s_waitcnt vmcnt(12) lgkmcnt(0)
    s_barrier
    v_mfma_f32_16x16x32_bf16 v[184:187], a[176:179], v[60:63], v[184:187]
    v_mfma_f32_16x16x32_bf16 v[188:191], a[180:183], v[60:63], v[188:191]
    v_mfma_f32_16x16x32_bf16 v[128:131], a[184:187], v[64:67], v[128:131]
    ds_read_b128 v[32:35], v10 offset:0
    v_mfma_f32_16x16x32_bf16 v[132:135], a[188:191], v[64:67], v[132:135]
    ds_read_b128 v[36:39], v10 offset:2048
    v_mfma_f32_16x16x32_bf16 v[136:139], a[184:187], v[68:71], v[136:139]
    ds_read_b128 v[40:43], v10 offset:4096
    v_mfma_f32_16x16x32_bf16 v[140:143], a[188:191], v[68:71], v[140:143]
    ds_read_b128 v[44:47], v10 offset:6144
    v_mfma_f32_16x16x32_bf16 v[144:147], a[184:187], v[72:75], v[144:147]
    ds_read_b128 v[48:51], v10 offset:8192
    v_mfma_f32_16x16x32_bf16 v[148:151], a[188:191], v[72:75], v[148:151]
    ds_read_b128 v[52:55], v10 offset:10240
    v_mfma_f32_16x16x32_bf16 v[152:155], a[184:187], v[76:79], v[152:155]
    ds_read_b128 v[56:59], v10 offset:12288
    v_mfma_f32_16x16x32_bf16 v[156:159], a[188:191], v[76:79], v[156:159]
    ds_read_b128 v[60:63], v10 offset:14336
    v_mfma_f32_16x16x32_bf16 v[160:163], a[184:187], v[80:83], v[160:163]
    v_mfma_f32_16x16x32_bf16 v[164:167], a[188:191], v[80:83], v[164:167]
    v_mfma_f32_16x16x32_bf16 v[168:171], a[184:187], v[84:87], v[168:171]
    v_mfma_f32_16x16x32_bf16 v[172:175], a[188:191], v[84:87], v[172:175]
    v_mfma_f32_16x16x32_bf16 v[176:179], a[184:187], v[88:91], v[176:179]
    v_mfma_f32_16x16x32_bf16 v[180:183], a[188:191], v[88:91], v[180:183]
    v_mfma_f32_16x16x32_bf16 v[184:187], a[184:187], v[92:95], v[184:187]
    v_mfma_f32_16x16x32_bf16 v[188:191], a[188:191], v[92:95], v[188:191]
    s_cmp_le_u32 s34, 12
    s_cbranch_scc1 be_65
    s_waitcnt lgkmcnt(0)
    v_mfma_f32_16x16x32_bf16 v[128:131], a[192:195], v[32:35], v[128:131]
    ds_read_b128 v[64:67], v11 offset:0
    v_mfma_f32_16x16x32_bf16 v[132:135], a[196:199], v[32:35], v[132:135]
    ds_read_b128 v[68:71], v11 offset:2048
    v_mfma_f32_16x16x32_bf16 v[136:139], a[192:195], v[36:39], v[136:139]
    ds_read_b128 v[72:75], v11 offset:4096
    v_mfma_f32_16x16x32_bf16 v[140:143], a[196:199], v[36:39], v[140:143]
    ds_read_b128 v[76:79], v11 offset:6144
    v_mfma_f32_16x16x32_bf16 v[144:147], a[192:195], v[40:43], v[144:147]
    ds_read_b128 v[80:83], v11 offset:8192
    v_mfma_f32_16x16x32_bf16 v[148:151], a[196:199], v[40:43], v[148:151]
    ds_read_b128 v[84:87], v11 offset:10240
    v_mfma_f32_16x16x32_bf16 v[152:155], a[192:195], v[44:47], v[152:155]
    ds_read_b128 v[88:91], v11 offset:12288
    v_mfma_f32_16x16x32_bf16 v[156:159], a[196:199], v[44:47], v[156:159]
    ds_read_b128 v[92:95], v11 offset:14336
    v_mfma_f32_16x16x32_bf16 v[160:163], a[192:195], v[48:51], v[160:163]
    v_mfma_f32_16x16x32_bf16 v[164:167], a[196:199], v[48:51], v[164:167]
    v_mfma_f32_16x16x32_bf16 v[168:171], a[192:195], v[52:55], v[168:171]
    v_mfma_f32_16x16x32_bf16 v[172:175], a[196:199], v[52:55], v[172:175]
    v_mfma_f32_16x16x32_bf16 v[176:179], a[192:195], v[56:59], v[176:179]
    v_mfma_f32_16x16x32_bf16 v[180:183], a[196:199], v[56:59], v[180:183]
    s_waitcnt vmcnt(8) lgkmcnt(0)
    s_barrier
    v_mfma_f32_16x16x32_bf16 v[184:187], a[192:195], v[60:63], v[184:187]
    v_mfma_f32_16x16x32_bf16 v[188:191], a[196:199], v[60:63], v[188:191]
    v_mfma_f32_16x16x32_bf16 v[128:131], a[200:203], v[64:67], v[128:131]
    ds_read_b128 v[32:35], v10 offset:16384
    v_mfma_f32_16x16x32_bf16 v[132:135], a[204:207], v[64:67], v[132:135]
    ds_read_b128 v[36:39], v10 offset:18432
    v_mfma_f32_16x16x32_bf16 v[136:139], a[200:203], v[68:71], v[136:139]
    ds_read_b128 v[40:43], v10 offset:20480
    v_mfma_f32_16x16x32_bf16 v[140:143], a[204:207], v[68:71], v[140:143]
    ds_read_b128 v[44:47], v10 offset:22528
    v_mfma_f32_16x16x32_bf16 v[144:147], a[200:203], v[72:75], v[144:147]
    ds_read_b128 v[48:51], v10 offset:24576
    v_mfma_f32_16x16x32_bf16 v[148:151], a[204:207], v[72:75], v[148:151]
    ds_read_b128 v[52:55], v10 offset:26624
    v_mfma_f32_16x16x32_bf16 v[152:155], a[200:203], v[76:79], v[152:155]
    ds_read_b128 v[56:59], v10 offset:28672
    v_mfma_f32_16x16x32_bf16 v[156:159], a[204:207], v[76:79], v[156:159]
    ds_read_b128 v[60:63], v10 offset:30720
    v_mfma_f32_16x16x32_bf16 v[160:163], a[200:203], v[80:83], v[160:163]
    v_mfma_f32_16x16x32_bf16 v[164:167], a[204:207], v[80:83], v[164:167]
    v_mfma_f32_16x16x32_bf16 v[168:171], a[200:203], v[84:87], v[168:171]
    v_mfma_f32_16x16x32_bf16 v[172:175], a[204:207], v[84:87], v[172:175]
    v_mfma_f32_16x16x32_bf16 v[176:179], a[200:203], v[88:91], v[176:179]
    v_mfma_f32_16x16x32_bf16 v[180:183], a[204:207], v[88:91], v[180:183]
    v_mfma_f32_16x16x32_bf16 v[184:187], a[200:203], v[92:95], v[184:187]
    v_mfma_f32_16x16x32_bf16 v[188:191], a[204:207], v[92:95], v[188:191]
    s_cmp_le_u32 s34, 13
    s_cbranch_scc1 be_65
    s_waitcnt lgkmcnt(0)
    v_mfma_f32_16x16x32_bf16 v[128:131], a[208:211], v[32:35], v[128:131]
    ds_read_b128 v[64:67], v11 offset:16384
    v_mfma_f32_16x16x32_bf16 v[132:135], a[212:215], v[32:35], v[132:135]
    ds_read_b128 v[68:71], v11 offset:18432
    v_mfma_f32_16x16x32_bf16 v[136:139], a[208:211], v[36:39], v[136:139]
    ds_read_b128 v[72:75], v11 offset:20480
    v_mfma_f32_16x16x32_bf16 v[140:143], a[212:215], v[36:39], v[140:143]
    ds_read_b128 v[76:79], v11 offset:22528
    v_mfma_f32_16x16x32_bf16 v[144:147], a[208:211], v[40:43], v[144:147]
    ds_read_b128 v[80:83], v11 offset:24576
    v_mfma_f32_16x16x32_bf16 v[148:151], a[212:215], v[40:43], v[148:151]
    ds_read_b128 v[84:87], v11 offset:26624
    v_mfma_f32_16x16x32_bf16 v[152:155], a[208:211], v[44:47], v[152:155]
    ds_read_b128 v[88:91], v11 offset:28672
    v_mfma_f32_16x16x32_bf16 v[156:159], a[212:215], v[44:47], v[156:159]
    ds_read_b128 v[92:95], v11 offset:30720
    v_mfma_f32_16x16x32_bf16 v[160:163], a[208:211], v[48:51], v[160:163]
    v_mfma_f32_16x16x32_bf16 v[164:167], a[212:215], v[48:51], v[164:167]
    v_mfma_f32_16x16x32_bf16 v[168:171], a[208:211], v[52:55], v[168:171]
    v_mfma_f32_16x16x32_bf16 v[172:175], a[212:215], v[52:55], v[172:175]
    v_mfma_f32_16x16x32_bf16 v[176:179], a[208:211], v[56:59], v[176:179]
    v_mfma_f32_16x16x32_bf16 v[180:183], a[212:215], v[56:59], v[180:183]
    s_waitcnt vmcnt(4) lgkmcnt(0)
    s_barrier
    v_mfma_f32_16x16x32_bf16 v[184:187], a[208:211], v[60:63], v[184:187]
    v_mfma_f32_16x16x32_bf16 v[188:191], a[212:215], v[60:63], v[188:191]
    v_mfma_f32_16x16x32_bf16 v[128:131], a[216:219], v[64:67], v[128:131]
    ds_read_b128 v[32:35], v10 offset:32768
    v_mfma_f32_16x16x32_bf16 v[132:135], a[220:223], v[64:67], v[132:135]
    ds_read_b128 v[36:39], v10 offset:34816
    v_mfma_f32_16x16x32_bf16 v[136:139], a[216:219], v[68:71], v[136:139]
    ds_read_b128 v[40:43], v10 offset:36864
    v_mfma_f32_16x16x32_bf16 v[140:143], a[220:223], v[68:71], v[140:143]
    ds_read_b128 v[44:47], v10 offset:38912
    v_mfma_f32_16x16x32_bf16 v[144:147], a[216:219], v[72:75], v[144:147]
    ds_read_b128 v[48:51], v10 offset:40960
    v_mfma_f32_16x16x32_bf16 v[148:151], a[220:223], v[72:75], v[148:151]
    ds_read_b128 v[52:55], v10 offset:43008
    v_mfma_f32_16x16x32_bf16 v[152:155], a[216:219], v[76:79], v[152:155]
    ds_read_b128 v[56:59], v10 offset:45056
    v_mfma_f32_16x16x32_bf16 v[156:159], a[220:223], v[76:79], v[156:159]
    ds_read_b128 v[60:63], v10 offset:47104
    v_mfma_f32_16x16x32_bf16 v[160:163], a[216:219], v[80:83], v[160:163]
    v_mfma_f32_16x16x32_bf16 v[164:167], a[220:223], v[80:83], v[164:167]
    v_mfma_f32_16x16x32_bf16 v[168:171], a[216:219], v[84:87], v[168:171]
    v_mfma_f32_16x16x32_bf16 v[172:175], a[220:223], v[84:87], v[172:175]
    v_mfma_f32_16x16x32_bf16 v[176:179], a[216:219], v[88:91], v[176:179]
    v_mfma_f32_16x16x32_bf16 v[180:183], a[220:223], v[88:91], v[180:183]
    v_mfma_f32_16x16x32_bf16 v[184:187], a[216:219], v[92:95], v[184:187]
    v_mfma_f32_16x16x32_bf16 v[188:191], a[220:223], v[92:95], v[188:191]
    s_cmp_le_u32 s34, 14
    s_cbranch_scc1 be_65
    s_waitcnt lgkmcnt(0)
    v_mfma_f32_16x16x32_bf16 v[128:131], a[224:227], v[32:35], v[128:131]
    ds_read_b128 v[64:67], v11 offset:32768
    v_mfma_f32_16x16x32_bf16 v[132:135], a[228:231], v[32:35], v[132:135]
    ds_read_b128 v[68:71], v11 offset:34816
    v_mfma_f32_16x16x32_bf16 v[136:139], a[224:227], v[36:39], v[136:139]
    ds_read_b128 v[72:75], v11 offset:36864
    v_mfma_f32_16x16x32_bf16 v[140:143], a[228:231], v[36:39], v[140:143]
    ds_read_b128 v[76:79], v11 offset:38912
    v_mfma_f32_16x16x32_bf16 v[144:147], a[224:227], v[40:43], v[144:147]
    ds_read_b128 v[80:83], v11 offset:40960
    v_mfma_f32_16x16x32_bf16 v[148:151], a[228:231], v[40:43], v[148:151]
    ds_read_b128 v[84:87], v11 offset:43008
    v_mfma_f32_16x16x32_bf16 v[152:155], a[224:227], v[44:47], v[152:155]
    ds_read_b128 v[88:91], v11 offset:45056
    v_mfma_f32_16x16x32_bf16 v[156:159], a[228:231], v[44:47], v[156:159]
    ds_read_b128 v[92:95], v11 offset:47104
    v_mfma_f32_16x16x32_bf16 v[160:163], a[224:227], v[48:51], v[160:163]
    v_mfma_f32_16x16x32_bf16 v[164:167], a[228:231], v[48:51], v[164:167]
    v_mfma_f32_16x16x32_bf16 v[168:171], a[224:227], v[52:55], v[168:171]
    v_mfma_f32_16x16x32_bf16 v[172:175], a[228:231], v[52:55], v[172:175]
    v_mfma_f32_16x16x32_bf16 v[176:179], a[224:227], v[56:59], v[176:179]
    v_mfma_f32_16x16x32_bf16 v[180:183], a[228:231], v[56:59], v[180:183]
    s_waitcnt vmcnt(0) lgkmcnt(0)
    s_barrier
    v_mfma_f32_16x16x32_bf16 v[184:187], a[224:227], v[60:63], v[184:187]
    v_mfma_f32_16x16x32_bf16 v[188:191], a[228:231], v[60:63], v[188:191]
    v_mfma_f32_16x16x32_bf16 v[128:131], a[232:235], v[64:67], v[128:131]
    ds_read_b128 v[32:35], v10 offset:49152
    v_mfma_f32_16x16x32_bf16 v[132:135], a[236:239], v[64:67], v[132:135]
    ds_read_b128 v[36:39], v10 offset:51200
    v_mfma_f32_16x16x32_bf16 v[136:139], a[232:235], v[68:71], v[136:139]
    ds_read_b128 v[40:43], v10 offset:53248
    v_mfma_f32_16x16x32_bf16 v[140:143], a[236:239], v[68:71], v[140:143]
    ds_read_b128 v[44:47], v10 offset:55296
    v_mfma_f32_16x16x32_bf16 v[144:147], a[232:235], v[72:75], v[144:147]
    ds_read_b128 v[48:51], v10 offset:57344
    v_mfma_f32_16x16x32_bf16 v[148:151], a[236:239], v[72:75], v[148:151]
    ds_read_b128 v[52:55], v10 offset:59392
    v_mfma_f32_16x16x32_bf16 v[152:155], a[232:235], v[76:79], v[152:155]
    ds_read_b128 v[56:59], v10 offset:61440
    v_mfma_f32_16x16x32_bf16 v[156:159], a[236:239], v[76:79], v[156:159]
    ds_read_b128 v[60:63], v10 offset:63488
    v_mfma_f32_16x16x32_bf16 v[160:163], a[232:235], v[80:83], v[160:163]
    v_mfma_f32_16x16x32_bf16 v[164:167], a[236:239], v[80:83], v[164:167]
    v_mfma_f32_16x16x32_bf16 v[168:171], a[232:235], v[84:87], v[168:171]
    v_mfma_f32_16x16x32_bf16 v[172:175], a[236:239], v[84:87], v[172:175]
    v_mfma_f32_16x16x32_bf16 v[176:179], a[232:235], v[88:91], v[176:179]
    v_mfma_f32_16x16x32_bf16 v[180:183], a[236:239], v[88:91], v[180:183]
    v_mfma_f32_16x16x32_bf16 v[184:187], a[232:235], v[92:95], v[184:187]
    v_mfma_f32_16x16x32_bf16 v[188:191], a[236:239], v[92:95], v[188:191]
    s_cmp_le_u32 s34, 15
    s_cbranch_scc1 be_65
    s_waitcnt lgkmcnt(0)
    v_mfma_f32_16x16x32_bf16 v[128:131], a[240:243], v[32:35], v[128:131]
    ds_read_b128 v[64:67], v11 offset:49152
    v_mfma_f32_16x16x32_bf16 v[132:135], a[244:247], v[32:35], v[132:135]
    ds_read_b128 v[68:71], v11 offset:51200
    v_mfma_f32_16x16x32_bf16 v[136:139], a[240:243], v[36:39], v[136:139]
    ds_read_b128 v[72:75], v11 offset:53248
    v_mfma_f32_16x16x32_bf16 v[140:143], a[244:247], v[36:39], v[140:143]
    ds_read_b128 v[76:79], v11 offset:55296
    v_mfma_f32_16x16x32_bf16 v[144:147], a[240:243], v[40:43], v[144:147]
    ds_read_b128 v[80:83], v11 offset:57344
    v_mfma_f32_16x16x32_bf16 v[148:151], a[244:247], v[40:43], v[148:151]
    ds_read_b128 v[84:87], v11 offset:59392
    v_mfma_f32_16x16x32_bf16 v[152:155], a[240:243], v[44:47], v[152:155]
    ds_read_b128 v[88:91], v11 offset:61440
    v_mfma_f32_16x16x32_bf16 v[156:159], a[244:247], v[44:47], v[156:159]
    ds_read_b128 v[92:95], v11 offset:63488
    v_mfma_f32_16x16x32_bf16 v[160:163], a[240:243], v[48:51], v[160:163]
    v_mfma_f32_16x16x32_bf16 v[164:167], a[244:247], v[48:51], v[164:167]
    v_mfma_f32_16x16x32_bf16 v[168:171], a[240:243], v[52:55], v[168:171]
    v_mfma_f32_16x16x32_bf16 v[172:175], a[244:247], v[52:55], v[172:175]
    v_mfma_f32_16x16x32_bf16 v[176:179], a[240:243], v[56:59], v[176:179]
    v_mfma_f32_16x16x32_bf16 v[180:183], a[244:247], v[56:59], v[180:183]
    s_waitcnt vmcnt(0) lgkmcnt(0)
    s_barrier
    v_mfma_f32_16x16x32_bf16 v[184:187], a[240:243], v[60:63], v[184:187]
    v_mfma_f32_16x16x32_bf16 v[188:191], a[244:247], v[60:63], v[188:191]
    v_mfma_f32_16x16x32_bf16 v[128:131], a[248:251], v[64:67], v[128:131]
    v_mfma_f32_16x16x32_bf16 v[132:135], a[252:255], v[64:67], v[132:135]
    v_mfma_f32_16x16x32_bf16 v[136:139], a[248:251], v[68:71], v[136:139]
    v_mfma_f32_16x16x32_bf16 v[140:143], a[252:255], v[68:71], v[140:143]
    v_mfma_f32_16x16x32_bf16 v[144:147], a[248:251], v[72:75], v[144:147]
    v_mfma_f32_16x16x32_bf16 v[148:151], a[252:255], v[72:75], v[148:151]
    v_mfma_f32_16x16x32_bf16 v[152:155], a[248:251], v[76:79], v[152:155]
    v_mfma_f32_16x16x32_bf16 v[156:159], a[252:255], v[76:79], v[156:159]
    v_mfma_f32_16x16x32_bf16 v[160:163], a[248:251], v[80:83], v[160:163]
    v_mfma_f32_16x16x32_bf16 v[164:167], a[252:255], v[80:83], v[164:167]
    v_mfma_f32_16x16x32_bf16 v[168:171], a[248:251], v[84:87], v[168:171]
    v_mfma_f32_16x16x32_bf16 v[172:175], a[252:255], v[84:87], v[172:175]
    v_mfma_f32_16x16x32_bf16 v[176:179], a[248:251], v[88:91], v[176:179]
    v_mfma_f32_16x16x32_bf16 v[180:183], a[252:255], v[88:91], v[180:183]
    v_mfma_f32_16x16x32_bf16 v[184:187], a[248:251], v[92:95], v[184:187]
    v_mfma_f32_16x16x32_bf16 v[188:191], a[252:255], v[92:95], v[188:191]
be_65:
    s_waitcnt lgkmcnt(0)
    s_nop 9
    v_mul_lo_u32 v24, v3, s33
    v_and_b32 v25, 1, v2
    v_lshl_add_u32 v24, v25, 5, v24
    v_lshrrev_b32 v25, 1, v2
    v_lshl_add_u32 v24, v25, 4, v24
    s_lshl_b32 s45, s41, 6
    v_add_u32 v24, s45, v24
    s_lshl_b32 s46, s33, 4
    s_mul_i32 s47, s46, 0
    s_add_u32 s47, s47, s30
    v_cvt_pk_bf16_f32 v32, v128, v129
    v_cvt_pk_bf16_f32 v33, v130, v131
    v_cvt_pk_bf16_f32 v34, v132, v133
    v_cvt_pk_bf16_f32 v35, v134, v135
    s_nop 1
    v_permlane16_swap_b32 v32, v34
    v_permlane16_swap_b32 v33, v35
    s_nop 0
    buffer_store_dwordx4 v[32:35], v24, s[20:23], s47 offen sc1
    s_mul_i32 s47, s46, 1
    s_add_u32 s47, s47, s30
    v_cvt_pk_bf16_f32 v36, v136, v137
    v_cvt_pk_bf16_f32 v37, v138, v139
    v_cvt_pk_bf16_f32 v38, v140, v141
    v_cvt_pk_bf16_f32 v39, v142, v143
    s_nop 1
    v_permlane16_swap_b32 v36, v38
    v_permlane16_swap_b32 v37, v39
    s_nop 0
    buffer_store_dwordx4 v[36:39], v24, s[20:23], s47 offen sc1
    s_mul_i32 s47, s46, 2
    s_add_u32 s47, s47, s30
    v_cvt_pk_bf16_f32 v32, v144, v145
    v_cvt_pk_bf16_f32 v33, v146, v147
    v_cvt_pk_bf16_f32 v34, v148, v149
    v_cvt_pk_bf16_f32 v35, v150, v151
    s_nop 1
    v_permlane16_swap_b32 v32, v34
    v_permlane16_swap_b32 v33, v35
    s_nop 0
    buffer_store_dwordx4 v[32:35], v24, s[20:23], s47 offen sc1
    s_mul_i32 s47, s46, 3
    s_add_u32 s47, s47, s30
    v_cvt_pk_bf16_f32 v36, v152, v153
    v_cvt_pk_bf16_f32 v37, v154, v155
    v_cvt_pk_bf16_f32 v38, v156, v157
    v_cvt_pk_bf16_f32 v39, v158, v159
    s_nop 1
    v_permlane16_swap_b32 v36, v38
    v_permlane16_swap_b32 v37, v39
    s_nop 0
    buffer_store_dwordx4 v[36:39], v24, s[20:23], s47 offen sc1
    s_mul_i32 s47, s46, 4
    s_add_u32 s47, s47, s30
    v_cvt_pk_bf16_f32 v32, v160, v161
    v_cvt_pk_bf16_f32 v33, v162, v163
    v_cvt_pk_bf16_f32 v34, v164, v165
    v_cvt_pk_bf16_f32 v35, v166, v167
    s_nop 1
    v_permlane16_swap_b32 v32, v34
    v_permlane16_swap_b32 v33, v35
    s_nop 0
    buffer_store_dwordx4 v[32:35], v24, s[20:23], s47 offen sc1
    s_mul_i32 s47, s46, 5
    s_add_u32 s47, s47, s30
    v_cvt_pk_bf16_f32 v36, v168, v169
    v_cvt_pk_bf16_f32 v37, v170, v171
    v_cvt_pk_bf16_f32 v38, v172, v173
    v_cvt_pk_bf16_f32 v39, v174, v175
    s_nop 1
    v_permlane16_swap_b32 v36, v38
    v_permlane16_swap_b32 v37, v39
    s_nop 0
    buffer_store_dwordx4 v[36:39], v24, s[20:23], s47 offen sc1
    s_mul_i32 s47, s46, 6
    s_add_u32 s47, s47, s30
    v_cvt_pk_bf16_f32 v32, v176, v177
    v_cvt_pk_bf16_f32 v33, v178, v179
    v_cvt_pk_bf16_f32 v34, v180, v181
    v_cvt_pk_bf16_f32 v35, v182, v183
    s_nop 1
    v_permlane16_swap_b32 v32, v34
    v_permlane16_swap_b32 v33, v35
    s_nop 0
    buffer_store_dwordx4 v[32:35], v24, s[20:23], s47 offen sc1
    s_mul_i32 s47, s46, 7
    s_add_u32 s47, s47, s30
    v_cvt_pk_bf16_f32 v36, v184, v185
    v_cvt_pk_bf16_f32 v37, v186, v187
    v_cvt_pk_bf16_f32 v38, v188, v189
    v_cvt_pk_bf16_f32 v39, v190, v191
    s_nop 1
    v_permlane16_swap_b32 v36, v38
    v_permlane16_swap_b32 v37, v39
    s_nop 0
    buffer_store_dwordx4 v[36:39], v24, s[20:23], s47 offen sc1
    s_branch unit_done
gemm_main_s:
    s_mov_b32 s35, 0
    s_cmp_lt_u32 s35, s34
    s_cselect_b32 s50, s28, 0x70000000
    s_add_u32 m0, s54, 0
    s_add_u32 s35, s35, 1
    buffer_load_dwordx4 v4, s[12:15], s50 offen offset:0 sc1 lds
    buffer_load_dwordx4 v5, s[12:15], s50 offen offset:1024 sc1 lds
    s_add_u32 s28, s28, 128
    s_cmp_lt_u32 s35, s34
    s_cselect_b32 s50, s28, 0x70000000
    s_add_u32 m0, s54, 8192
    s_add_u32 s35, s35, 1
    buffer_load_dwordx4 v4, s[12:15], s50 offen offset:0 sc1 lds
    buffer_load_dwordx4 v5, s[12:15], s50 offen offset:1024 sc1 lds
    s_add_u32 s28, s28, 128
    s_cmp_lt_u32 s35, s34
    s_cselect_b32 s50, s28, 0x70000000
    s_add_u32 m0, s54, 16384
    s_add_u32 s35, s35, 1
    buffer_load_dwordx4 v4, s[12:15], s50 offen offset:0 sc1 lds
    buffer_load_dwordx4 v5, s[12:15], s50 offen offset:1024 sc1 lds
    s_add_u32 s28, s28, 128
    s_waitcnt vmcnt(4)
    s_barrier
    ds_read_b128 v[32:35], v8 offset:0
    ds_read_b128 v[36:39], v8 offset:2048
    ds_read_b128 v[40:43], v8 offset:4096
    ds_read_b128 v[44:47], v8 offset:6144
    s_waitcnt lgkmcnt(0)
    v_mfma_f32_16x16x32_bf16 v[128:131], a[0:3], v[32:35], 0
    ds_read_b128 v[64:67], v9 offset:0
    v_mfma_f32_16x16x32_bf16 v[132:135], a[4:7], v[32:35], 0
    ds_read_b128 v[68:71], v9 offset:2048
    v_mfma_f32_16x16x32_bf16 v[136:139], a[0:3], v[36:39], 0
    ds_read_b128 v[72:75], v9 offset:4096
    s_cmp_lt_u32 s35, s34
    s_cselect_b32 s50, s28, 0x70000000
    s_add_u32 m0, s54, 24576
    s_add_u32 s35, s35, 1
    buffer_load_dwordx4 v4, s[12:15], s50 offen offset:0 sc1 lds
    v_mfma_f32_16x16x32_bf16 v[140:143], a[4:7], v[36:39], 0
    ds_read_b128 v[76:79], v9 offset:6144
    v_mfma_f32_16x16x32_bf16 v[144:147], a[0:3], v[40:43], 0
    v_mfma_f32_16x16x32_bf16 v[148:151], a[4:7], v[40:43], 0
    s_waitcnt vmcnt(3) lgkmcnt(0)
    s_barrier
    v_mfma_f32_16x16x32_bf16 v[152:155], a[0:3], v[44:47], 0
    buffer_load_dwordx4 v5, s[12:15], s50 offen offset:1024 sc1 lds
    s_add_u32 s28, s28, 128
    s_mul_i32 s44, s51, 2
    s_add_u32 s28, s28, s44
    v_mfma_f32_16x16x32_bf16 v[156:159], a[4:7], v[44:47], 0
    v_mfma_f32_16x16x32_bf16 v[128:131], a[8:11], v[64:67], v[128:131]
    ds_read_b128 v[32:35], v8 offset:8192
    v_mfma_f32_16x16x32_bf16 v[132:135], a[12:15], v[64:67], v[132:135]
    ds_read_b128 v[36:39], v8 offset:10240
    v_mfma_f32_16x16x32_bf16 v[136:139], a[8:11], v[68:71], v[136:139]
    ds_read_b128 v[40:43], v8 offset:12288
    s_cmp_lt_u32 s35, s34
    s_cselect_b32 s50, s28, 0x70000000
    s_add_u32 m0, s54, 32768
    s_add_u32 s35, s35, 1
    buffer_load_dwordx4 v4, s[12:15], s50 offen offset:0 sc1 lds
    v_mfma_f32_16x16x32_bf16 v[140:143], a[12:15], v[68:71], v[140:143]
    ds_read_b128 v[44:47], v8 offset:14336
    v_mfma_f32_16x16x32_bf16 v[144:147], a[8:11], v[72:75], v[144:147]
    v_mfma_f32_16x16x32_bf16 v[148:151], a[12:15], v[72:75], v[148:151]
    v_mfma_f32_16x16x32_bf16 v[152:155], a[8:11], v[76:79], v[152:155]
    buffer_load_dwordx4 v5, s[12:15], s50 offen offset:1024 sc1 lds
    s_add_u32 s28, s28, 128
    v_mfma_f32_16x16x32_bf16 v[156:159], a[12:15], v[76:79], v[156:159]
    s_cmp_le_u32 s34, 1
    s_cbranch_scc1 be_66
    s_waitcnt lgkmcnt(0)
    v_mfma_f32_16x16x32_bf16 v[128:131], a[16:19], v[32:35], v[128:131]
    ds_read_b128 v[64:67], v9 offset:8192
    v_mfma_f32_16x16x32_bf16 v[132:135], a[20:23], v[32:35], v[132:135]
    ds_read_b128 v[68:71], v9 offset:10240
    v_mfma_f32_16x16x32_bf16 v[136:139], a[16:19], v[36:39], v[136:139]
    ds_read_b128 v[72:75], v9 offset:12288
    s_cmp_lt_u32 s35, s34
    s_cselect_b32 s50, s28, 0x70000000
    s_add_u32 m0, s54, 40960
    s_add_u32 s35, s35, 1
    buffer_load_dwordx4 v4, s[12:15], s50 offen offset:0 sc1 lds
    v_mfma_f32_16x16x32_bf16 v[140:143], a[20:23], v[36:39], v[140:143]
    ds_read_b128 v[76:79], v9 offset:14336
    v_mfma_f32_16x16x32_bf16 v[144:147], a[16:19], v[40:43], v[144:147]
    v_mfma_f32_16x16x32_bf16 v[148:151], a[20:23], v[40:43], v[148:151]
    s_waitcnt vmcnt(5) lgkmcnt(0)
    s_barrier
    v_mfma_f32_16x16x32_bf16 v[152:155], a[16:19], v[44:47], v[152:155]
    buffer_load_dwordx4 v5, s[12:15], s50 offen offset:1024 sc1 lds
    s_add_u32 s28, s28, 128
    v_mfma_f32_16x16x32_bf16 v[156:159], a[20:23], v[44:47], v[156:159]
    v_mfma_f32_16x16x32_bf16 v[128:131], a[24:27], v[64:67], v[128:131]
    ds_read_b128 v[32:35], v8 offset:16384
    v_mfma_f32_16x16x32_bf16 v[132:135], a[28:31], v[64:67], v[132:135]
    ds_read_b128 v[36:39], v8 offset:18432
    v_mfma_f32_16x16x32_bf16 v[136:139], a[24:27], v[68:71], v[136:139]
    ds_read_b128 v[40:43], v8 offset:20480
    s_cmp_lt_u32 s35, s34
    s_cselect_b32 s50, s28, 0x70000000
    s_add_u32 m0, s54, 49152
    s_add_u32 s35, s35, 1
    buffer_load_dwordx4 v4, s[12:15], s50 offen offset:0 sc1 lds
    v_mfma_f32_16x16x32_bf16 v[140:143], a[28:31], v[68:71], v[140:143]
    ds_read_b128 v[44:47], v8 offset:22528
    v_mfma_f32_16x16x32_bf16 v[144:147], a[24:27], v[72:75], v[144:147]
    v_mfma_f32_16x16x32_bf16 v[148:151], a[28:31], v[72:75], v[148:151]
    v_mfma_f32_16x16x32_bf16 v[152:155], a[24:27], v[76:79], v[152:155]
    buffer_load_dwordx4 v5, s[12:15], s50 offen offset:1024 sc1 lds
    s_add_u32 s28, s28, 128
    v_mfma_f32_16x16x32_bf16 v[156:159], a[28:31], v[76:79], v[156:159]
    s_cmp_le_u32 s34, 2
    s_cbranch_scc1 be_66
    s_waitcnt lgkmcnt(0)
    v_mfma_f32_16x16x32_bf16 v[128:131], a[32:35], v[32:35], v[128:131]
    ds_read_b128 v[64:67], v9 offset:16384
    v_mfma_f32_16x16x32_bf16 v[132:135], a[36:39], v[32:35], v[132:135]
    ds_read_b128 v[68:71], v9 offset:18432
    v_mfma_f32_16x16x32_bf16 v[136:139], a[32:35], v[36:39], v[136:139]
    ds_read_b128 v[72:75], v9 offset:20480
    s_cmp_lt_u32 s35, s34
    s_cselect_b32 s50, s28, 0x70000000
    s_add_u32 m0, s54, 57344
    s_add_u32 s35, s35, 1
    buffer_load_dwordx4 v4, s[12:15], s50 offen offset:0 sc1 lds
    v_mfma_f32_16x16x32_bf16 v[140:143], a[36:39], v[36:39], v[140:143]
    ds_read_b128 v[76:79], v9 offset:22528
    v_mfma_f32_16x16x32_bf16 v[144:147], a[32:35], v[40:43], v[144:147]
    v_mfma_f32_16x16x32_bf16 v[148:151], a[36:39], v[40:43], v[148:151]
    s_waitcnt vmcnt(7) lgkmcnt(0)
    s_barrier
    v_mfma_f32_16x16x32_bf16 v[152:155], a[32:35], v[44:47], v[152:155]
    buffer_load_dwordx4 v5, s[12:15], s50 offen offset:1024 sc1 lds
    s_add_u32 s28, s28, 128
    s_mul_i32 s44, s51, -3
    s_add_u32 s28, s28, s44
    v_mfma_f32_16x16x32_bf16 v[156:159], a[36:39], v[44:47], v[156:159]
    v_mfma_f32_16x16x32_bf16 v[128:131], a[40:43], v[64:67], v[128:131]
    ds_read_b128 v[32:35], v8 offset:24576
    v_mfma_f32_16x16x32_bf16 v[132:135], a[44:47], v[64:67], v[132:135]
    ds_read_b128 v[36:39], v8 offset:26624
    v_mfma_f32_16x16x32_bf16 v[136:139], a[40:43], v[68:71], v[136:139]
    ds_read_b128 v[40:43], v8 offset:28672
    s_cmp_lt_u32 s35, s34
    s_cselect_b32 s50, s28, 0x70000000
    s_add_u32 m0, s54, 0
    s_add_u32 s35, s35, 1
    buffer_load_dwordx4 v4, s[12:15], s50 offen offset:0 sc1 lds
    v_mfma_f32_16x16x32_bf16 v[140:143], a[44:47], v[68:71], v[140:143]
    ds_read_b128 v[44:47], v8 offset:30720
    v_mfma_f32_16x16x32_bf16 v[144:147], a[40:43], v[72:75], v[144:147]
    v_mfma_f32_16x16x32_bf16 v[148:151], a[44:47], v[72:75], v[148:151]
    v_mfma_f32_16x16x32_bf16 v[152:155], a[40:43], v[76:79], v[152:155]
    buffer_load_dwordx4 v5, s[12:15], s50 offen offset:1024 sc1 lds
    s_add_u32 s28, s28, 128
    v_mfma_f32_16x16x32_bf16 v[156:159], a[44:47], v[76:79], v[156:159]
    s_cmp_le_u32 s34, 3
    s_cbranch_scc1 be_66
    s_waitcnt lgkmcnt(0)
    v_mfma_f32_16x16x32_bf16 v[128:131], a[48:51], v[32:35], v[128:131]
    ds_read_b128 v[64:67], v9 offset:24576
    v_mfma_f32_16x16x32_bf16 v[132:135], a[52:55], v[32:35], v[132:135]
    ds_read_b128 v[68:71], v9 offset:26624
    v_mfma_f32_16x16x32_bf16 v[136:139], a[48:51], v[36:39], v[136:139]
    ds_read_b128 v[72:75], v9 offset:28672
    s_cmp_lt_u32 s35, s34
    s_cselect_b32 s50, s28, 0x70000000
    s_add_u32 m0, s54, 8192
    s_add_u32 s35, s35, 1
    buffer_load_dwordx4 v4, s[12:15], s50 offen offset:0 sc1 lds
    v_mfma_f32_16x16x32_bf16 v[140:143], a[52:55], v[36:39], v[140:143]
    ds_read_b128 v[76:79], v9 offset:30720
    v_mfma_f32_16x16x32_bf16 v[144:147], a[48:51], v[40:43], v[144:147]
    v_mfma_f32_16x16x32_bf16 v[148:151], a[52:55], v[40:43], v[148:151]
    s_waitcnt vmcnt(9) lgkmcnt(0)
    s_barrier
    v_mfma_f32_16x16x32_bf16 v[152:155], a[48:51], v[44:47], v[152:155]
    buffer_load_dwordx4 v5, s[12:15], s50 offen offset:1024 sc1 lds
    s_add_u32 s28, s28, 128
    v_mfma_f32_16x16x32_bf16 v[156:159], a[52:55], v[44:47], v[156:159]
    v_mfma_f32_16x16x32_bf16 v[128:131], a[56:59], v[64:67], v[128:131]
    ds_read_b128 v[32:35], v8 offset:32768
    v_mfma_f32_16x16x32_bf16 v[132:135], a[60:63], v[64:67], v[132:135]
    ds_read_b128 v[36:39], v8 offset:34816
    v_mfma_f32_16x16x32_bf16 v[136:139], a[56:59], v[68:71], v[136:139]
    ds_read_b128 v[40:43], v8 offset:36864
    s_cmp_lt_u32 s35, s34
    s_cselect_b32 s50, s28, 0x70000000
    s_add_u32 m0, s54, 16384
    s_add_u32 s35, s35, 1
    buffer_load_dwordx4 v4, s[12:15], s50 offen offset:0 sc1 lds
    v_mfma_f32_16x16x32_bf16 v[140:143], a[60:63], v[68:71], v[140:143]
    ds_read_b128 v[44:47], v8 offset:38912
    v_mfma_f32_16x16x32_bf16 v[144:147], a[56:59], v[72:75], v[144:147]
    v_mfma_f32_16x16x32_bf16 v[148:151], a[60:63], v[72:75], v[148:151]
    v_mfma_f32_16x16x32_bf16 v[152:155], a[56:59], v[76:79], v[152:155]
    buffer_load_dwordx4 v5, s[12:15], s50 offen offset:1024 sc1 lds
    s_add_u32 s28, s28, 128
    v_mfma_f32_16x16x32_bf16 v[156:159], a[60:63], v[76:79], v[156:159]
    s_cmp_le_u32 s34, 4
    s_cbranch_scc1 be_66
    s_waitcnt lgkmcnt(0)
    v_mfma_f32_16x16x32_bf16 v[128:131], a[64:67], v[32:35], v[128:131]
    ds_read_b128 v[64:67], v9 offset:32768
    v_mfma_f32_16x16x32_bf16 v[132:135], a[68:71], v[32:35], v[132:135]
    ds_read_b128 v[68:71], v9 offset:34816
    v_mfma_f32_16x16x32_bf16 v[136:139], a[64:67], v[36:39], v[136:139]
    ds_read_b128 v[72:75], v9 offset:36864
    v_mfma_f32_16x16x32_bf16 v[140:143], a[68:71], v[36:39], v[140:143]
    ds_read_b128 v[76:79], v9 offset:38912
    v_mfma_f32_16x16x32_bf16 v[144:147], a[64:67], v[40:43], v[144:147]
    s_cmp_lt_u32 s35, s34
    s_cselect_b32 s50, s28, 0x70000000
    s_add_u32 m0, s54, 24576
    s_add_u32 s35, s35, 1
    buffer_load_dwordx4 v4, s[12:15], s50 offen offset:0 sc1 lds
    v_mfma_f32_16x16x32_bf16 v[148:151], a[68:71], v[40:43], v[148:151]
    s_waitcnt vmcnt(11) lgkmcnt(0)
    s_barrier
    v_mfma_f32_16x16x32_bf16 v[152:155], a[64:67], v[44:47], v[152:155]
    v_mfma_f32_16x16x32_bf16 v[156:159], a[68:71], v[44:47], v[156:159]
    v_mfma_f32_16x16x32_bf16 v[128:131], a[72:75], v[64:67], v[128:131]
    ds_read_b128 v[32:35], v8 offset:40960
    v_mfma_f32_16x16x32_bf16 v[132:135], a[76:79], v[64:67], v[132:135]
    ds_read_b128 v[36:39], v8 offset:43008
    v_mfma_f32_16x16x32_bf16 v[136:139], a[72:75], v[68:71], v[136:139]
    ds_read_b128 v[40:43], v8 offset:45056
    v_mfma_f32_16x16x32_bf16 v[140:143], a[76:79], v[68:71], v[140:143]
    ds_read_b128 v[44:47], v8 offset:47104
    v_mfma_f32_16x16x32_bf16 v[144:147], a[72:75], v[72:75], v[144:147]
    buffer_load_dwordx4 v5, s[12:15], s50 offen offset:1024 sc1 lds
    s_add_u32 s28, s28, 128
    s_mul_i32 s44, s51, 4
    s_add_u32 s28, s28, s44
    v_mfma_f32_16x16x32_bf16 v[148:151], a[76:79], v[72:75], v[148:151]
    v_mfma_f32_16x16x32_bf16 v[152:155], a[72:75], v[76:79], v[152:155]
    v_mfma_f32_16x16x32_bf16 v[156:159], a[76:79], v[76:79], v[156:159]
    s_cmp_le_u32 s34, 5
    s_cbranch_scc1 be_66
    s_waitcnt lgkmcnt(0)
    v_mfma_f32_16x16x32_bf16 v[128:131], a[80:83], v[32:35], v[128:131]
    ds_read_b128 v[64:67], v9 offset:40960
    v_mfma_f32_16x16x32_bf16 v[132:135], a[84:87], v[32:35], v[132:135]
    ds_read_b128 v[68:71], v9 offset:43008
    v_mfma_f32_16x16x32_bf16 v[136:139], a[80:83], v[36:39], v[136:139]
    ds_read_b128 v[72:75], v9 offset:45056
    v_mfma_f32_16x16x32_bf16 v[140:143], a[84:87], v[36:39], v[140:143]
    ds_read_b128 v[76:79], v9 offset:47104
    v_mfma_f32_16x16x32_bf16 v[144:147], a[80:83], v[40:43], v[144:147]
    s_cmp_lt_u32 s35, s34
    s_cselect_b32 s50, s28, 0x70000000
    s_add_u32 m0, s54, 32768
    s_add_u32 s35, s35, 1
    buffer_load_dwordx4 v4, s[12:15], s50 offen offset:0 sc1 lds
    v_mfma_f32_16x16x32_bf16 v[148:151], a[84:87], v[40:43], v[148:151]
    s_waitcnt vmcnt(11) lgkmcnt(0)
    s_barrier
    v_mfma_f32_16x16x32_bf16 v[152:155], a[80:83], v[44:47], v[152:155]
    v_mfma_f32_16x16x32_bf16 v[156:159], a[84:87], v[44:47], v[156:159]
    v_mfma_f32_16x16x32_bf16 v[128:131], a[88:91], v[64:67], v[128:131]
    ds_read_b128 v[32:35], v8 offset:49152
    v_mfma_f32_16x16x32_bf16 v[132:135], a[92:95], v[64:67], v[132:135]
    ds_read_b128 v[36:39], v8 offset:51200
    v_mfma_f32_16x16x32_bf16 v[136:139], a[88:91], v[68:71], v[136:139]
    ds_read_b128 v[40:43], v8 offset:53248
    v_mfma_f32_16x16x32_bf16 v[140:143], a[92:95], v[68:71], v[140:143]
    ds_read_b128 v[44:47], v8 offset:55296
    v_mfma_f32_16x16x32_bf16 v[144:147], a[88:91], v[72:75], v[144:147]
    buffer_load_dwordx4 v5, s[12:15], s50 offen offset:1024 sc1 lds
    s_add_u32 s28, s28, 128
    v_mfma_f32_16x16x32_bf16 v[148:151], a[92:95], v[72:75], v[148:151]
    v_mfma_f32_16x16x32_bf16 v[152:155], a[88:91], v[76:79], v[152:155]
    v_mfma_f32_16x16x32_bf16 v[156:159], a[92:95], v[76:79], v[156:159]
    s_cmp_le_u32 s34, 6
    s_cbranch_scc1 be_66
    s_waitcnt lgkmcnt(0)
    v_mfma_f32_16x16x32_bf16 v[128:131], a[96:99], v[32:35], v[128:131]
    ds_read_b128 v[64:67], v9 offset:49152
    v_mfma_f32_16x16x32_bf16 v[132:135], a[100:103], v[32:35], v[132:135]
    ds_read_b128 v[68:71], v9 offset:51200
    v_mfma_f32_16x16x32_bf16 v[136:139], a[96:99], v[36:39], v[136:139]
    ds_read_b128 v[72:75], v9 offset:53248
    v_mfma_f32_16x16x32_bf16 v[140:143], a[100:103], v[36:39], v[140:143]
    ds_read_b128 v[76:79], v9 offset:55296
    v_mfma_f32_16x16x32_bf16 v[144:147], a[96:99], v[40:43], v[144:147]
    s_cmp_lt_u32 s35, s34
    s_cselect_b32 s50, s28, 0x70000000
    s_add_u32 m0, s54, 40960
    s_add_u32 s35, s35, 1
    buffer_load_dwordx4 v4, s[12:15], s50 offen offset:0 sc1 lds
    v_mfma_f32_16x16x32_bf16 v[148:151], a[100:103], v[40:43], v[148:151]
    s_waitcnt vmcnt(11) lgkmcnt(0)
    s_barrier
    v_mfma_f32_16x16x32_bf16 v[152:155], a[96:99], v[44:47], v[152:155]
    v_mfma_f32_16x16x32_bf16 v[156:159], a[100:103], v[44:47], v[156:159]
    v_mfma_f32_16x16x32_bf16 v[128:131], a[104:107], v[64:67], v[128:131]
    ds_read_b128 v[32:35], v8 offset:57344
    v_mfma_f32_16x16x32_bf16 v[132:135], a[108:111], v[64:67], v[132:135]
    ds_read_b128 v[36:39], v8 offset:59392
    v_mfma_f32_16x16x32_bf16 v[136:139], a[104:107], v[68:71], v[136:139]
    ds_read_b128 v[40:43], v8 offset:61440
    v_mfma_f32_16x16x32_bf16 v[140:143], a[108:111], v[68:71], v[140:143]
    ds_read_b128 v[44:47], v8 offset:63488
    v_mfma_f32_16x16x32_bf16 v[144:147], a[104:107], v[72:75], v[144:147]
    buffer_load_dwordx4 v5, s[12:15], s50 offen offset:1024 sc1 lds
    s_add_u32 s28, s28, 128
    v_mfma_f32_16x16x32_bf16 v[148:151], a[108:111], v[72:75], v[148:151]
    v_mfma_f32_16x16x32_bf16 v[152:155], a[104:107], v[76:79], v[152:155]
    v_mfma_f32_16x16x32_bf16 v[156:159], a[108:111], v[76:79], v[156:159]
    s_cmp_le_u32 s34, 7
    s_cbranch_scc1 be_66
    s_waitcnt lgkmcnt(0)
    v_mfma_f32_16x16x32_bf16 v[128:131], a[112:115], v[32:35], v[128:131]
    ds_read_b128 v[64:67], v9 offset:57344
    v_mfma_f32_16x16x32_bf16 v[132:135], a[116:119], v[32:35], v[132:135]
    ds_read_b128 v[68:71], v9 offset:59392
    v_mfma_f32_16x16x32_bf16 v[136:139], a[112:115], v[36:39], v[136:139]
    ds_read_b128 v[72:75], v9 offset:61440
    v_mfma_f32_16x16x32_bf16 v[140:143], a[116:119], v[36:39], v[140:143]
    ds_read_b128 v[76:79], v9 offset:63488
    v_mfma_f32_16x16x32_bf16 v[144:147], a[112:115], v[40:43], v[144:147]
    s_cmp_lt_u32 s35, s34
    s_cselect_b32 s50, s28, 0x70000000
    s_add_u32 m0, s54, 49152
    s_add_u32 s35, s35, 1
    buffer_load_dwordx4 v4, s[12:15], s50 offen offset:0 sc1 lds
    v_mfma_f32_16x16x32_bf16 v[148:151], a[116:119], v[40:43], v[148:151]
    s_waitcnt vmcnt(11) lgkmcnt(0)
    s_barrier
    v_mfma_f32_16x16x32_bf16 v[152:155], a[112:115], v[44:47], v[152:155]
    v_mfma_f32_16x16x32_bf16 v[156:159], a[116:119], v[44:47], v[156:159]
    v_mfma_f32_16x16x32_bf16 v[128:131], a[120:123], v[64:67], v[128:131]
    ds_read_b128 v[32:35], v8 offset:0
    v_mfma_f32_16x16x32_bf16 v[132:135], a[124:127], v[64:67], v[132:135]
    ds_read_b128 v[36:39], v8 offset:2048
    v_mfma_f32_16x16x32_bf16 v[136:139], a[120:123], v[68:71], v[136:139]
    ds_read_b128 v[40:43], v8 offset:4096
    v_mfma_f32_16x16x32_bf16 v[140:143], a[124:127], v[68:71], v[140:143]
    ds_read_b128 v[44:47], v8 offset:6144
    v_mfma_f32_16x16x32_bf16 v[144:147], a[120:123], v[72:75], v[144:147]
    buffer_load_dwordx4 v5, s[12:15], s50 offen offset:1024 sc1 lds
    s_add_u32 s28, s28, 128
    v_mfma_f32_16x16x32_bf16 v[148:151], a[124:127], v[72:75], v[148:151]
    v_mfma_f32_16x16x32_bf16 v[152:155], a[120:123], v[76:79], v[152:155]
    v_mfma_f32_16x16x32_bf16 v[156:159], a[124:127], v[76:79], v[156:159]
    s_cmp_le_u32 s34, 8
    s_cbranch_scc1 be_66
    s_waitcnt lgkmcnt(0)
    v_mfma_f32_16x16x32_bf16 v[128:131], a[128:131], v[32:35], v[128:131]
    ds_read_b128 v[64:67], v9 offset:0
    v_mfma_f32_16x16x32_bf16 v[132:135], a[132:135], v[32:35], v[132:135]
    ds_read_b128 v[68:71], v9 offset:2048
    v_mfma_f32_16x16x32_bf16 v[136:139], a[128:131], v[36:39], v[136:139]
    ds_read_b128 v[72:75], v9 offset:4096
    v_mfma_f32_16x16x32_bf16 v[140:143], a[132:135], v[36:39], v[140:143]
    ds_read_b128 v[76:79], v9 offset:6144
    v_mfma_f32_16x16x32_bf16 v[144:147], a[128:131], v[40:43], v[144:147]
    s_cmp_lt_u32 s35, s34
    s_cselect_b32 s50, s28, 0x70000000
    s_add_u32 m0, s54, 57344
    s_add_u32 s35, s35, 1
    buffer_load_dwordx4 v4, s[12:15], s50 offen offset:0 sc1 lds
    v_mfma_f32_16x16x32_bf16 v[148:151], a[132:135], v[40:43], v[148:151]
    s_waitcnt vmcnt(11) lgkmcnt(0)
    s_barrier
    v_mfma_f32_16x16x32_bf16 v[152:155], a[128:131], v[44:47], v[152:155]
    v_mfma_f32_16x16x32_bf16 v[156:159], a[132:135], v[44:47], v[156:159]
    v_mfma_f32_16x16x32_bf16 v[128:131], a[136:139], v[64:67], v[128:131]
    ds_read_b128 v[32:35], v8 offset:8192
    v_mfma_f32_16x16x32_bf16 v[132:135], a[140:143], v[64:67], v[132:135]
    ds_read_b128 v[36:39], v8 offset:10240
    v_mfma_f32_16x16x32_bf16 v[136:139], a[136:139], v[68:71], v[136:139]
    ds_read_b128 v[40:43], v8 offset:12288
    v_mfma_f32_16x16x32_bf16 v[140:143], a[140:143], v[68:71], v[140:143]
    ds_read_b128 v[44:47], v8 offset:14336
    v_mfma_f32_16x16x32_bf16 v[144:147], a[136:139], v[72:75], v[144:147]
    buffer_load_dwordx4 v5, s[12:15], s50 offen offset:1024 sc1 lds
    s_add_u32 s28, s28, 128
    v_mfma_f32_16x16x32_bf16 v[148:151], a[140:143], v[72:75], v[148:151]
    v_mfma_f32_16x16x32_bf16 v[152:155], a[136:139], v[76:79], v[152:155]
    v_mfma_f32_16x16x32_bf16 v[156:159], a[140:143], v[76:79], v[156:159]
    s_cmp_le_u32 s34, 9
    s_cbranch_scc1 be_66
    s_waitcnt lgkmcnt(0)
    v_mfma_f32_16x16x32_bf16 v[128:131], a[144:147], v[32:35], v[128:131]
    ds_read_b128 v[64:67], v9 offset:8192
    v_mfma_f32_16x16x32_bf16 v[132:135], a[148:151], v[32:35], v[132:135]
    ds_read_b128 v[68:71], v9 offset:10240
    v_mfma_f32_16x16x32_bf16 v[136:139], a[144:147], v[36:39], v[136:139]
    ds_read_b128 v[72:75], v9 offset:12288
    v_mfma_f32_16x16x32_bf16 v[140:143], a[148:151], v[36:39], v[140:143]
    ds_read_b128 v[76:79], v9 offset:14336
    v_mfma_f32_16x16x32_bf16 v[144:147], a[144:147], v[40:43], v[144:147]
    v_mfma_f32_16x16x32_bf16 v[148:151], a[148:151], v[40:43], v[148:151]
    s_waitcnt vmcnt(10) lgkmcnt(0)
    s_barrier
    v_mfma_f32_16x16x32_bf16 v[152:155], a[144:147], v[44:47], v[152:155]
    v_mfma_f32_16x16x32_bf16 v[156:159], a[148:151], v[44:47], v[156:159]
    v_mfma_f32_16x16x32_bf16 v[128:131], a[152:155], v[64:67], v[128:131]
    ds_read_b128 v[32:35], v8 offset:16384
    v_mfma_f32_16x16x32_bf16 v[132:135], a[156:159], v[64:67], v[132:135]
    ds_read_b128 v[36:39], v8 offset:18432
    v_mfma_f32_16x16x32_bf16 v[136:139], a[152:155], v[68:71], v[136:139]
    ds_read_b128 v[40:43], v8 offset:20480
    v_mfma_f32_16x16x32_bf16 v[140:143], a[156:159], v[68:71], v[140:143]
    ds_read_b128 v[44:47], v8 offset:22528
    v_mfma_f32_16x16x32_bf16 v[144:147], a[152:155], v[72:75], v[144:147]
    v_mfma_f32_16x16x32_bf16 v[148:151], a[156:159], v[72:75], v[148:151]
    v_mfma_f32_16x16x32_bf16 v[152:155], a[152:155], v[76:79], v[152:155]
    v_mfma_f32_16x16x32_bf16 v[156:159], a[156:159], v[76:79], v[156:159]
    s_cmp_le_u32 s34, 10
    s_cbranch_scc1 be_66
    s_waitcnt lgkmcnt(0)
    v_mfma_f32_16x16x32_bf16 v[128:131], a[160:163], v[32:35], v[128:131]
    ds_read_b128 v[64:67], v9 offset:16384
    v_mfma_f32_16x16x32_bf16 v[132:135], a[164:167], v[32:35], v[132:135]
    ds_read_b128 v[68:71], v9 offset:18432
    v_mfma_f32_16x16x32_bf16 v[136:139], a[160:163], v[36:39], v[136:139]
    ds_read_b128 v[72:75], v9 offset:20480
    v_mfma_f32_16x16x32_bf16 v[140:143], a[164:167], v[36:39], v[140:143]
    ds_read_b128 v[76:79], v9 offset:22528
    v_mfma_f32_16x16x32_bf16 v[144:147], a[160:163], v[40:43], v[144:147]
    v_mfma_f32_16x16x32_bf16 v[148:151], a[164:167], v[40:43], v[148:151]
    s_waitcnt vmcnt(8) lgkmcnt(0)
    s_barrier
    v_mfma_f32_16x16x32_bf16 v[152:155], a[160:163], v[44:47], v[152:155]
    v_mfma_f32_16x16x32_bf16 v[156:159], a[164:167], v[44:47], v[156:159]
    v_mfma_f32_16x16x32_bf16 v[128:131], a[168:171], v[64:67], v[128:131]
    ds_read_b128 v[32:35], v8 offset:24576
    v_mfma_f32_16x16x32_bf16 v[132:135], a[172:175], v[64:67], v[132:135]
    ds_read_b128 v[36:39], v8 offset:26624
    v_mfma_f32_16x16x32_bf16 v[136:139], a[168:171], v[68:71], v[136:139]
    ds_read_b128 v[40:43], v8 offset:28672
    v_mfma_f32_16x16x32_bf16 v[140:143], a[172:175], v[68:71], v[140:143]
    ds_read_b128 v[44:47], v8 offset:30720
    v_mfma_f32_16x16x32_bf16 v[144:147], a[168:171], v[72:75], v[144:147]
    v_mfma_f32_16x16x32_bf16 v[148:151], a[172:175], v[72:75], v[148:151]
    v_mfma_f32_16x16x32_bf16 v[152:155], a[168:171], v[76:79], v[152:155]
    v_mfma_f32_16x16x32_bf16 v[156:159], a[172:175], v[76:79], v[156:159]
    s_cmp_le_u32 s34, 11
    s_cbranch_scc1 be_66
    s_waitcnt lgkmcnt(0)
    v_mfma_f32_16x16x32_bf16 v[128:131], a[176:179], v[32:35], v[128:131]
    ds_read_b128 v[64:67], v9 offset:24576
    v_mfma_f32_16x16x32_bf16 v[132:135], a[180:183], v[32:35], v[132:135]
    ds_read_b128 v[68:71], v9 offset:26624
    v_mfma_f32_16x16x32_bf16 v[136:139], a[176:179], v[36:39], v[136:139]
    ds_read_b128 v[72:75], v9 offset:28672
    v_mfma_f32_16x16x32_bf16 v[140:143], a[180:183], v[36:39], v[140:143]
    ds_read_b128 v[76:79], v9 offset:30720
    v_mfma_f32_16x16x32_bf16 v[144:147], a[176:179], v[40:43], v[144:147]
    v_mfma_f32_16x16x32_bf16 v[148:151], a[180:183], v[40:43], v[148:151]
    s_waitcnt vmcnt(6) lgkmcnt(0)
    s_barrier
    v_mfma_f32_16x16x32_bf16 v[152:155], a[176:179], v[44:47], v[152:155]
    v_mfma_f32_16x16x32_bf16 v[156:159], a[180:183], v[44:47], v[156:159]
    v_mfma_f32_16x16x32_bf16 v[128:131], a[184:187], v[64:67], v[128:131]
    ds_read_b128 v[32:35], v8 offset:32768
    v_mfma_f32_16x16x32_bf16 v[132:135], a[188:191], v[64:67], v[132:135]
    ds_read_b128 v[36:39], v8 offset:34816
    v_mfma_f32_16x16x32_bf16 v[136:139], a[184:187], v[68:71], v[136:139]
    ds_read_b128 v[40:43], v8 offset:36864
    v_mfma_f32_16x16x32_bf16 v[140:143], a[188:191], v[68:71], v[140:143]
    ds_read_b128 v[44:47], v8 offset:38912
    v_mfma_f32_16x16x32_bf16 v[144:147], a[184:187], v[72:75], v[144:147]
    v_mfma_f32_16x16x32_bf16 v[148:151], a[188:191], v[72:75], v[148:151]
    v_mfma_f32_16x16x32_bf16 v[152:155], a[184:187], v[76:79], v[152:155]
    v_mfma_f32_16x16x32_bf16 v[156:159], a[188:191], v[76:79], v[156:159]
    s_cmp_le_u32 s34, 12
    s_cbranch_scc1 be_66
    s_waitcnt lgkmcnt(0)
    v_mfma_f32_16x16x32_bf16 v[128:131], a[192:195], v[32:35], v[128:131]
    ds_read_b128 v[64:67], v9 offset:32768
    v_mfma_f32_16x16x32_bf16 v[132:135], a[196:199], v[32:35], v[132:135]
    ds_read_b128 v[68:71], v9 offset:34816
    v_mfma_f32_16x16x32_bf16 v[136:139], a[192:195], v[36:39], v[136:139]
    ds_read_b128 v[72:75], v9 offset:36864
    v_mfma_f32_16x16x32_bf16 v[140:143], a[196:199], v[36:39], v[140:143]
    ds_read_b128 v[76:79], v9 offset:38912
    v_mfma_f32_16x16x32_bf16 v[144:147], a[192:195], v[40:43], v[144:147]
    v_mfma_f32_16x16x32_bf16 v[148:151], a[196:199], v[40:43], v[148:151]
    s_waitcnt vmcnt(4) lgkmcnt(0)
    s_barrier
    v_mfma_f32_16x16x32_bf16 v[152:155], a[192:195], v[44:47], v[152:155]
    v_mfma_f32_16x16x32_bf16 v[156:159], a[196:199], v[44:47], v[156:159]
    v_mfma_f32_16x16x32_bf16 v[128:131], a[200:203], v[64:67], v[128:131]
    ds_read_b128 v[32:35], v8 offset:40960
    v_mfma_f32_16x16x32_bf16 v[132:135], a[204:207], v[64:67], v[132:135]
    ds_read_b128 v[36:39], v8 offset:43008
    v_mfma_f32_16x16x32_bf16 v[136:139], a[200:203], v[68:71], v[136:139]
    ds_read_b128 v[40:43], v8 offset:45056
    v_mfma_f32_16x16x32_bf16 v[140:143], a[204:207], v[68:71], v[140:143]
    ds_read_b128 v[44:47], v8 offset:47104
    v_mfma_f32_16x16x32_bf16 v[144:147], a[200:203], v[72:75], v[144:147]
    v_mfma_f32_16x16x32_bf16 v[148:151], a[204:207], v[72:75], v[148:151]
    v_mfma_f32_16x16x32_bf16 v[152:155], a[200:203], v[76:79], v[152:155]
    v_mfma_f32_16x16x32_bf16 v[156:159], a[204:207], v[76:79], v[156:159]
    s_cmp_le_u32 s34, 13
    s_cbranch_scc1 be_66
    s_waitcnt lgkmcnt(0)
    v_mfma_f32_16x16x32_bf16 v[128:131], a[208:211], v[32:35], v[128:131]
    ds_read_b128 v[64:67], v9 offset:40960
    v_mfma_f32_16x16x32_bf16 v[132:135], a[212:215], v[32:35], v[132:135]
    ds_read_b128 v[68:71], v9 offset:43008
    v_mfma_f32_16x16x32_bf16 v[136:139], a[208:211], v[36:39], v[136:139]
    ds_read_b128 v[72:75], v9 offset:45056
    v_mfma_f32_16x16x32_bf16 v[140:143], a[212:215], v[36:39], v[140:143]
    ds_read_b128 v[76:79], v9 offset:47104
    v_mfma_f32_16x16x32_bf16 v[144:147], a[208:211], v[40:43], v[144:147]
    v_mfma_f32_16x16x32_bf16 v[148:151], a[212:215], v[40:43], v[148:151]
    s_waitcnt vmcnt(2) lgkmcnt(0)
    s_barrier
    v_mfma_f32_16x16x32_bf16 v[152:155], a[208:211], v[44:47], v[152:155]
    v_mfma_f32_16x16x32_bf16 v[156:159], a[212:215], v[44:47], v[156:159]
    v_mfma_f32_16x16x32_bf16 v[128:131], a[216:219], v[64:67], v[128:131]
    ds_read_b128 v[32:35], v8 offset:49152
    v_mfma_f32_16x16x32_bf16 v[132:135], a[220:223], v[64:67], v[132:135]
    ds_read_b128 v[36:39], v8 offset:51200
    v_mfma_f32_16x16x32_bf16 v[136:139], a[216:219], v[68:71], v[136:139]
    ds_read_b128 v[40:43], v8 offset:53248
    v_mfma_f32_16x16x32_bf16 v[140:143], a[220:223], v[68:71], v[140:143]
    ds_read_b128 v[44:47], v8 offset:55296
    v_mfma_f32_16x16x32_bf16 v[144:147], a[216:219], v[72:75], v[144:147]
    v_mfma_f32_16x16x32_bf16 v[148:151], a[220:223], v[72:75], v[148:151]
    v_mfma_f32_16x16x32_bf16 v[152:155], a[216:219], v[76:79], v[152:155]
    v_mfma_f32_16x16x32_bf16 v[156:159], a[220:223], v[76:79], v[156:159]
    s_cmp_le_u32 s34, 14
    s_cbranch_scc1 be_66
    s_waitcnt lgkmcnt(0)
    v_mfma_f32_16x16x32_bf16 v[128:131], a[224:227], v[32:35], v[128:131]
    ds_read_b128 v[64:67], v9 offset:49152
    v_mfma_f32_16x16x32_bf16 v[132:135], a[228:231], v[32:35], v[132:135]
    ds_read_b128 v[68:71], v9 offset:51200
    v_mfma_f32_16x16x32_bf16 v[136:139], a[224:227], v[36:39], v[136:139]
    ds_read_b128 v[72:75], v9 offset:53248
    v_mfma_f32_16x16x32_bf16 v[140:143], a[228:231], v[36:39], v[140:143]
    ds_read_b128 v[76:79], v9 offset:55296
    v_mfma_f32_16x16x32_bf16 v[144:147], a[224:227], v[40:43], v[144:147]
    v_mfma_f32_16x16x32_bf16 v[148:151], a[228:231], v[40:43], v[148:151]
    s_waitcnt vmcnt(0) lgkmcnt(0)
    s_barrier
    v_mfma_f32_16x16x32_bf16 v[152:155], a[224:227], v[44:47], v[152:155]
    v_mfma_f32_16x16x32_bf16 v[156:159], a[228:231], v[44:47], v[156:159]
    v_mfma_f32_16x16x32_bf16 v[128:131], a[232:235], v[64:67], v[128:131]
    ds_read_b128 v[32:35], v8 offset:57344
    v_mfma_f32_16x16x32_bf16 v[132:135], a[236:239], v[64:67], v[132:135]
    ds_read_b128 v[36:39], v8 offset:59392
    v_mfma_f32_16x16x32_bf16 v[136:139], a[232:235], v[68:71], v[136:139]
    ds_read_b128 v[40:43], v8 offset:61440
    v_mfma_f32_16x16x32_bf16 v[140:143], a[236:239], v[68:71], v[140:143]
    ds_read_b128 v[44:47], v8 offset:63488
    v_mfma_f32_16x16x32_bf16 v[144:147], a[232:235], v[72:75], v[144:147]
    v_mfma_f32_16x16x32_bf16 v[148:151], a[236:239], v[72:75], v[148:151]
    v_mfma_f32_16x16x32_bf16 v[152:155], a[232:235], v[76:79], v[152:155]
    v_mfma_f32_16x16x32_bf16 v[156:159], a[236:239], v[76:79], v[156:159]
    s_cmp_le_u32 s34, 15
    s_cbranch_scc1 be_66
    s_waitcnt lgkmcnt(0)
    v_mfma_f32_16x16x32_bf16 v[128:131], a[240:243], v[32:35], v[128:131]
    ds_read_b128 v[64:67], v9 offset:57344
    v_mfma_f32_16x16x32_bf16 v[132:135], a[244:247], v[32:35], v[132:135]
    ds_read_b128 v[68:71], v9 offset:59392
    v_mfma_f32_16x16x32_bf16 v[136:139], a[240:243], v[36:39], v[136:139]
    ds_read_b128 v[72:75], v9 offset:61440
    v_mfma_f32_16x16x32_bf16 v[140:143], a[244:247], v[36:39], v[140:143]
    ds_read_b128 v[76:79], v9 offset:63488
    v_mfma_f32_16x16x32_bf16 v[144:147], a[240:243], v[40:43], v[144:147]
    v_mfma_f32_16x16x32_bf16 v[148:151], a[244:247], v[40:43], v[148:151]
    s_waitcnt vmcnt(0) lgkmcnt(0)
    s_barrier
    v_mfma_f32_16x16x32_bf16 v[152:155], a[240:243], v[44:47], v[152:155]
    v_mfma_f32_16x16x32_bf16 v[156:159], a[244:247], v[44:47], v[156:159]
    v_mfma_f32_16x16x32_bf16 v[128:131], a[248:251], v[64:67], v[128:131]
    v_mfma_f32_16x16x32_bf16 v[132:135], a[252:255], v[64:67], v[132:135]
    v_mfma_f32_16x16x32_bf16 v[136:139], a[248:251], v[68:71], v[136:139]
    v_mfma_f32_16x16x32_bf16 v[140:143], a[252:255], v[68:71], v[140:143]
    v_mfma_f32_16x16x32_bf16 v[144:147], a[248:251], v[72:75], v[144:147]
    v_mfma_f32_16x16x32_bf16 v[148:151], a[252:255], v[72:75], v[148:151]
    v_mfma_f32_16x16x32_bf16 v[152:155], a[248:251], v[76:79], v[152:155]
    v_mfma_f32_16x16x32_bf16 v[156:159], a[252:255], v[76:79], v[156:159]
be_66:
    s_waitcnt lgkmcnt(0)
    s_nop 9
    s_cmp_eq_u32 s40, 1
    s_cbranch_scc1 epi1s
    s_cmp_eq_u32 s40, 2
    s_cbranch_scc1 epi2s
    v_mul_lo_u32 v24, v3, s33
    v_and_b32 v25, 1, v2
    v_lshl_add_u32 v24, v25, 5, v24
    v_lshrrev_b32 v25, 1, v2
    v_lshl_add_u32 v24, v25, 4, v24
    s_lshl_b32 s45, s41, 6
    v_add_u32 v24, s45, v24
    s_lshl_b32 s46, s33, 4
    s_mul_i32 s47, s46, 0
    s_add_u32 s47, s47, s30
    v_cvt_pk_bf16_f32 v32, v128, v129
    v_cvt_pk_bf16_f32 v33, v130, v131
    v_cvt_pk_bf16_f32 v34, v132, v133
    v_cvt_pk_bf16_f32 v35, v134, v135
    s_nop 1
    v_permlane16_swap_b32 v32, v34
    v_permlane16_swap_b32 v33, v35
    s_nop 0
    buffer_store_dwordx4 v[32:35], v24, s[20:23], s47 offen sc1
    s_mul_i32 s47, s46, 1
    s_add_u32 s47, s47, s30
    v_cvt_pk_bf16_f32 v36, v136, v137
    v_cvt_pk_bf16_f32 v37, v138, v139
    v_cvt_pk_bf16_f32 v38, v140, v141
    v_cvt_pk_bf16_f32 v39, v142, v143
    s_nop 1
    v_permlane16_swap_b32 v36, v38
    v_permlane16_swap_b32 v37, v39
    s_nop 0
    buffer_store_dwordx4 v[36:39], v24, s[20:23], s47 offen sc1
    s_mul_i32 s47, s46, 2
    s_add_u32 s47, s47, s30
    v_cvt_pk_bf16_f32 v32, v144, v145
    v_cvt_pk_bf16_f32 v33, v146, v147
    v_cvt_pk_bf16_f32 v34, v148, v149
    v_cvt_pk_bf16_f32 v35, v150, v151
    s_nop 1
    v_permlane16_swap_b32 v32, v34
    v_permlane16_swap_b32 v33, v35
    s_nop 0
    buffer_store_dwordx4 v[32:35], v24, s[20:23], s47 offen sc1
    s_mul_i32 s47, s46, 3
    s_add_u32 s47, s47, s30
    v_cvt_pk_bf16_f32 v36, v152, v153
    v_cvt_pk_bf16_f32 v37, v154, v155
    v_cvt_pk_bf16_f32 v38, v156, v157
    v_cvt_pk_bf16_f32 v39, v158, v159
    s_nop 1
    v_permlane16_swap_b32 v36, v38
    v_permlane16_swap_b32 v37, v39
    s_nop 0
    buffer_store_dwordx4 v[36:39], v24, s[20:23], s47 offen sc1
    s_branch unit_done
epi1s:
    s_mov_b32 s52, 0xbdd2d3e8
    s_mov_b32 s53, 0xbdd2d3e8
    v_mov_b32 v28, 0xc0135761
    v_mov_b32 v29, 0xc0135761
    v_mov_b32 v30, 1.0
    v_mov_b32 v31, 1.0
    v_mul_lo_u32 v24, v3, s33
    v_and_b32 v25, 1, v2
    v_lshl_add_u32 v24, v25, 5, v24
    v_lshrrev_b32 v25, 1, v2
    v_lshl_add_u32 v24, v25, 4, v24
    s_lshl_b32 s45, s41, 6
    v_add_u32 v24, s45, v24
    s_lshl_b32 s46, s33, 4
    s_mul_i32 s47, s46, 0
    s_add_u32 s47, s47, s30
    v_cvt_pk_bf16_f32 v40, v128, v129
    v_lshlrev_b32 v128, 16, v40
    v_and_b32 v129, 0xffff0000, v40
    v_cvt_pk_bf16_f32 v40, v130, v131
    v_lshlrev_b32 v130, 16, v40
    v_and_b32 v131, 0xffff0000, v40
    v_cvt_pk_bf16_f32 v40, v132, v133
    v_lshlrev_b32 v132, 16, v40
    v_and_b32 v133, 0xffff0000, v40
    v_cvt_pk_bf16_f32 v40, v134, v135
    v_lshlrev_b32 v134, 16, v40
    v_and_b32 v135, 0xffff0000, v40
    v_pk_mul_f32 v[40:41], v[128:129], v[128:129]
    v_pk_mul_f32 v[42:43], v[130:131], v[130:131]
    v_pk_mul_f32 v[44:45], v[132:133], v[132:133]
    v_pk_mul_f32 v[46:47], v[134:135], v[134:135]
    v_pk_fma_f32 v[40:41], v[40:41], s[52:53], v[28:29]
    v_pk_fma_f32 v[42:43], v[42:43], s[52:53], v[28:29]
    v_pk_fma_f32 v[44:45], v[44:45], s[52:53], v[28:29]
    v_pk_fma_f32 v[46:47], v[46:47], s[52:53], v[28:29]
    v_pk_mul_f32 v[40:41], v[40:41], v[128:129]
    v_pk_mul_f32 v[42:43], v[42:43], v[130:131]
    v_pk_mul_f32 v[44:45], v[44:45], v[132:133]
    v_pk_mul_f32 v[46:47], v[46:47], v[134:135]
    v_exp_f32 v40, v40
    v_exp_f32 v41, v41
    v_exp_f32 v42, v42
    v_exp_f32 v43, v43
    v_exp_f32 v44, v44
    v_exp_f32 v45, v45
    v_exp_f32 v46, v46
    v_exp_f32 v47, v47
    v_pk_add_f32 v[40:41], v[40:41], v[30:31]
    v_pk_add_f32 v[42:43], v[42:43], v[30:31]
    v_pk_add_f32 v[44:45], v[44:45], v[30:31]
    v_pk_add_f32 v[46:47], v[46:47], v[30:31]
    v_rcp_f32 v40, v40
    v_rcp_f32 v41, v41
    v_rcp_f32 v42, v42
    v_rcp_f32 v43, v43
    v_rcp_f32 v44, v44
    v_rcp_f32 v45, v45
    v_rcp_f32 v46, v46
    v_rcp_f32 v47, v47
    s_nop 0
    v_pk_mul_f32 v[128:129], v[128:129], v[40:41]
    v_pk_mul_f32 v[130:131], v[130:131], v[42:43]
    v_pk_mul_f32 v[132:133], v[132:133], v[44:45]
    v_pk_mul_f32 v[134:135], v[134:135], v[46:47]
    v_cvt_pk_bf16_f32 v32, v128, v129
    v_cvt_pk_bf16_f32 v33, v130, v131
    v_cvt_pk_bf16_f32 v34, v132, v133
    v_cvt_pk_bf16_f32 v35, v134, v135
    s_nop 1
    v_permlane16_swap_b32 v32, v34
    v_permlane16_swap_b32 v33, v35
    s_nop 0
    buffer_store_dwordx4 v[32:35], v24, s[20:23], s47 offen sc1
    s_mul_i32 s47, s46, 1
    s_add_u32 s47, s47, s30
    v_cvt_pk_bf16_f32 v40, v136, v137
    v_lshlrev_b32 v136, 16, v40
    v_and_b32 v137, 0xffff0000, v40
    v_cvt_pk_bf16_f32 v40, v138, v139
    v_lshlrev_b32 v138, 16, v40
    v_and_b32 v139, 0xffff0000, v40
    v_cvt_pk_bf16_f32 v40, v140, v141
    v_lshlrev_b32 v140, 16, v40
    v_and_b32 v141, 0xffff0000, v40
    v_cvt_pk_bf16_f32 v40, v142, v143
    v_lshlrev_b32 v142, 16, v40
    v_and_b32 v143, 0xffff0000, v40
    v_pk_mul_f32 v[40:41], v[136:137], v[136:137]
    v_pk_mul_f32 v[42:43], v[138:139], v[138:139]
    v_pk_mul_f32 v[44:45], v[140:141], v[140:141]
    v_pk_mul_f32 v[46:47], v[142:143], v[142:143]
    v_pk_fma_f32 v[40:41], v[40:41], s[52:53], v[28:29]
    v_pk_fma_f32 v[42:43], v[42:43], s[52:53], v[28:29]
    v_pk_fma_f32 v[44:45], v[44:45], s[52:53], v[28:29]
    v_pk_fma_f32 v[46:47], v[46:47], s[52:53], v[28:29]
    v_pk_mul_f32 v[40:41], v[40:41], v[136:137]
    v_pk_mul_f32 v[42:43], v[42:43], v[138:139]
    v_pk_mul_f32 v[44:45], v[44:45], v[140:141]
    v_pk_mul_f32 v[46:47], v[46:47], v[142:143]
    v_exp_f32 v40, v40
    v_exp_f32 v41, v41
    v_exp_f32 v42, v42
    v_exp_f32 v43, v43
    v_exp_f32 v44, v44
    v_exp_f32 v45, v45
    v_exp_f32 v46, v46
    v_exp_f32 v47, v47
    v_pk_add_f32 v[40:41], v[40:41], v[30:31]
    v_pk_add_f32 v[42:43], v[42:43], v[30:31]
    v_pk_add_f32 v[44:45], v[44:45], v[30:31]
    v_pk_add_f32 v[46:47], v[46:47], v[30:31]
    v_rcp_f32 v40, v40
    v_rcp_f32 v41, v41
    v_rcp_f32 v42, v42
    v_rcp_f32 v43, v43
    v_rcp_f32 v44, v44
    v_rcp_f32 v45, v45
    v_rcp_f32 v46, v46
    v_rcp_f32 v47, v47
    s_nop 0
    v_pk_mul_f32 v[136:137], v[136:137], v[40:41]
    v_pk_mul_f32 v[138:139], v[138:139], v[42:43]
    v_pk_mul_f32 v[140:141], v[140:141], v[44:45]
    v_pk_mul_f32 v[142:143], v[142:143], v[46:47]
    v_cvt_pk_bf16_f32 v36, v136, v137
    v_cvt_pk_bf16_f32 v37, v138, v139
    v_cvt_pk_bf16_f32 v38, v140, v141
    v_cvt_pk_bf16_f32 v39, v142, v143
    s_nop 1
    v_permlane16_swap_b32 v36, v38
    v_permlane16_swap_b32 v37, v39
    s_nop 0
    buffer_store_dwordx4 v[36:39], v24, s[20:23], s47 offen sc1
    s_mul_i32 s47, s46, 2
    s_add_u32 s47, s47, s30
    v_cvt_pk_bf16_f32 v40, v144, v145
    v_lshlrev_b32 v144, 16, v40
    v_and_b32 v145, 0xffff0000, v40
    v_cvt_pk_bf16_f32 v40, v146, v147
    v_lshlrev_b32 v146, 16, v40
    v_and_b32 v147, 0xffff0000, v40
    v_cvt_pk_bf16_f32 v40, v148, v149
    v_lshlrev_b32 v148, 16, v40
    v_and_b32 v149, 0xffff0000, v40
    v_cvt_pk_bf16_f32 v40, v150, v151
    v_lshlrev_b32 v150, 16, v40
    v_and_b32 v151, 0xffff0000, v40
    v_pk_mul_f32 v[40:41], v[144:145], v[144:145]
    v_pk_mul_f32 v[42:43], v[146:147], v[146:147]
    v_pk_mul_f32 v[44:45], v[148:149], v[148:149]
    v_pk_mul_f32 v[46:47], v[150:151], v[150:151]
    v_pk_fma_f32 v[40:41], v[40:41], s[52:53], v[28:29]
    v_pk_fma_f32 v[42:43], v[42:43], s[52:53], v[28:29]
    v_pk_fma_f32 v[44:45], v[44:45], s[52:53], v[28:29]
    v_pk_fma_f32 v[46:47], v[46:47], s[52:53], v[28:29]
    v_pk_mul_f32 v[40:41], v[40:41], v[144:145]
    v_pk_mul_f32 v[42:43], v[42:43], v[146:147]
    v_pk_mul_f32 v[44:45], v[44:45], v[148:149]
    v_pk_mul_f32 v[46:47], v[46:47], v[150:151]
    v_exp_f32 v40, v40
    v_exp_f32 v41, v41
    v_exp_f32 v42, v42
    v_exp_f32 v43, v43
    v_exp_f32 v44, v44
    v_exp_f32 v45, v45
    v_exp_f32 v46, v46
    v_exp_f32 v47, v47
    v_pk_add_f32 v[40:41], v[40:41], v[30:31]
    v_pk_add_f32 v[42:43], v[42:43], v[30:31]
    v_pk_add_f32 v[44:45], v[44:45], v[30:31]
    v_pk_add_f32 v[46:47], v[46:47], v[30:31]
    v_rcp_f32 v40, v40
    v_rcp_f32 v41, v41
    v_rcp_f32 v42, v42
    v_rcp_f32 v43, v43
    v_rcp_f32 v44, v44
    v_rcp_f32 v45, v45
    v_rcp_f32 v46, v46
    v_rcp_f32 v47, v47
    s_nop 0
    v_pk_mul_f32 v[144:145], v[144:145], v[40:41]
    v_pk_mul_f32 v[146:147], v[146:147], v[42:43]
    v_pk_mul_f32 v[148:149], v[148:149], v[44:45]
    v_pk_mul_f32 v[150:151], v[150:151], v[46:47]
    v_cvt_pk_bf16_f32 v32, v144, v145
    v_cvt_pk_bf16_f32 v33, v146, v147
    v_cvt_pk_bf16_f32 v34, v148, v149
    v_cvt_pk_bf16_f32 v35, v150, v151
    s_nop 1
    v_permlane16_swap_b32 v32, v34
    v_permlane16_swap_b32 v33, v35
    s_nop 0
    buffer_store_dwordx4 v[32:35], v24, s[20:23], s47 offen sc1
    s_mul_i32 s47, s46, 3
    s_add_u32 s47, s47, s30
    v_cvt_pk_bf16_f32 v40, v152, v153
    v_lshlrev_b32 v152, 16, v40
    v_and_b32 v153, 0xffff0000, v40
    v_cvt_pk_bf16_f32 v40, v154, v155
    v_lshlrev_b32 v154, 16, v40
    v_and_b32 v155, 0xffff0000, v40
    v_cvt_pk_bf16_f32 v40, v156, v157
    v_lshlrev_b32 v156, 16, v40
    v_and_b32 v157, 0xffff0000, v40
    v_cvt_pk_bf16_f32 v40, v158, v159
    v_lshlrev_b32 v158, 16, v40
    v_and_b32 v159, 0xffff0000, v40
    v_pk_mul_f32 v[40:41], v[152:153], v[152:153]
    v_pk_mul_f32 v[42:43], v[154:155], v[154:155]
    v_pk_mul_f32 v[44:45], v[156:157], v[156:157]
    v_pk_mul_f32 v[46:47], v[158:159], v[158:159]
    v_pk_fma_f32 v[40:41], v[40:41], s[52:53], v[28:29]
    v_pk_fma_f32 v[42:43], v[42:43], s[52:53], v[28:29]
    v_pk_fma_f32 v[44:45], v[44:45], s[52:53], v[28:29]
    v_pk_fma_f32 v[46:47], v[46:47], s[52:53], v[28:29]
    v_pk_mul_f32 v[40:41], v[40:41], v[152:153]
    v_pk_mul_f32 v[42:43], v[42:43], v[154:155]
    v_pk_mul_f32 v[44:45], v[44:45], v[156:157]
    v_pk_mul_f32 v[46:47], v[46:47], v[158:159]
    v_exp_f32 v40, v40
    v_exp_f32 v41, v41
    v_exp_f32 v42, v42
    v_exp_f32 v43, v43
    v_exp_f32 v44, v44
    v_exp_f32 v45, v45
    v_exp_f32 v46, v46
    v_exp_f32 v47, v47
    v_pk_add_f32 v[40:41], v[40:41], v[30:31]
    v_pk_add_f32 v[42:43], v[42:43], v[30:31]
    v_pk_add_f32 v[44:45], v[44:45], v[30:31]
    v_pk_add_f32 v[46:47], v[46:47], v[30:31]
    v_rcp_f32 v40, v40
    v_rcp_f32 v41, v41
    v_rcp_f32 v42, v42
    v_rcp_f32 v43, v43
    v_rcp_f32 v44, v44
    v_rcp_f32 v45, v45
    v_rcp_f32 v46, v46
    v_rcp_f32 v47, v47
    s_nop 0
    v_pk_mul_f32 v[152:153], v[152:153], v[40:41]
    v_pk_mul_f32 v[154:155], v[154:155], v[42:43]
    v_pk_mul_f32 v[156:157], v[156:157], v[44:45]
    v_pk_mul_f32 v[158:159], v[158:159], v[46:47]
    v_cvt_pk_bf16_f32 v36, v152, v153
    v_cvt_pk_bf16_f32 v37, v154, v155
    v_cvt_pk_bf16_f32 v38, v156, v157
    v_cvt_pk_bf16_f32 v39, v158, v159
    s_nop 1
    v_permlane16_swap_b32 v36, v38
    v_permlane16_swap_b32 v37, v39
    s_nop 0
    buffer_store_dwordx4 v[36:39], v24, s[20:23], s47 offen sc1
    s_branch unit_done
epi2s:
    v_mul_lo_u32 v24, v3, s33
    v_and_b32 v25, 1, v2
    v_lshl_add_u32 v24, v25, 5, v24
    v_lshrrev_b32 v25, 1, v2
    v_lshl_add_u32 v24, v25, 4, v24
    s_lshl_b32 s45, s41, 6
    v_add_u32 v24, s45, v24
    s_lshl_b32 s46, s33, 4
    s_mul_i32 s47, s46, 0
    s_add_u32 s47, s47, s38
    buffer_load_dwordx4 v[96:99], v24, s[24:27], s47 offen sc1
    s_mul_i32 s47, s46, 1
    s_add_u32 s47, s47, s38
    buffer_load_dwordx4 v[100:103], v24, s[24:27], s47 offen sc1
    s_mul_i32 s47, s46, 2
    s_add_u32 s47, s47, s38
    buffer_load_dwordx4 v[104:107], v24, s[24:27], s47 offen sc1
    s_mul_i32 s47, s46, 3
    s_add_u32 s47, s47, s38
    buffer_load_dwordx4 v[108:111], v24, s[24:27], s47 offen sc1
    s_mul_i32 s47, s46, 0
    s_add_u32 s47, s47, s30
    v_cvt_pk_bf16_f32 v32, v128, v129
    v_cvt_pk_bf16_f32 v33, v130, v131
    v_cvt_pk_bf16_f32 v34, v132, v133
    v_cvt_pk_bf16_f32 v35, v134, v135
    s_nop 1
    v_permlane16_swap_b32 v32, v34
    v_permlane16_swap_b32 v33, v35
    s_waitcnt vmcnt(0)
    v_lshlrev_b32 v40, 16, v32
    v_and_b32 v41, 0xffff0000, v32
    v_lshlrev_b32 v42, 16, v96
    v_and_b32 v43, 0xffff0000, v96
    v_pk_add_f32 v[40:41], v[40:41], v[42:43]
    v_cvt_pk_bf16_f32 v32, v40, v41
    v_lshlrev_b32 v40, 16, v33
    v_and_b32 v41, 0xffff0000, v33
    v_lshlrev_b32 v42, 16, v97
    v_and_b32 v43, 0xffff0000, v97
    v_pk_add_f32 v[40:41], v[40:41], v[42:43]
    v_cvt_pk_bf16_f32 v33, v40, v41
    v_lshlrev_b32 v40, 16, v34
    v_and_b32 v41, 0xffff0000, v34
    v_lshlrev_b32 v42, 16, v98
    v_and_b32 v43, 0xffff0000, v98
    v_pk_add_f32 v[40:41], v[40:41], v[42:43]
    v_cvt_pk_bf16_f32 v34, v40, v41
    v_lshlrev_b32 v40, 16, v35
    v_and_b32 v41, 0xffff0000, v35
    v_lshlrev_b32 v42, 16, v99
    v_and_b32 v43, 0xffff0000, v99
    v_pk_add_f32 v[40:41], v[40:41], v[42:43]
    v_cvt_pk_bf16_f32 v35, v40, v41
    buffer_store_dwordx4 v[32:35], v24, s[20:23], s47 offen sc1
    s_mul_i32 s47, s46, 1
    s_add_u32 s47, s47, s30
    v_cvt_pk_bf16_f32 v36, v136, v137
    v_cvt_pk_bf16_f32 v37, v138, v139
    v_cvt_pk_bf16_f32 v38, v140, v141
    v_cvt_pk_bf16_f32 v39, v142, v143
    s_nop 1
    v_permlane16_swap_b32 v36, v38
    v_permlane16_swap_b32 v37, v39
    v_lshlrev_b32 v40, 16, v36
    v_and_b32 v41, 0xffff0000, v36
    v_lshlrev_b32 v42, 16, v100
    v_and_b32 v43, 0xffff0000, v100
    v_pk_add_f32 v[40:41], v[40:41], v[42:43]
    v_cvt_pk_bf16_f32 v36, v40, v41
    v_lshlrev_b32 v40, 16, v37
    v_and_b32 v41, 0xffff0000, v37
    v_lshlrev_b32 v42, 16, v101
    v_and_b32 v43, 0xffff0000, v101
    v_pk_add_f32 v[40:41], v[40:41], v[42:43]
    v_cvt_pk_bf16_f32 v37, v40, v41
    v_lshlrev_b32 v40, 16, v38
    v_and_b32 v41, 0xffff0000, v38
    v_lshlrev_b32 v42, 16, v102
    v_and_b32 v43, 0xffff0000, v102
    v_pk_add_f32 v[40:41], v[40:41], v[42:43]
    v_cvt_pk_bf16_f32 v38, v40, v41
    v_lshlrev_b32 v40, 16, v39
    v_and_b32 v41, 0xffff0000, v39
    v_lshlrev_b32 v42, 16, v103
    v_and_b32 v43, 0xffff0000, v103
    v_pk_add_f32 v[40:41], v[40:41], v[42:43]
    v_cvt_pk_bf16_f32 v39, v40, v41
    buffer_store_dwordx4 v[36:39], v24, s[20:23], s47 offen sc1
    s_mul_i32 s47, s46, 2
    s_add_u32 s47, s47, s30
    v_cvt_pk_bf16_f32 v32, v144, v145
    v_cvt_pk_bf16_f32 v33, v146, v147
    v_cvt_pk_bf16_f32 v34, v148, v149
    v_cvt_pk_bf16_f32 v35, v150, v151
    s_nop 1
    v_permlane16_swap_b32 v32, v34
    v_permlane16_swap_b32 v33, v35
    v_lshlrev_b32 v40, 16, v32
    v_and_b32 v41, 0xffff0000, v32
    v_lshlrev_b32 v42, 16, v104
    v_and_b32 v43, 0xffff0000, v104
    v_pk_add_f32 v[40:41], v[40:41], v[42:43]
    v_cvt_pk_bf16_f32 v32, v40, v41
    v_lshlrev_b32 v40, 16, v33
    v_and_b32 v41, 0xffff0000, v33
    v_lshlrev_b32 v42, 16, v105
    v_and_b32 v43, 0xffff0000, v105
    v_pk_add_f32 v[40:41], v[40:41], v[42:43]
    v_cvt_pk_bf16_f32 v33, v40, v41
    v_lshlrev_b32 v40, 16, v34
    v_and_b32 v41, 0xffff0000, v34
    v_lshlrev_b32 v42, 16, v106
    v_and_b32 v43, 0xffff0000, v106
    v_pk_add_f32 v[40:41], v[40:41], v[42:43]
    v_cvt_pk_bf16_f32 v34, v40, v41
    v_lshlrev_b32 v40, 16, v35
    v_and_b32 v41, 0xffff0000, v35
    v_lshlrev_b32 v42, 16, v107
    v_and_b32 v43, 0xffff0000, v107
    v_pk_add_f32 v[40:41], v[40:41], v[42:43]
    v_cvt_pk_bf16_f32 v35, v40, v41
    buffer_store_dwordx4 v[32:35], v24, s[20:23], s47 offen sc1
    s_mul_i32 s47, s46, 3
    s_add_u32 s47, s47, s30
    v_cvt_pk_bf16_f32 v36, v152, v153
    v_cvt_pk_bf16_f32 v37, v154, v155
    v_cvt_pk_bf16_f32 v38, v156, v157
    v_cvt_pk_bf16_f32 v39, v158, v159
    s_nop 1
    v_permlane16_swap_b32 v36, v38
    v_permlane16_swap_b32 v37, v39
    v_lshlrev_b32 v40, 16, v36
    v_and_b32 v41, 0xffff0000, v36
    v_lshlrev_b32 v42, 16, v108
    v_and_b32 v43, 0xffff0000, v108
    v_pk_add_f32 v[40:41], v[40:41], v[42:43]
    v_cvt_pk_bf16_f32 v36, v40, v41
    v_lshlrev_b32 v40, 16, v37
    v_and_b32 v41, 0xffff0000, v37
    v_lshlrev_b32 v42, 16, v109
    v_and_b32 v43, 0xffff0000, v109
    v_pk_add_f32 v[40:41], v[40:41], v[42:43]
    v_cvt_pk_bf16_f32 v37, v40, v41
    v_lshlrev_b32 v40, 16, v38
    v_and_b32 v41, 0xffff0000, v38
    v_lshlrev_b32 v42, 16, v110
    v_and_b32 v43, 0xffff0000, v110
    v_pk_add_f32 v[40:41], v[40:41], v[42:43]
    v_cvt_pk_bf16_f32 v38, v40, v41
    v_lshlrev_b32 v40, 16, v39
    v_and_b32 v41, 0xffff0000, v39
    v_lshlrev_b32 v42, 16, v111
    v_and_b32 v43, 0xffff0000, v111
    v_pk_add_f32 v[40:41], v[40:41], v[42:43]
    v_cvt_pk_bf16_f32 v39, v40, v41
    buffer_store_dwordx4 v[36:39], v24, s[20:23], s47 offen sc1
    s_branch unit_done
unit_done:
    s_waitcnt vmcnt(0)
    s_barrier
    v_cmp_eq_u32 vcc, 0, v0
    s_and_saveexec_b64 s[92:93], vcc
    s_cbranch_execz sf_67
    v_mov_b32 v250, 0
    v_mov_b32 v251, 1
    buffer_store_dword v251, v250, s[8:11], s83 offen sc1
sf_67:
    s_mov_b64 exec, s[92:93]
    s_cmp_eq_u32 s84, 1
    s_cbranch_scc1 qkv_next
    s_cmp_eq_u32 s84, 2
    s_cbranch_scc1 rl_top
    s_cmp_eq_u32 s84, 3
    s_cbranch_scc1 att_next
    s_branch ms_top
unit_nosig:
    s_waitcnt vmcnt(0)
    s_barrier
    s_branch rl_top
worker_abort:
    s_mov_b64 exec, 1
    v_mov_b32 v250, 1
    v_mov_b32 v251, 132
    global_atomic_add v251, v250, s[6:7] sc1
    s_waitcnt vmcnt(0)
L_exit_main:
    s_endpgm
.p2align 2
.type qtable,@object
qtable:
    .long 0x20000058, 0x77800000, 0x00000000, 0x00000000
    .long 0x20020058, 0x77820000, 0x00000000, 0x00000000
    .long 0x20040058, 0x77840000, 0x00000000, 0x00000000
    .long 0x20060058, 0x77860000, 0x00000000, 0x00000000
    .long 0x20080058, 0x77880000, 0x00000000, 0x00000000
    .long 0x200a0058, 0x778a0000, 0x00000000, 0x00000000
    .long 0x200c0058, 0x778c0000, 0x00000000, 0x00000000
    .long 0x200e0058, 0x778e0000, 0x00000000, 0x00000000
    .long 0x40000000, 0x00000000, 0x00000000, 0x00000000
    .long 0x40020000, 0x00000000, 0x00000000, 0x00000000
    .long 0x40040000, 0x00000000, 0x00000000, 0x00000000
    .long 0x40060000, 0x00000000, 0x00000000, 0x00000000
    .long 0x40080000, 0x00000000, 0x00000000, 0x00000000
    .long 0x400a0000, 0x00000000, 0x00000000, 0x00000000
    .long 0x400c0000, 0x00000000, 0x00000000, 0x00000000
    .long 0x400e0000, 0x00000000, 0x00000000, 0x00000000
    .long 0x80000050, 0x00000000, 0x00000000, 0x00000000
    .long 0x80020050, 0x00000000, 0x00000000, 0x00000000
    .long 0x80040050, 0x00000000, 0x00000000, 0x00000000
    .long 0x80060050, 0x00000000, 0x00000000, 0x00000000
    .long 0x80080050, 0x00000000, 0x00000000, 0x00000000
    .long 0x800a0050, 0x00000000, 0x00000000, 0x00000000
    .long 0x800c0050, 0x00000000, 0x00000000, 0x00000000
    .long 0x800e0050, 0x00000000, 0x00000000, 0x00000000
    .long 0x10003f00, 0x87c92649, 0x00000000, 0x00000000
    .long 0x10023f00, 0x87cb2649, 0x00000000, 0x00000000
    .long 0x10043f00, 0x87cd2649, 0x00000000, 0x00000000
    .long 0x10063f00, 0x87cf2649, 0x00000000, 0x00000000
    .long 0x10083f00, 0x87c16f49, 0x00000000, 0x00000000
    .long 0x100a3f00, 0x87c36f49, 0x00000000, 0x00000000
    .long 0x100c3f00, 0x87c56f49, 0x00000000, 0x00000000
    .long 0x100e3f00, 0x87c76f49, 0x00000000, 0x00000000
    .long 0x20004b58, 0x77900000, 0x00000000, 0x00000000
    .long 0x20024b58, 0x77920000, 0x00000000, 0x00000000
    .long 0x20044b58, 0x77940000, 0x00000000, 0x00000000
    .long 0x20064b58, 0x77960000, 0x00000000, 0x00000000
    .long 0x20084b58, 0x77980000, 0x00000000, 0x00000000
    .long 0x200a4b58, 0x779a0000, 0x00000000, 0x00000000
    .long 0x200c4b58, 0x779c0000, 0x00000000, 0x00000000
    .long 0x200e4b58, 0x779e0000, 0x00000000, 0x00000000
    .long 0x50000000, 0x00000000, 0x00000000, 0x00000000
    .long 0x50020000, 0x00000000, 0x00000000, 0x00000000
    .long 0x50040000, 0x00000000, 0x00000000, 0x00000000
    .long 0x50060000, 0x00000000, 0x00000000, 0x00000000
    .long 0x50080000, 0x00000000, 0x00000000, 0x00000000
    .long 0x500a0000, 0x00000000, 0x00000000, 0x00000000
    .long 0x500c0000, 0x00000000, 0x00000000, 0x00000000
    .long 0x500e0000, 0x00000000, 0x00000000, 0x00000000
    .long 0x80004a50, 0x00000000, 0x00000000, 0x00000000
    .long 0x80024a50, 0x00000000, 0x00000000, 0x00000000
    .long 0x80044a50, 0x00000000, 0x00000000, 0x00000000
    .long 0x80064a50, 0x00000000, 0x00000000, 0x00000000
    .long 0x80084a50, 0x00000000, 0x00000000, 0x00000000
    .long 0x800a4a50, 0x00000000, 0x00000000, 0x00000000
    .long 0x800c4a50, 0x00000000, 0x00000000, 0x00000000
    .long 0x800e4a50, 0x00000000, 0x00000000, 0x00000000
    .long 0x10403f00, 0x87c96f49, 0x00000000, 0x00000000
    .long 0x10423f00, 0x87cb6f49, 0x00000000, 0x00000000
    .long 0x10443f00, 0x87cd6f49, 0x00000000, 0x00000000
    .long 0x10463f00, 0x87cf6f49, 0x00000000, 0x00000000
    .long 0x10483f00, 0x00000000, 0x00000000, 0x00000000
    .long 0x104a3f00, 0x00000000, 0x00000000, 0x00000000
    .long 0x104c3f00, 0x00000000, 0x00000000, 0x00000000
    .long 0x104e3f00, 0x00000000, 0x00000000, 0x00000000
    .long 0x20009658, 0x77a00000, 0x00000000, 0x00000000
    .long 0x20029658, 0x77a20000, 0x00000000, 0x00000000
    .long 0x20049658, 0x77a40000, 0x00000000, 0x00000000
    .long 0x20069658, 0x77a60000, 0x00000000, 0x00000000
    .long 0x20089658, 0x77a80000, 0x00000000, 0x00000000
    .long 0x200a9658, 0x77aa0000, 0x00000000, 0x00000000
    .long 0x200c9658, 0x77ac0000, 0x00000000, 0x00000000
    .long 0x200e9658, 0x77ae0000, 0x00000000, 0x00000000
    .long 0x70000007, 0x00000000, 0x00000000, 0x00000000
    .long 0x70020007, 0x00000000, 0x00000000, 0x00000000
    .long 0x70040007, 0x00000000, 0x00000000, 0x00000000
    .long 0x70060007, 0x00000000, 0x00000000, 0x00000000
    .long 0x70080007, 0x00000000, 0x00000000, 0x00000000
    .long 0x700a0007, 0x00000000, 0x00000000, 0x00000000
    .long 0x700c0007, 0x00000000, 0x00000000, 0x00000000
    .long 0x80009448, 0x00000000, 0x00000000, 0x00000000
    .long 0x80029448, 0x00000000, 0x00000000, 0x00000000
    .long 0x80049448, 0x00000000, 0x00000000, 0x00000000
    .long 0x80069448, 0x00000000, 0x00000000, 0x00000000
    .long 0x80089448, 0x00000000, 0x00000000, 0x00000000
    .long 0x800a9448, 0x00000000, 0x00000000, 0x00000000
    .long 0x800c9448, 0x00000000, 0x00000000, 0x00000000
    .long 0x800e9448, 0x00000000, 0x00000000, 0x00000000
    .long 0xa0000000, 0x00000000, 0x00000000, 0x00000000
    .long 0xa0020000, 0x00000000, 0x00000000, 0x00000000
    .long 0xa0040000, 0x00000000, 0x00000000, 0x00000000
    .long 0xa0060000, 0x00000000, 0x00000000, 0x00000000
    .long 0xa0080000, 0x00000000, 0x00000000, 0x00000000
    .long 0xa00a0000, 0x00000000, 0x00000000, 0x00000000
    .long 0xa00c0000, 0x00000000, 0x00000000, 0x00000000
    .long 0xa00e0000, 0x00000000, 0x00000000, 0x00000000
    .long 0xa0100000, 0x00000000, 0x00000000, 0x00000000
    .long 0x2000e158, 0x77b00000, 0x00000000, 0x00000000
    .long 0x2002e158, 0x77b20000, 0x00000000, 0x00000000
    .long 0x2004e158, 0x77b40000, 0x00000000, 0x00000000
    .long 0x2006e158, 0x77b60000, 0x00000000, 0x00000000
    .long 0x2008e158, 0x00000000, 0x00000000, 0x00000000
    .long 0x200ae158, 0x00000000, 0x00000000, 0x00000000
    .long 0x200ce158, 0x00000000, 0x00000000, 0x00000000
    .long 0x200ee158, 0x00000000, 0x00000000, 0x00000000
    .long 0x700e0007, 0x00000000, 0x00000000, 0x00000000
    .long 0x70100007, 0x00000000, 0x00000000, 0x00000000
    .long 0x70120007, 0x00000000, 0x00000000, 0x00000000
    .long 0x70140007, 0x00000000, 0x00000000, 0x00000000
    .long 0x70160007, 0x00000000, 0x00000000, 0x00000000
    .long 0x70180007, 0x00000000, 0x00000000, 0x00000000
    .long 0x701a0007, 0x00000000, 0x00000000, 0x00000000
    .long 0x8000dd48, 0x00000000, 0x00000000, 0x00000000
    .long 0x8002dd48, 0x00000000, 0x00000000, 0x00000000
    .long 0x8004dd48, 0x00000000, 0x00000000, 0x00000000
    .long 0x8006dd48, 0x00000000, 0x00000000, 0x00000000
    .long 0x8008dd48, 0x00000000, 0x00000000, 0x00000000
    .long 0x800add48, 0x00000000, 0x00000000, 0x00000000
    .long 0x800cdd48, 0x00000000, 0x00000000, 0x00000000
    .long 0x800edd48, 0x00000000, 0x00000000, 0x00000000
    .long 0xa0120000, 0x00000000, 0x00000000, 0x00000000
    .long 0xa0140000, 0x00000000, 0x00000000, 0x00000000
    .long 0xa0160000, 0x00000000, 0x00000000, 0x00000000
    .long 0xa0180000, 0x00000000, 0x00000000, 0x00000000
    .long 0xa01a0000, 0x00000000, 0x00000000, 0x00000000
    .long 0xa01c0000, 0x00000000, 0x00000000, 0x00000000
    .long 0xa01e0000, 0x00000000, 0x00000000, 0x00000000
    .long 0xa0200000, 0x00000000, 0x00000000, 0x00000000
    .long 0xa0220000, 0x00000000, 0x00000000, 0x00000000
    .long 0x20012c50, 0x00000000, 0x00000000, 0x00000000
    .long 0x20032c50, 0x00000000, 0x00000000, 0x00000000
    .long 0x20052c50, 0x00000000, 0x00000000, 0x00000000
    .long 0x20072c50, 0x00000000, 0x00000000, 0x00000000
    .long 0x20092c50, 0x00000000, 0x00000000, 0x00000000
    .long 0x200b2c50, 0x00000000, 0x00000000, 0x00000000
    .long 0x200d2c50, 0x00000000, 0x00000000, 0x00000000
    .long 0x200f2c50, 0x00000000, 0x00000000, 0x00000000
    .long 0x701c0007, 0x00000000, 0x00000000, 0x00000000
    .long 0x701e0007, 0x00000000, 0x00000000, 0x00000000
    .long 0x70200007, 0x00000000, 0x00000000, 0x00000000
    .long 0x70220007, 0x00000000, 0x00000000, 0x00000000
    .long 0x70240007, 0x00000000, 0x00000000, 0x00000000
    .long 0x70260007, 0x00000000, 0x00000000, 0x00000000
    .long 0x70280007, 0x00000000, 0x00000000, 0x00000000
    .long 0x80012648, 0x00000000, 0x00000000, 0x00000000
    .long 0x80032648, 0x00000000, 0x00000000, 0x00000000
    .long 0x80052648, 0x00000000, 0x00000000, 0x00000000
    .long 0x80072648, 0x00000000, 0x00000000, 0x00000000
    .long 0x80092648, 0x00000000, 0x00000000, 0x00000000
    .long 0x800b2648, 0x00000000, 0x00000000, 0x00000000
    .long 0x800d2648, 0x00000000, 0x00000000, 0x00000000
    .long 0x800f2648, 0x00000000, 0x00000000, 0x00000000
    .long 0xa0240000, 0x00000000, 0x00000000, 0x00000000
    .long 0xa0260000, 0x00000000, 0x00000000, 0x00000000
    .long 0xa0280000, 0x00000000, 0x00000000, 0x00000000
    .long 0xa02a0000, 0x00000000, 0x00000000, 0x00000000
    .long 0xa02c0000, 0x00000000, 0x00000000, 0x00000000
    .long 0xa02e0000, 0x00000000, 0x00000000, 0x00000000
    .long 0xa0300000, 0x00000000, 0x00000000, 0x00000000
    .long 0xa0320000, 0x00000000, 0x00000000, 0x00000000
    .long 0xa0340000, 0x00000000, 0x00000000, 0x00000000
    .long 0x20017650, 0x00000000, 0x00000000, 0x00000000
    .long 0x20037650, 0x00000000, 0x00000000, 0x00000000
    .long 0x20057650, 0x00000000, 0x00000000, 0x00000000
    .long 0x20077650, 0x00000000, 0x00000000, 0x00000000
    .long 0x20097650, 0x00000000, 0x00000000, 0x00000000
    .long 0x200b7650, 0x00000000, 0x00000000, 0x00000000
    .long 0x200d7650, 0x00000000, 0x00000000, 0x00000000
    .long 0x200f7650, 0x00000000, 0x00000000, 0x00000000
    .long 0x702a0007, 0x00000000, 0x00000000, 0x00000000
    .long 0x702c0007, 0x00000000, 0x00000000, 0x00000000
    .long 0x702e0007, 0x00000000, 0x00000000, 0x00000000
    .long 0x70300007, 0x00000000, 0x00000000, 0x00000000
    .long 0x70320007, 0x00000000, 0x00000000, 0x00000000
    .long 0x70340007, 0x00000000, 0x00000000, 0x00000000
    .long 0x70360007, 0x00000000, 0x00000000, 0x00000000
    .long 0x80016f48, 0x00000000, 0x00000000, 0x00000000
    .long 0x80036f48, 0x00000000, 0x00000000, 0x00000000
    .long 0x80056f48, 0x00000000, 0x00000000, 0x00000000
    .long 0x80076f48, 0x00000000, 0x00000000, 0x00000000
    .long 0x80096f48, 0x00000000, 0x00000000, 0x00000000
    .long 0x800b6f48, 0x00000000, 0x00000000, 0x00000000
    .long 0x800d6f48, 0x00000000, 0x00000000, 0x00000000
    .long 0x800f6f48, 0x00000000, 0x00000000, 0x00000000
    .long 0xa0360000, 0x00000000, 0x00000000, 0x00000000
    .long 0xa0380000, 0x00000000, 0x00000000, 0x00000000
    .long 0xa03a0000, 0x00000000, 0x00000000, 0x00000000
    .long 0xa03c0000, 0x00000000, 0x00000000, 0x00000000
    .long 0xa03e0000, 0x00000000, 0x00000000, 0x00000000
    .long 0x00000000, 0x00000000, 0x00000000, 0x00000000
    .long 0x00000000, 0x00000000, 0x00000000, 0x00000000
    .long 0x00000000, 0x00000000, 0x00000000, 0x00000000
    .long 0x00000000, 0x00000000, 0x00000000, 0x00000000
    .long 0x27c00059, 0x77c00001, 0x00000000, 0x00000000
    .long 0x27c20059, 0x77c20001, 0x00000000, 0x00000000
    .long 0x27c40059, 0x77c40001, 0x00000000, 0x00000000
    .long 0x27c60059, 0x77c60001, 0x00000000, 0x00000000
    .long 0x27c80059, 0x77c80001, 0x00000000, 0x00000000
    .long 0x27ca0059, 0x77ca0001, 0x00000000, 0x00000000
    .long 0x27cc0059, 0x77cc0001, 0x00000000, 0x00000000
    .long 0x27ce0059, 0x77ce0001, 0x00000000, 0x00000000
    .long 0x27c04b59, 0x77d00001, 0x00000000, 0x00000000
    .long 0x27c24b59, 0x77d20001, 0x00000000, 0x00000000
    .long 0x27c44b59, 0x77d40001, 0x00000000, 0x00000000
    .long 0x27c64b59, 0x77d60001, 0x00000000, 0x00000000
    .long 0x27c84b59, 0x77d80001, 0x00000000, 0x00000000
    .long 0x27ca4b59, 0x77da0001, 0x00000000, 0x00000000
    .long 0x27cc4b59, 0x77dc0001, 0x00000000, 0x00000000
    .long 0x27ce4b59, 0x77de0001, 0x00000000, 0x00000000
    .long 0x27c09659, 0x77e00001, 0x00000000, 0x00000000
    .long 0x27c29659, 0x77e20001, 0x00000000, 0x00000000
    .long 0x27c49659, 0x77e40001, 0x00000000, 0x00000000
    .long 0x27c69659, 0x77e60001, 0x00000000, 0x00000000
    .long 0x27c89659, 0x77e80001, 0x00000000, 0x00000000
    .long 0x27ca9659, 0x77ea0001, 0x00000000, 0x00000000
    .long 0x27cc9659, 0x77ec0001, 0x00000000, 0x00000000
    .long 0x27ce9659, 0x77ee0001, 0x00000000, 0x00000000
    .long 0x27c0e159, 0x77f00001, 0x00000000, 0x00000000
    .long 0x27c2e159, 0x77f20001, 0x00000000, 0x00000000
    .long 0x27c4e159, 0x77f40001, 0x00000000, 0x00000000
    .long 0x27c6e159, 0x77f60001, 0x00000000, 0x00000000
    .long 0x27c8e159, 0x87c00051, 0x00000000, 0x00000000
    .long 0x27cae159, 0x87c20051, 0x00000000, 0x00000000
    .long 0x27cce159, 0x87c40051, 0x00000000, 0x00000000
    .long 0x27cee159, 0x87c60051, 0x00000000, 0x00000000
    .long 0x27c12c51, 0x87c80051, 0x00000000, 0x00000000
    .long 0x27c32c51, 0x87ca0051, 0x00000000, 0x00000000
    .long 0x27c52c51, 0x87cc0051, 0x00000000, 0x00000000
    .long 0x27c72c51, 0x87ce0051, 0x00000000, 0x00000000
    .long 0x27c92c51, 0x87c04a51, 0x00000000, 0x00000000
    .long 0x27cb2c51, 0x87c24a51, 0x00000000, 0x00000000
    .long 0x27cd2c51, 0x87c44a51, 0x00000000, 0x00000000
    .long 0x27cf2c51, 0x87c64a51, 0x00000000, 0x00000000
    .long 0x27c17651, 0x87c84a51, 0x00000000, 0x00000000
    .long 0x27c37651, 0x87ca4a51, 0x00000000, 0x00000000
    .long 0x27c57651, 0x87cc4a51, 0x00000000, 0x00000000
    .long 0x27c77651, 0x87ce4a51, 0x00000000, 0x00000000
    .long 0x27c97651, 0x87c09449, 0x00000000, 0x00000000
    .long 0x27cb7651, 0x87c29449, 0x00000000, 0x00000000
    .long 0x27cd7651, 0x87c49449, 0x00000000, 0x00000000
    .long 0x27cf7651, 0x87c69449, 0x00000000, 0x00000000
    .long 0x47c00001, 0x87c89449, 0x00000000, 0x00000000
    .long 0x47c20001, 0x87ca9449, 0x00000000, 0x00000000
    .long 0x47c40001, 0x87cc9449, 0x00000000, 0x00000000
    .long 0x47c60001, 0x87ce9449, 0x00000000, 0x00000000
    .long 0x47c80001, 0x87c0dd49, 0x00000000, 0x00000000
    .long 0x47ca0001, 0x87c2dd49, 0x00000000, 0x00000000
    .long 0x47cc0001, 0x87c4dd49, 0x00000000, 0x00000000
    .long 0x47ce0001, 0x87c6dd49, 0x00000000, 0x00000000
    .long 0x1fc00000, 0x57c00001, 0x87c8dd49, 0x00000000
    .long 0x1fc20000, 0x57c20001, 0x87cadd49, 0x00000000
    .long 0x1fc40000, 0x57c40001, 0x87ccdd49, 0x00000000
    .long 0x1fc60000, 0x57c60001, 0x87cedd49, 0x00000000
    .long 0x1fc80000, 0x57c80001, 0x87c12649, 0x00000000
    .long 0x1fca0000, 0x57ca0001, 0x87c32649, 0x00000000
    .long 0x1fcc0000, 0x57cc0001, 0x87c52649, 0x00000000
    .long 0x1fce0000, 0x57ce0001, 0x87c72649, 0x00000000
.section .rodata,"a"
.p2align 6
.amdhsa_kernel sequential_preLN__memory_aug_recurrent_mem_tr__mixer_s_mlp__prompt_kernel
  .amdhsa_next_free_vgpr 512
  .amdhsa_next_free_sgpr 102
  .amdhsa_accum_offset 256
  .amdhsa_group_segment_fixed_size 0
  .amdhsa_kernarg_size 120
  .amdhsa_user_sgpr_count 2
  .amdhsa_user_sgpr_kernarg_segment_ptr 1
  .amdhsa_system_sgpr_workgroup_id_x 1
  .amdhsa_float_denorm_mode_32 3
.end_amdhsa_kernel
```
